```python
import torch

def _softmax(x, axis=-1):
    return torch.softmax(x, dim=axis)
def _gelu(x):
    return torch.nn.functional.gelu(x, approximate="tanh")
def _silu(x):
    return torch.nn.functional.silu(x)
def _sigmoid(x):
    return torch.sigmoid(x)
def _layernorm(x, axis=-1, eps=1e-5):
    m = x.mean(dim=axis, keepdim=True)
    v = x.var(dim=axis, keepdim=True, unbiased=False)
    return (x - m) / torch.sqrt(v + eps)
def _scatter_add(tgt, idx, src, axis=0):
    return tgt.clone().index_add_(axis, idx, src)
def _segment_sum(src, seg, n):
    out = torch.zeros((n,) + src.shape[1:], dtype=src.dtype)
    return out.index_add_(0, seg, src)
def _pad(x, pw):
    flat = tuple(v for pair in reversed(pw) for v in pair)
    return torch.nn.functional.pad(x, flat)

kernel_name = 'sequential_preLN__mha_block__geglu_ffn__prompt'

def setup_inputs():

    _w = (lambda a: (lambda t: t.to(torch.bfloat16) if t.is_floating_point() else t)(torch.as_tensor(a)))
    def _A_setup():
        B, S, D, H = 1, 2048, 512, 32
        return {
            "x": _w((lambda *s: torch.randn(*s, dtype=torch.bfloat16) * 0.05)(B, S, D)),
            "wqkv": _w((lambda *s: torch.randn(*s, dtype=torch.bfloat16) * 0.05)(D, 3 * D)),
            "wo": _w((lambda *s: torch.randn(*s, dtype=torch.bfloat16) * 0.05)(D, D)),
        }
    _A_in = _A_setup()

    def _B_setup():
        B, S, D, F = 1, 2048, 512, 1792
        return {
            "x": _w((lambda *s: torch.randn(*s, dtype=torch.bfloat16) * 0.05)(B, S, D)),
            "w_gate": _w((lambda *s: torch.randn(*s, dtype=torch.bfloat16) * 0.05)(D, F)),
            "w_up": _w((lambda *s: torch.randn(*s, dtype=torch.bfloat16) * 0.05)(D, F)),
            "w_down": _w((lambda *s: torch.randn(*s, dtype=torch.bfloat16) * 0.05)(F, D)),
        }
    _B_in = _B_setup()

    return {
        "A_x": _A_in["x"],
        "A_wqkv": _A_in["wqkv"],
        "A_wo": _A_in["wo"],
        "B_x": _B_in["x"],
        "B_w_gate": _B_in["w_gate"],
        "B_w_up": _B_in["w_up"],
        "B_w_down": _B_in["w_down"],
    }

def reference(A_x, A_wqkv, A_wo, B_x, B_w_gate, B_w_up, B_w_down):
    def _A_ref(x, wqkv, wo):
        B, S, D = x.shape
        H = 32
        Dh = D // H
        qkv = (lambda x, *d: x.permute(*d))((x @ wqkv).reshape(B, S, 3, H, Dh), 2, 0, 3, 1, 4)
        q, k, v = qkv[0], qkv[1], qkv[2]
        scores = torch.einsum("bhqd,bhkd->bhqk", q, k) * (Dh ** -0.5)
        p = _softmax(scores, axis=-1)
        o = torch.einsum("bhqk,bhkd->bhqd", p, v)
        return (lambda x, *d: x.permute(*d))(o, 0, 2, 1, 3).reshape(B, S, D) @ wo

    def _B_ref(x, w_gate, w_up, w_down):
        return (_gelu(x @ w_gate) * (x @ w_up)) @ w_down

    x = A_x
    h = x + _A_ref(_layernorm(x, axis=-1), A_wqkv, A_wo)
    h2 = h + _B_ref(_layernorm(h, axis=-1), B_w_gate, B_w_up, B_w_down)
    return h2
```

```asm
; @launch kernel=qkv_kernel grid=(256,1,1) block=(512,1,1) lds=155648
; @launch kernel=ffn_kernel grid=(256,1,1) block=(512,1,1) lds=163840
.amdgcn_target "amdgcn-amd-amdhsa--gfx950"
.text
.p2align 8
TEXT_START:
    .globl qkv_kernel
    .p2align 8
    .type qkv_kernel,@function
qkv_kernel:
    s_cmp_ge_u32 s2, 256
    s_cbranch_scc1 qkv_kernel_done
    s_load_dwordx4 s[4:7], s[0:1], 0
    s_load_dwordx2 s[8:9], s[0:1], 72
    v_and_b32 v1, 63, v0
    v_lshrrev_b32 v2, 6, v0
    s_and_b32 s27, s2, 7
    s_lshr_b32 s28, s2, 3
    v_readfirstlane_b32 s24, v2
    s_lshr_b32 s25, s27, 1
    s_lshl_b32 s25, s25, 3
    s_lshr_b32 s29, s28, 2
    s_or_b32 s25, s25, s29
    s_and_b32 s26, s27, 1
    s_lshl_b32 s26, s26, 2
    s_and_b32 s29, s28, 3
    s_or_b32 s26, s26, s29
    s_cmp_lt_u32 s24, 4
    s_cbranch_scc1 L_mm_1
    s_setprio 2
    s_and_b32 s24, s24, 3
    s_mov_b32 s35, 0
    s_lshl_b32 s28, s25, 16
    s_lshl_b32 s29, s24, 14
    s_add_u32 s28, s28, s29
    v_lshrrev_b32 v2, 3, v1
    v_lshlrev_b32 v2, 10, v2
    v_and_b32 v3, 7, v1
    v_lshrrev_b32 v4, 4, v1
    v_xor_b32 v4, v3, v4
    v_lshl_add_u32 v7, v4, 4, v2
    v_add_u32 v7, s28, v7
    v_xor_b32 v8, 64, v7
    v_add_u32 v8, 7168, v8
    v_lshrrev_b32 v2, 3, v1
    v_mul_u32_u24 v2, 3072, v2
    v_bfe_u32 v4, v1, 4, 1
    v_lshlrev_b32 v4, 2, v4
    v_xor_b32 v4, v3, v4
    v_lshl_add_u32 v2, v4, 4, v2
    s_mul_i32 s28, s24, 49152
    s_lshl_b32 s29, s26, 7
    s_add_u32 s28, s28, s29
    v_add_u32 v9, s28, v2
    v_add_u32 v10, 23552, v9
    s_lshl_b32 s31, s24, 11
    v_lshlrev_b32 v15, 10, v1
    v_cmp_gt_u32 vcc, 4, v1
    v_mov_b32 v5, 0x40000000
    s_nop 0
    v_cndmask_b32 v15, v5, v15, vcc
    s_lshl_b32 s37, s25, 16
    s_and_b32 s27, s26, 3
    s_lshl_b32 s27, s27, 14
    s_add_u32 s37, s37, s27
    s_lshl_b32 s27, s24, 12
    s_add_u32 s37, s37, s27
    v_and_b32 v16, 1, v1
    v_mul_u32_u24 v16, 3072, v16
    v_lshrrev_b32 v2, 1, v1
    v_lshl_add_u32 v16, v2, 10, v16
    v_cmp_gt_u32 vcc, 6, v1
    s_nop 1
    v_cndmask_b32 v16, v5, v16, vcc
    s_and_b32 s27, s25, 7
    s_lshl_b32 s27, s27, 3
    s_lshl_b32 s28, s24, 1
    s_add_u32 s27, s27, s28
    s_mul_i32 s38, s27, 3072
    s_lshl_b32 s27, s26, 7
    s_add_u32 s38, s38, s27
    v_lshlrev_b32 v4, 7, v1
    s_waitcnt lgkmcnt(0)
    s_mov_b32 s12, s4
    s_mov_b32 s13, s5
    s_mov_b32 s14, 0x200000
    s_mov_b32 s15, 0x00020000
    s_mov_b32 s16, s6
    s_mov_b32 s17, s7
    s_mov_b32 s18, 0x180000
    s_mov_b32 s19, 0x00020000
    s_mov_b32 s20, s8
    s_mov_b32 s21, s9
    s_mov_b32 s22, 0x1800000
    s_mov_b32 s23, 0x00020000
    v_mov_b32 v116, 0
    v_mov_b32 v117, 0
    v_mov_b32 v118, 0
    v_mov_b32 v119, 0
    v_lshlrev_b32 v26, 4, v1
    s_lshl_b32 s39, s2, 12
    s_lshl_b32 s40, s24, 10
    s_add_u32 s39, s39, s40
    s_add_u32 s39, s39, 0x1100000
    buffer_load_dword v6, v15, s[12:15], s37 offen offset:0
    buffer_load_dword v6, v16, s[16:19], s38 offen
    s_add_u32 s38, s38, 196608
    buffer_load_dword v6, v15, s[12:15], s37 offen offset:128
    buffer_load_dword v6, v16, s[16:19], s38 offen
    s_add_u32 s38, s38, 196608
    buffer_load_dword v6, v15, s[12:15], s37 offen offset:256
    buffer_load_dword v6, v16, s[16:19], s38 offen
    s_add_u32 s38, s38, 196608
    buffer_load_dword v6, v15, s[12:15], s37 offen offset:384
    buffer_load_dword v6, v16, s[16:19], s38 offen
    s_add_u32 s38, s38, 196608
    buffer_load_dword v6, v15, s[12:15], s37 offen offset:512
    buffer_load_dword v6, v16, s[16:19], s38 offen
    s_add_u32 s38, s38, 196608
    buffer_load_dword v6, v15, s[12:15], s37 offen offset:640
    buffer_load_dword v6, v16, s[16:19], s38 offen
    s_add_u32 s38, s38, 196608
    buffer_load_dword v6, v15, s[12:15], s37 offen offset:768
    buffer_load_dword v6, v16, s[16:19], s38 offen
    s_add_u32 s38, s38, 196608
    buffer_load_dword v6, v15, s[12:15], s37 offen offset:896
    buffer_load_dword v6, v16, s[16:19], s38 offen
    s_add_u32 s38, s38, 196608
    s_add_u32 m0, s31, 0
    s_add_u32 s27, s35, 0
    s_and_b32 s27, s27, 7
    s_lshl_b32 s30, s27, 7
    buffer_load_dwordx4 v7, s[12:15], s30 offen offset:0 lds
    buffer_load_dwordx4 v8, s[12:15], s30 offen offset:1024 lds
    s_mul_i32 s30, s27, 196608
    s_add_u32 m0, s31, 8192
    s_nop 0
    buffer_load_dwordx4 v9, s[16:19], s30 offen offset:0 lds
    buffer_load_dwordx4 v10, s[16:19], s30 offen offset:1024 lds
    s_add_u32 m0, s31, 16384
    s_add_u32 s30, s30, 1024
    buffer_load_dwordx4 v9, s[16:19], s30 offen offset:0 lds
    buffer_load_dwordx4 v10, s[16:19], s30 offen offset:1024 lds
    s_add_u32 m0, s31, 24576
    s_add_u32 s30, s30, 1024
    buffer_load_dwordx4 v9, s[16:19], s30 offen offset:0 lds
    buffer_load_dwordx4 v10, s[16:19], s30 offen offset:1024 lds
    s_add_u32 m0, s31, 32768
    s_add_u32 s27, s35, 1
    s_and_b32 s27, s27, 7
    s_lshl_b32 s30, s27, 7
    buffer_load_dwordx4 v7, s[12:15], s30 offen offset:0 lds
    buffer_load_dwordx4 v8, s[12:15], s30 offen offset:1024 lds
    s_mul_i32 s30, s27, 196608
    s_add_u32 m0, s31, 40960
    s_nop 0
    buffer_load_dwordx4 v9, s[16:19], s30 offen offset:0 lds
    buffer_load_dwordx4 v10, s[16:19], s30 offen offset:1024 lds
    s_add_u32 m0, s31, 49152
    s_add_u32 s30, s30, 1024
    buffer_load_dwordx4 v9, s[16:19], s30 offen offset:0 lds
    buffer_load_dwordx4 v10, s[16:19], s30 offen offset:1024 lds
    s_add_u32 m0, s31, 57344
    s_add_u32 s30, s30, 1024
    buffer_load_dwordx4 v9, s[16:19], s30 offen offset:0 lds
    buffer_load_dwordx4 v10, s[16:19], s30 offen offset:1024 lds
    s_waitcnt vmcnt(8)
    s_barrier
    s_add_u32 m0, s31, 65536
    s_add_u32 s27, s35, 2
    s_and_b32 s27, s27, 7
    s_lshl_b32 s30, s27, 7
    buffer_load_dwordx4 v7, s[12:15], s30 offen offset:0 lds
    buffer_load_dwordx4 v8, s[12:15], s30 offen offset:1024 lds
    s_mul_i32 s30, s27, 196608
    s_add_u32 m0, s31, 73728
    s_nop 0
    buffer_load_dwordx4 v9, s[16:19], s30 offen offset:0 lds
    buffer_load_dwordx4 v10, s[16:19], s30 offen offset:1024 lds
    s_add_u32 m0, s31, 81920
    s_add_u32 s30, s30, 1024
    buffer_load_dwordx4 v9, s[16:19], s30 offen offset:0 lds
    buffer_load_dwordx4 v10, s[16:19], s30 offen offset:1024 lds
    s_add_u32 m0, s31, 90112
    s_add_u32 s30, s30, 1024
    buffer_load_dwordx4 v9, s[16:19], s30 offen offset:0 lds
    buffer_load_dwordx4 v10, s[16:19], s30 offen offset:1024 lds
    s_waitcnt vmcnt(8)
    s_barrier
    s_add_u32 m0, s31, 98304
    s_add_u32 s27, s35, 3
    s_and_b32 s27, s27, 7
    s_lshl_b32 s30, s27, 7
    buffer_load_dwordx4 v7, s[12:15], s30 offen offset:0 lds
    buffer_load_dwordx4 v8, s[12:15], s30 offen offset:1024 lds
    s_mul_i32 s30, s27, 196608
    s_add_u32 m0, s31, 106496
    s_nop 0
    buffer_load_dwordx4 v9, s[16:19], s30 offen offset:0 lds
    buffer_load_dwordx4 v10, s[16:19], s30 offen offset:1024 lds
    s_add_u32 m0, s31, 114688
    s_add_u32 s30, s30, 1024
    buffer_load_dwordx4 v9, s[16:19], s30 offen offset:0 lds
    buffer_load_dwordx4 v10, s[16:19], s30 offen offset:1024 lds
    s_add_u32 m0, s31, 122880
    s_add_u32 s30, s30, 1024
    buffer_load_dwordx4 v9, s[16:19], s30 offen offset:0 lds
    buffer_load_dwordx4 v10, s[16:19], s30 offen offset:1024 lds
    s_waitcnt vmcnt(8)
    s_barrier
    s_add_u32 m0, s31, 0
    s_add_u32 s27, s35, 4
    s_and_b32 s27, s27, 7
    s_lshl_b32 s30, s27, 7
    buffer_load_dwordx4 v7, s[12:15], s30 offen offset:0 lds
    buffer_load_dwordx4 v8, s[12:15], s30 offen offset:1024 lds
    s_mul_i32 s30, s27, 196608
    s_add_u32 m0, s31, 8192
    s_nop 0
    buffer_load_dwordx4 v9, s[16:19], s30 offen offset:0 lds
    buffer_load_dwordx4 v10, s[16:19], s30 offen offset:1024 lds
    s_add_u32 m0, s31, 16384
    s_add_u32 s30, s30, 1024
    buffer_load_dwordx4 v9, s[16:19], s30 offen offset:0 lds
    buffer_load_dwordx4 v10, s[16:19], s30 offen offset:1024 lds
    s_add_u32 m0, s31, 24576
    s_add_u32 s30, s30, 1024
    buffer_load_dwordx4 v9, s[16:19], s30 offen offset:0 lds
    buffer_load_dwordx4 v10, s[16:19], s30 offen offset:1024 lds
    s_waitcnt vmcnt(8)
    s_barrier
    s_add_u32 m0, s31, 32768
    s_add_u32 s27, s35, 5
    s_and_b32 s27, s27, 7
    s_lshl_b32 s30, s27, 7
    buffer_load_dwordx4 v7, s[12:15], s30 offen offset:0 lds
    buffer_load_dwordx4 v8, s[12:15], s30 offen offset:1024 lds
    s_mul_i32 s30, s27, 196608
    s_add_u32 m0, s31, 40960
    s_nop 0
    buffer_load_dwordx4 v9, s[16:19], s30 offen offset:0 lds
    buffer_load_dwordx4 v10, s[16:19], s30 offen offset:1024 lds
    s_add_u32 m0, s31, 49152
    s_add_u32 s30, s30, 1024
    buffer_load_dwordx4 v9, s[16:19], s30 offen offset:0 lds
    buffer_load_dwordx4 v10, s[16:19], s30 offen offset:1024 lds
    s_add_u32 m0, s31, 57344
    s_add_u32 s30, s30, 1024
    buffer_load_dwordx4 v9, s[16:19], s30 offen offset:0 lds
    buffer_load_dwordx4 v10, s[16:19], s30 offen offset:1024 lds
    s_waitcnt vmcnt(8)
    s_barrier
    s_add_u32 m0, s31, 65536
    s_add_u32 s27, s35, 6
    s_and_b32 s27, s27, 7
    s_lshl_b32 s30, s27, 7
    buffer_load_dwordx4 v7, s[12:15], s30 offen offset:0 lds
    buffer_load_dwordx4 v8, s[12:15], s30 offen offset:1024 lds
    s_mul_i32 s30, s27, 196608
    s_add_u32 m0, s31, 73728
    s_nop 0
    buffer_load_dwordx4 v9, s[16:19], s30 offen offset:0 lds
    buffer_load_dwordx4 v10, s[16:19], s30 offen offset:1024 lds
    s_add_u32 m0, s31, 81920
    s_add_u32 s30, s30, 1024
    buffer_load_dwordx4 v9, s[16:19], s30 offen offset:0 lds
    buffer_load_dwordx4 v10, s[16:19], s30 offen offset:1024 lds
    s_add_u32 m0, s31, 90112
    s_add_u32 s30, s30, 1024
    buffer_load_dwordx4 v9, s[16:19], s30 offen offset:0 lds
    buffer_load_dwordx4 v10, s[16:19], s30 offen offset:1024 lds
    s_waitcnt vmcnt(8)
    s_barrier
    s_add_u32 m0, s31, 98304
    s_add_u32 s27, s35, 7
    s_and_b32 s27, s27, 7
    s_lshl_b32 s30, s27, 7
    buffer_load_dwordx4 v7, s[12:15], s30 offen offset:0 lds
    buffer_load_dwordx4 v8, s[12:15], s30 offen offset:1024 lds
    s_mul_i32 s30, s27, 196608
    s_add_u32 m0, s31, 106496
    s_nop 0
    buffer_load_dwordx4 v9, s[16:19], s30 offen offset:0 lds
    buffer_load_dwordx4 v10, s[16:19], s30 offen offset:1024 lds
    s_add_u32 m0, s31, 114688
    s_add_u32 s30, s30, 1024
    buffer_load_dwordx4 v9, s[16:19], s30 offen offset:0 lds
    buffer_load_dwordx4 v10, s[16:19], s30 offen offset:1024 lds
    s_add_u32 m0, s31, 122880
    s_add_u32 s30, s30, 1024
    buffer_load_dwordx4 v9, s[16:19], s30 offen offset:0 lds
    buffer_load_dwordx4 v10, s[16:19], s30 offen offset:1024 lds
    s_waitcnt vmcnt(8)
    s_barrier
    buffer_store_dwordx4 v[116:119], v26, s[20:23], s39 offen sc1
    v_mov_b32 v120, -1
    v_mov_b32 v121, -1
    v_mov_b32 v122, -1
    v_mov_b32 v123, -1
    s_lshl_b32 s39, s2, 14
    s_lshl_b32 s40, s24, 12
    s_add_u32 s39, s39, s40
    s_add_u32 s39, s39, 0x600000
    buffer_store_dwordx4 v[120:123], v26, s[20:23], s39 offen offset:0 sc1
    buffer_store_dwordx4 v[120:123], v26, s[20:23], s39 offen offset:1024 sc1
    buffer_store_dwordx4 v[120:123], v26, s[20:23], s39 offen offset:2048 sc1
    buffer_store_dwordx4 v[120:123], v26, s[20:23], s39 offen offset:3072 sc1
    s_waitcnt vmcnt(5)
    s_barrier
    s_branch L_end_2
L_mm_1:
    s_cmp_lg_u32 s24, 0
    s_cbranch_scc1 L_nct_3
    v_lshlrev_b32 v4, 7, v1
    s_getpc_b64 s[44:45]
L_pc_4:
    s_sub_u32 s44, s44, L_pc_4-TEXT_START
    s_subb_u32 s45, s45, 0
    s_bfe_u32 s28, s2, 0x30003
    s_lshl_b32 s28, s28, 13
    v_add_u32 v36, s28, v4
    v_min_u32 v36, TEXT_END-TEXT_START-4, v36
    v_mov_b32 v37, s45
    v_add_co_u32 v36, vcc, s44, v36
    s_nop 1
    v_addc_co_u32 v37, vcc, 0, v37, vcc
    global_load_dword v244, v[36:37], off
L_nct_3:
    s_and_b32 s32, s24, 1
    s_lshr_b32 s33, s24, 1
    s_xor_b32 s34, s32, s33
    v_and_b32 v2, 31, v1
    v_lshrrev_b32 v3, 5, v1
    v_bfe_u32 v4, v2, 1, 3
    v_xor_b32 v4, v4, v3
    s_lshl_b32 s28, s34, 2
    v_xor_b32 v4, s28, v4
    v_lshlrev_b32 v24, 2, v2
    v_lshlrev_b32 v2, 7, v2
    s_lshl_b32 s28, s32, 12
    v_add_u32 v2, s28, v2
    v_xor_b32 v5, 0, v4
    v_lshl_add_u32 v7, v5, 4, v2
    v_add_u32 v11, 0x10000, v7
    v_xor_b32 v5, 2, v4
    v_lshl_add_u32 v8, v5, 4, v2
    v_add_u32 v12, 0x10000, v8
    v_xor_b32 v5, 4, v4
    v_lshl_add_u32 v9, v5, 4, v2
    v_add_u32 v13, 0x10000, v9
    v_xor_b32 v5, 6, v4
    v_lshl_add_u32 v10, v5, 4, v2
    v_add_u32 v14, 0x10000, v10
    v_lshlrev_b32 v25, 4, v3
    v_bfe_u32 v5, v1, 2, 2
    v_lshl_add_u32 v5, v3, 3, v5
    v_lshlrev_b32 v5, 7, v5
    v_bfe_u32 v3, v1, 3, 1
    v_xor_b32 v3, s33, v3
    v_lshl_add_u32 v5, v3, 6, v5
    v_bfe_u32 v3, v1, 4, 1
    v_lshl_add_u32 v5, v3, 5, v5
    v_and_b32 v3, 3, v1
    v_lshl_add_u32 v5, v3, 3, v5
    s_lshl_b32 s28, s34, 12
    s_add_u32 s28, s28, 8192
    v_add_u32 v15, s28, v5
    v_xor_b32 v16, 4096, v15
    v_add_u32 v17, 0x10000, v15
    v_add_u32 v18, 0x10000, v16
    v_and_b32 v2, 15, v1
    v_bfe_u32 v3, v1, 4, 1
    v_cmp_eq_u32 vcc, v2, v3
    v_mov_b32 v3, 0x3f803f80
    s_nop 0
    v_cndmask_b32 v32, 0, v3, vcc
    v_cndmask_b32 v33, 0, v3, vcc
    v_cndmask_b32 v34, 0, v3, vcc
    v_cndmask_b32 v35, 0, v3, vcc
    s_lshl_b32 s28, s24, 10
    s_add_u32 s29, s28, 147456
    v_add_u32 v23, s29, v24
    s_add_u32 s29, s28, 151552
    v_add_u32 v24, s29, v24
    v_add_u32 v25, s29, v25
    s_lshl_b32 s27, s25, 1
    s_add_u32 s27, s27, s32
    s_lshl_b32 s28, s26, 8
    s_add_u32 s28, s28, s27
    s_lshl_b32 s29, s33, 7
    s_add_u32 s28, s28, s29
    s_lshl_b32 s37, s28, 10
    s_add_u32 s38, s37, 65536
    s_lshl_b32 s39, s28, 11
    s_add_u32 s39, s39, 0x200000
    s_add_u32 s40, s39, 131072
    v_lshlrev_b32 v26, 4, v1
    v_and_b32 v27, 0x33, v1
    v_bfe_u32 v2, v1, 2, 1
    v_lshl_or_b32 v27, v2, 3, v27
    v_bfe_u32 v2, v1, 3, 1
    v_lshl_or_b32 v27, v2, 2, v27
    v_lshlrev_b32 v27, 4, v27
    v_and_b32 v28, 0x2f, v1
    v_lshlrev_b32 v28, 4, v28
    v_bfe_u32 v2, v1, 4, 1
    v_lshl_or_b32 v28, v2, 17, v28
    s_waitcnt lgkmcnt(0)
    s_mov_b32 s20, s8
    s_mov_b32 s21, s9
    s_mov_b32 s22, 0x1800000
    s_mov_b32 s23, 0x00020000
    s_lshl_b32 s28, s24, 12
    s_add_u32 s28, s28, 131072
    v_add_u32 v245, s28, v26
    v_and_b32 v2, 31, v1
    v_bfe_u32 v3, v1, 2, 1
    v_lshl_add_u32 v3, v3, 5, v2
    v_lshlrev_b32 v3, 4, v3
    v_bfe_u32 v4, v1, 3, 2
    v_lshl_add_u32 v3, v4, 10, v3
    v_and_b32 v4, 3, v1
    v_lshl_add_u32 v3, v4, 2, v3
    v_add_u32 v3, s28, v3
    v_xor_b32 v4, 8192, v3
    v_xor_b32 v5, 2048, v23
    v_xor_b32 v6, 1024, v23
    s_barrier
    ds_read_b128 v[116:119], v7 offset:0
    ds_read_b64_tr_b16 v[132:133], v15 offset:0
    ds_read_b64_tr_b16 v[134:135], v15 offset:512
    ds_read_b64_tr_b16 v[148:149], v15 offset:8192
    ds_read_b64_tr_b16 v[150:151], v15 offset:8704
    ds_read_b64_tr_b16 v[164:165], v15 offset:16384
    ds_read_b64_tr_b16 v[166:167], v15 offset:16896
    ds_read_b128 v[120:123], v8 offset:0
    ds_read_b64_tr_b16 v[136:137], v15 offset:2048
    ds_read_b64_tr_b16 v[138:139], v15 offset:2560
    ds_read_b64_tr_b16 v[152:153], v15 offset:10240
    ds_read_b64_tr_b16 v[154:155], v15 offset:10752
    ds_read_b64_tr_b16 v[168:169], v15 offset:18432
    ds_read_b64_tr_b16 v[170:171], v15 offset:18944
    s_waitcnt lgkmcnt(0)
    v_mfma_f32_32x32x16_bf16 v[36:51], v[132:135], v[116:119], 0
    ds_read_b128 v[124:127], v9 offset:0
    v_mfma_f32_16x16x32_bf16 v[84:87], v[32:35], v[132:135], 0
    ds_read_b64_tr_b16 v[140:141], v16 offset:0
    v_mfma_f32_32x32x16_bf16 v[52:67], v[148:151], v[116:119], 0
    ds_read_b64_tr_b16 v[142:143], v16 offset:512
    v_mfma_f32_16x16x32_bf16 v[88:91], v[32:35], v[148:151], 0
    ds_read_b64_tr_b16 v[156:157], v16 offset:8192
    v_mfma_f32_32x32x16_bf16 v[68:83], v[116:119], v[164:167], 0
    ds_read_b64_tr_b16 v[158:159], v16 offset:8704
    v_mfma_f32_16x16x32_bf16 v[92:95], v[32:35], v[164:167], 0
    ds_read_b64_tr_b16 v[172:173], v16 offset:16384
    v_mfma_f32_32x32x16_bf16 v[100:115], v[116:119], v[116:119], 0
    ds_read_b64_tr_b16 v[174:175], v16 offset:16896
    v_mfma_f32_16x16x32_bf16 v[96:99], v[32:35], v[116:119], 0
    ds_read_b128 v[128:131], v10 offset:0
    v_mfma_f32_32x32x16_bf16 v[36:51], v[136:139], v[120:123], v[36:51]
    ds_read_b64_tr_b16 v[144:145], v16 offset:2048
    v_mfma_f32_16x16x32_bf16 v[84:87], v[32:35], v[136:139], v[84:87]
    ds_read_b64_tr_b16 v[146:147], v16 offset:2560
    v_mfma_f32_32x32x16_bf16 v[52:67], v[152:155], v[120:123], v[52:67]
    ds_read_b64_tr_b16 v[160:161], v16 offset:10240
    v_mfma_f32_16x16x32_bf16 v[88:91], v[32:35], v[152:155], v[88:91]
    ds_read_b64_tr_b16 v[162:163], v16 offset:10752
    v_mfma_f32_32x32x16_bf16 v[68:83], v[120:123], v[168:171], v[68:83]
    ds_read_b64_tr_b16 v[176:177], v16 offset:18432
    v_mfma_f32_16x16x32_bf16 v[92:95], v[32:35], v[168:171], v[92:95]
    ds_read_b64_tr_b16 v[178:179], v16 offset:18944
    v_mfma_f32_32x32x16_bf16 v[100:115], v[120:123], v[120:123], v[100:115]
    v_mfma_f32_16x16x32_bf16 v[96:99], v[32:35], v[120:123], v[96:99]
    s_waitcnt lgkmcnt(0)
    s_barrier
    v_mfma_f32_32x32x16_bf16 v[36:51], v[140:143], v[124:127], v[36:51]
    ds_read_b128 v[180:183], v7 offset:32768
    ds_read_b64_tr_b16 v[196:197], v15 offset:32768
    ds_read_b64_tr_b16 v[198:199], v15 offset:33280
    v_mfma_f32_32x32x16_bf16 v[52:67], v[156:159], v[124:127], v[52:67]
    ds_read_b64_tr_b16 v[212:213], v15 offset:40960
    ds_read_b64_tr_b16 v[214:215], v15 offset:41472
    ds_read_b64_tr_b16 v[228:229], v15 offset:49152
    v_mfma_f32_32x32x16_bf16 v[68:83], v[124:127], v[172:175], v[68:83]
    ds_read_b64_tr_b16 v[230:231], v15 offset:49664
    ds_read_b128 v[184:187], v8 offset:32768
    ds_read_b64_tr_b16 v[200:201], v15 offset:34816
    v_mfma_f32_32x32x16_bf16 v[36:51], v[144:147], v[128:131], v[36:51]
    ds_read_b64_tr_b16 v[202:203], v15 offset:35328
    ds_read_b64_tr_b16 v[216:217], v15 offset:43008
    ds_read_b64_tr_b16 v[218:219], v15 offset:43520
    v_mfma_f32_32x32x16_bf16 v[52:67], v[160:163], v[128:131], v[52:67]
    ds_read_b64_tr_b16 v[232:233], v15 offset:51200
    ds_read_b64_tr_b16 v[234:235], v15 offset:51712
    v_mfma_f32_32x32x16_bf16 v[68:83], v[128:131], v[176:179], v[68:83]
    s_waitcnt lgkmcnt(0)
    v_mfma_f32_32x32x16_bf16 v[36:51], v[196:199], v[180:183], v[36:51]
    ds_read_b128 v[188:191], v9 offset:32768
    v_mfma_f32_16x16x32_bf16 v[84:87], v[32:35], v[196:199], v[84:87]
    ds_read_b64_tr_b16 v[204:205], v16 offset:32768
    v_mfma_f32_32x32x16_bf16 v[52:67], v[212:215], v[180:183], v[52:67]
    ds_read_b64_tr_b16 v[206:207], v16 offset:33280
    v_mfma_f32_16x16x32_bf16 v[88:91], v[32:35], v[212:215], v[88:91]
    ds_read_b64_tr_b16 v[220:221], v16 offset:40960
    v_mfma_f32_32x32x16_bf16 v[68:83], v[180:183], v[228:231], v[68:83]
    ds_read_b64_tr_b16 v[222:223], v16 offset:41472
    v_mfma_f32_16x16x32_bf16 v[92:95], v[32:35], v[228:231], v[92:95]
    ds_read_b64_tr_b16 v[236:237], v16 offset:49152
    v_mfma_f32_32x32x16_bf16 v[100:115], v[180:183], v[180:183], v[100:115]
    ds_read_b64_tr_b16 v[238:239], v16 offset:49664
    v_mfma_f32_16x16x32_bf16 v[96:99], v[32:35], v[180:183], v[96:99]
    ds_read_b128 v[192:195], v10 offset:32768
    v_mfma_f32_32x32x16_bf16 v[36:51], v[200:203], v[184:187], v[36:51]
    ds_read_b64_tr_b16 v[208:209], v16 offset:34816
    v_mfma_f32_16x16x32_bf16 v[84:87], v[32:35], v[200:203], v[84:87]
    ds_read_b64_tr_b16 v[210:211], v16 offset:35328
    v_mfma_f32_32x32x16_bf16 v[52:67], v[216:219], v[184:187], v[52:67]
    ds_read_b64_tr_b16 v[224:225], v16 offset:43008
    v_mfma_f32_16x16x32_bf16 v[88:91], v[32:35], v[216:219], v[88:91]
    ds_read_b64_tr_b16 v[226:227], v16 offset:43520
    v_mfma_f32_32x32x16_bf16 v[68:83], v[184:187], v[232:235], v[68:83]
    ds_read_b64_tr_b16 v[240:241], v16 offset:51200
    v_mfma_f32_16x16x32_bf16 v[92:95], v[32:35], v[232:235], v[92:95]
    ds_read_b64_tr_b16 v[242:243], v16 offset:51712
    v_mfma_f32_32x32x16_bf16 v[100:115], v[184:187], v[184:187], v[100:115]
    v_mfma_f32_16x16x32_bf16 v[96:99], v[32:35], v[184:187], v[96:99]
    s_waitcnt lgkmcnt(0)
    s_barrier
    v_mfma_f32_32x32x16_bf16 v[36:51], v[204:207], v[188:191], v[36:51]
    ds_read_b128 v[116:119], v11 offset:0
    ds_read_b64_tr_b16 v[132:133], v17 offset:0
    ds_read_b64_tr_b16 v[134:135], v17 offset:512
    v_mfma_f32_32x32x16_bf16 v[52:67], v[220:223], v[188:191], v[52:67]
    ds_read_b64_tr_b16 v[148:149], v17 offset:8192
    ds_read_b64_tr_b16 v[150:151], v17 offset:8704
    ds_read_b64_tr_b16 v[164:165], v17 offset:16384
    v_mfma_f32_32x32x16_bf16 v[68:83], v[188:191], v[236:239], v[68:83]
    ds_read_b64_tr_b16 v[166:167], v17 offset:16896
    ds_read_b128 v[120:123], v12 offset:0
    ds_read_b64_tr_b16 v[136:137], v17 offset:2048
    v_mfma_f32_32x32x16_bf16 v[36:51], v[208:211], v[192:195], v[36:51]
    ds_read_b64_tr_b16 v[138:139], v17 offset:2560
    ds_read_b64_tr_b16 v[152:153], v17 offset:10240
    ds_read_b64_tr_b16 v[154:155], v17 offset:10752
    v_mfma_f32_32x32x16_bf16 v[52:67], v[224:227], v[192:195], v[52:67]
    ds_read_b64_tr_b16 v[168:169], v17 offset:18432
    ds_read_b64_tr_b16 v[170:171], v17 offset:18944
    v_mfma_f32_32x32x16_bf16 v[68:83], v[192:195], v[240:243], v[68:83]
    s_waitcnt lgkmcnt(0)
    v_mfma_f32_32x32x16_bf16 v[36:51], v[132:135], v[116:119], v[36:51]
    ds_read_b128 v[124:127], v13 offset:0
    v_mfma_f32_16x16x32_bf16 v[84:87], v[32:35], v[132:135], v[84:87]
    ds_read_b64_tr_b16 v[140:141], v18 offset:0
    v_mfma_f32_32x32x16_bf16 v[52:67], v[148:151], v[116:119], v[52:67]
    ds_read_b64_tr_b16 v[142:143], v18 offset:512
    v_mfma_f32_16x16x32_bf16 v[88:91], v[32:35], v[148:151], v[88:91]
    ds_read_b64_tr_b16 v[156:157], v18 offset:8192
    v_mfma_f32_32x32x16_bf16 v[68:83], v[116:119], v[164:167], v[68:83]
    ds_read_b64_tr_b16 v[158:159], v18 offset:8704
    v_mfma_f32_16x16x32_bf16 v[92:95], v[32:35], v[164:167], v[92:95]
    ds_read_b64_tr_b16 v[172:173], v18 offset:16384
    v_mfma_f32_32x32x16_bf16 v[100:115], v[116:119], v[116:119], v[100:115]
    ds_read_b64_tr_b16 v[174:175], v18 offset:16896
    v_mfma_f32_16x16x32_bf16 v[96:99], v[32:35], v[116:119], v[96:99]
    ds_read_b128 v[128:131], v14 offset:0
    v_mfma_f32_32x32x16_bf16 v[36:51], v[136:139], v[120:123], v[36:51]
    ds_read_b64_tr_b16 v[144:145], v18 offset:2048
    v_mfma_f32_16x16x32_bf16 v[84:87], v[32:35], v[136:139], v[84:87]
    ds_read_b64_tr_b16 v[146:147], v18 offset:2560
    v_mfma_f32_32x32x16_bf16 v[52:67], v[152:155], v[120:123], v[52:67]
    ds_read_b64_tr_b16 v[160:161], v18 offset:10240
    v_mfma_f32_16x16x32_bf16 v[88:91], v[32:35], v[152:155], v[88:91]
    ds_read_b64_tr_b16 v[162:163], v18 offset:10752
    v_mfma_f32_32x32x16_bf16 v[68:83], v[120:123], v[168:171], v[68:83]
    ds_read_b64_tr_b16 v[176:177], v18 offset:18432
    v_mfma_f32_16x16x32_bf16 v[92:95], v[32:35], v[168:171], v[92:95]
    ds_read_b64_tr_b16 v[178:179], v18 offset:18944
    v_mfma_f32_32x32x16_bf16 v[100:115], v[120:123], v[120:123], v[100:115]
    v_mfma_f32_16x16x32_bf16 v[96:99], v[32:35], v[120:123], v[96:99]
    s_waitcnt lgkmcnt(0)
    s_barrier
    v_mfma_f32_32x32x16_bf16 v[36:51], v[140:143], v[124:127], v[36:51]
    ds_read_b128 v[180:183], v11 offset:32768
    ds_read_b64_tr_b16 v[196:197], v17 offset:32768
    ds_read_b64_tr_b16 v[198:199], v17 offset:33280
    v_mfma_f32_32x32x16_bf16 v[52:67], v[156:159], v[124:127], v[52:67]
    ds_read_b64_tr_b16 v[212:213], v17 offset:40960
    ds_read_b64_tr_b16 v[214:215], v17 offset:41472
    ds_read_b64_tr_b16 v[228:229], v17 offset:49152
    v_mfma_f32_32x32x16_bf16 v[68:83], v[124:127], v[172:175], v[68:83]
    ds_read_b64_tr_b16 v[230:231], v17 offset:49664
    ds_read_b128 v[184:187], v12 offset:32768
    ds_read_b64_tr_b16 v[200:201], v17 offset:34816
    v_mfma_f32_32x32x16_bf16 v[36:51], v[144:147], v[128:131], v[36:51]
    ds_read_b64_tr_b16 v[202:203], v17 offset:35328
    ds_read_b64_tr_b16 v[216:217], v17 offset:43008
    ds_read_b64_tr_b16 v[218:219], v17 offset:43520
    v_mfma_f32_32x32x16_bf16 v[52:67], v[160:163], v[128:131], v[52:67]
    ds_read_b64_tr_b16 v[232:233], v17 offset:51200
    ds_read_b64_tr_b16 v[234:235], v17 offset:51712
    v_mfma_f32_32x32x16_bf16 v[68:83], v[128:131], v[176:179], v[68:83]
    s_waitcnt lgkmcnt(0)
    v_mfma_f32_32x32x16_bf16 v[36:51], v[196:199], v[180:183], v[36:51]
    ds_read_b128 v[188:191], v13 offset:32768
    v_mfma_f32_16x16x32_bf16 v[84:87], v[32:35], v[196:199], v[84:87]
    ds_read_b64_tr_b16 v[204:205], v18 offset:32768
    v_mfma_f32_32x32x16_bf16 v[52:67], v[212:215], v[180:183], v[52:67]
    ds_read_b64_tr_b16 v[206:207], v18 offset:33280
    v_mfma_f32_16x16x32_bf16 v[88:91], v[32:35], v[212:215], v[88:91]
    ds_read_b64_tr_b16 v[220:221], v18 offset:40960
    v_mfma_f32_32x32x16_bf16 v[68:83], v[180:183], v[228:231], v[68:83]
    ds_read_b64_tr_b16 v[222:223], v18 offset:41472
    v_mfma_f32_16x16x32_bf16 v[92:95], v[32:35], v[228:231], v[92:95]
    ds_read_b64_tr_b16 v[236:237], v18 offset:49152
    v_mfma_f32_32x32x16_bf16 v[100:115], v[180:183], v[180:183], v[100:115]
    ds_read_b64_tr_b16 v[238:239], v18 offset:49664
    v_mfma_f32_16x16x32_bf16 v[96:99], v[32:35], v[180:183], v[96:99]
    ds_read_b128 v[192:195], v14 offset:32768
    v_mfma_f32_32x32x16_bf16 v[36:51], v[200:203], v[184:187], v[36:51]
    ds_read_b64_tr_b16 v[208:209], v18 offset:34816
    v_mfma_f32_16x16x32_bf16 v[84:87], v[32:35], v[200:203], v[84:87]
    ds_read_b64_tr_b16 v[210:211], v18 offset:35328
    v_mfma_f32_32x32x16_bf16 v[52:67], v[216:219], v[184:187], v[52:67]
    ds_read_b64_tr_b16 v[224:225], v18 offset:43008
    v_mfma_f32_16x16x32_bf16 v[88:91], v[32:35], v[216:219], v[88:91]
    ds_read_b64_tr_b16 v[226:227], v18 offset:43520
    v_mfma_f32_32x32x16_bf16 v[68:83], v[184:187], v[232:235], v[68:83]
    ds_read_b64_tr_b16 v[240:241], v18 offset:51200
    v_mfma_f32_16x16x32_bf16 v[92:95], v[32:35], v[232:235], v[92:95]
    ds_read_b64_tr_b16 v[242:243], v18 offset:51712
    v_mfma_f32_32x32x16_bf16 v[100:115], v[184:187], v[184:187], v[100:115]
    v_mfma_f32_16x16x32_bf16 v[96:99], v[32:35], v[184:187], v[96:99]
    s_waitcnt lgkmcnt(0)
    s_barrier
    v_mfma_f32_32x32x16_bf16 v[36:51], v[204:207], v[188:191], v[36:51]
    ds_read_b128 v[116:119], v7 offset:0
    ds_read_b64_tr_b16 v[132:133], v15 offset:0
    ds_read_b64_tr_b16 v[134:135], v15 offset:512
    v_mfma_f32_32x32x16_bf16 v[52:67], v[220:223], v[188:191], v[52:67]
    ds_read_b64_tr_b16 v[148:149], v15 offset:8192
    ds_read_b64_tr_b16 v[150:151], v15 offset:8704
    ds_read_b64_tr_b16 v[164:165], v15 offset:16384
    v_mfma_f32_32x32x16_bf16 v[68:83], v[188:191], v[236:239], v[68:83]
    ds_read_b64_tr_b16 v[166:167], v15 offset:16896
    ds_read_b128 v[120:123], v8 offset:0
    ds_read_b64_tr_b16 v[136:137], v15 offset:2048
    v_mfma_f32_32x32x16_bf16 v[36:51], v[208:211], v[192:195], v[36:51]
    ds_read_b64_tr_b16 v[138:139], v15 offset:2560
    ds_read_b64_tr_b16 v[152:153], v15 offset:10240
    ds_read_b64_tr_b16 v[154:155], v15 offset:10752
    v_mfma_f32_32x32x16_bf16 v[52:67], v[224:227], v[192:195], v[52:67]
    ds_read_b64_tr_b16 v[168:169], v15 offset:18432
    ds_read_b64_tr_b16 v[170:171], v15 offset:18944
    v_mfma_f32_32x32x16_bf16 v[68:83], v[192:195], v[240:243], v[68:83]
    s_waitcnt lgkmcnt(0)
    v_mfma_f32_32x32x16_bf16 v[36:51], v[132:135], v[116:119], v[36:51]
    ds_read_b128 v[124:127], v9 offset:0
    v_mfma_f32_16x16x32_bf16 v[84:87], v[32:35], v[132:135], v[84:87]
    ds_read_b64_tr_b16 v[140:141], v16 offset:0
    v_mfma_f32_32x32x16_bf16 v[52:67], v[148:151], v[116:119], v[52:67]
    ds_read_b64_tr_b16 v[142:143], v16 offset:512
    v_mfma_f32_16x16x32_bf16 v[88:91], v[32:35], v[148:151], v[88:91]
    ds_read_b64_tr_b16 v[156:157], v16 offset:8192
    v_mfma_f32_32x32x16_bf16 v[68:83], v[116:119], v[164:167], v[68:83]
    ds_read_b64_tr_b16 v[158:159], v16 offset:8704
    v_mfma_f32_16x16x32_bf16 v[92:95], v[32:35], v[164:167], v[92:95]
    ds_read_b64_tr_b16 v[172:173], v16 offset:16384
    v_mfma_f32_32x32x16_bf16 v[100:115], v[116:119], v[116:119], v[100:115]
    ds_read_b64_tr_b16 v[174:175], v16 offset:16896
    v_mfma_f32_16x16x32_bf16 v[96:99], v[32:35], v[116:119], v[96:99]
    ds_read_b128 v[128:131], v10 offset:0
    v_mfma_f32_32x32x16_bf16 v[36:51], v[136:139], v[120:123], v[36:51]
    ds_read_b64_tr_b16 v[144:145], v16 offset:2048
    v_mfma_f32_16x16x32_bf16 v[84:87], v[32:35], v[136:139], v[84:87]
    ds_read_b64_tr_b16 v[146:147], v16 offset:2560
    v_mfma_f32_32x32x16_bf16 v[52:67], v[152:155], v[120:123], v[52:67]
    ds_read_b64_tr_b16 v[160:161], v16 offset:10240
    v_mfma_f32_16x16x32_bf16 v[88:91], v[32:35], v[152:155], v[88:91]
    ds_read_b64_tr_b16 v[162:163], v16 offset:10752
    v_mfma_f32_32x32x16_bf16 v[68:83], v[120:123], v[168:171], v[68:83]
    ds_read_b64_tr_b16 v[176:177], v16 offset:18432
    v_mfma_f32_16x16x32_bf16 v[92:95], v[32:35], v[168:171], v[92:95]
    ds_read_b64_tr_b16 v[178:179], v16 offset:18944
    v_mfma_f32_32x32x16_bf16 v[100:115], v[120:123], v[120:123], v[100:115]
    v_mfma_f32_16x16x32_bf16 v[96:99], v[32:35], v[120:123], v[96:99]
    s_waitcnt lgkmcnt(0)
    s_barrier
    v_mfma_f32_32x32x16_bf16 v[36:51], v[140:143], v[124:127], v[36:51]
    ds_read_b128 v[180:183], v7 offset:32768
    ds_read_b64_tr_b16 v[196:197], v15 offset:32768
    ds_read_b64_tr_b16 v[198:199], v15 offset:33280
    v_mfma_f32_32x32x16_bf16 v[52:67], v[156:159], v[124:127], v[52:67]
    ds_read_b64_tr_b16 v[212:213], v15 offset:40960
    ds_read_b64_tr_b16 v[214:215], v15 offset:41472
    ds_read_b64_tr_b16 v[228:229], v15 offset:49152
    v_mfma_f32_32x32x16_bf16 v[68:83], v[124:127], v[172:175], v[68:83]
    ds_read_b64_tr_b16 v[230:231], v15 offset:49664
    ds_read_b128 v[184:187], v8 offset:32768
    ds_read_b64_tr_b16 v[200:201], v15 offset:34816
    v_mfma_f32_32x32x16_bf16 v[36:51], v[144:147], v[128:131], v[36:51]
    ds_read_b64_tr_b16 v[202:203], v15 offset:35328
    ds_read_b64_tr_b16 v[216:217], v15 offset:43008
    ds_read_b64_tr_b16 v[218:219], v15 offset:43520
    v_mfma_f32_32x32x16_bf16 v[52:67], v[160:163], v[128:131], v[52:67]
    ds_read_b64_tr_b16 v[232:233], v15 offset:51200
    ds_read_b64_tr_b16 v[234:235], v15 offset:51712
    v_mfma_f32_32x32x16_bf16 v[68:83], v[128:131], v[176:179], v[68:83]
    s_waitcnt lgkmcnt(0)
    v_mfma_f32_32x32x16_bf16 v[36:51], v[196:199], v[180:183], v[36:51]
    ds_read_b128 v[188:191], v9 offset:32768
    v_mfma_f32_16x16x32_bf16 v[84:87], v[32:35], v[196:199], v[84:87]
    ds_read_b64_tr_b16 v[204:205], v16 offset:32768
    v_mfma_f32_32x32x16_bf16 v[52:67], v[212:215], v[180:183], v[52:67]
    ds_read_b64_tr_b16 v[206:207], v16 offset:33280
    v_mfma_f32_16x16x32_bf16 v[88:91], v[32:35], v[212:215], v[88:91]
    ds_read_b64_tr_b16 v[220:221], v16 offset:40960
    v_mfma_f32_32x32x16_bf16 v[68:83], v[180:183], v[228:231], v[68:83]
    ds_read_b64_tr_b16 v[222:223], v16 offset:41472
    v_mfma_f32_16x16x32_bf16 v[92:95], v[32:35], v[228:231], v[92:95]
    ds_read_b64_tr_b16 v[236:237], v16 offset:49152
    v_mfma_f32_32x32x16_bf16 v[100:115], v[180:183], v[180:183], v[100:115]
    ds_read_b64_tr_b16 v[238:239], v16 offset:49664
    v_mfma_f32_16x16x32_bf16 v[96:99], v[32:35], v[180:183], v[96:99]
    ds_read_b128 v[192:195], v10 offset:32768
    v_mfma_f32_32x32x16_bf16 v[36:51], v[200:203], v[184:187], v[36:51]
    ds_read_b64_tr_b16 v[208:209], v16 offset:34816
    v_mfma_f32_16x16x32_bf16 v[84:87], v[32:35], v[200:203], v[84:87]
    ds_read_b64_tr_b16 v[210:211], v16 offset:35328
    v_mfma_f32_32x32x16_bf16 v[52:67], v[216:219], v[184:187], v[52:67]
    ds_read_b64_tr_b16 v[224:225], v16 offset:43008
    v_mfma_f32_16x16x32_bf16 v[88:91], v[32:35], v[216:219], v[88:91]
    ds_read_b64_tr_b16 v[226:227], v16 offset:43520
    v_mfma_f32_32x32x16_bf16 v[68:83], v[184:187], v[232:235], v[68:83]
    ds_read_b64_tr_b16 v[240:241], v16 offset:51200
    v_mfma_f32_16x16x32_bf16 v[92:95], v[32:35], v[232:235], v[92:95]
    ds_read_b64_tr_b16 v[242:243], v16 offset:51712
    v_mfma_f32_32x32x16_bf16 v[100:115], v[184:187], v[184:187], v[100:115]
    v_mfma_f32_16x16x32_bf16 v[96:99], v[32:35], v[184:187], v[96:99]
    s_waitcnt lgkmcnt(0)
    s_barrier
    v_mfma_f32_32x32x16_bf16 v[36:51], v[204:207], v[188:191], v[36:51]
    ds_read_b128 v[116:119], v11 offset:0
    ds_read_b64_tr_b16 v[132:133], v17 offset:0
    ds_read_b64_tr_b16 v[134:135], v17 offset:512
    v_mfma_f32_32x32x16_bf16 v[52:67], v[220:223], v[188:191], v[52:67]
    ds_read_b64_tr_b16 v[148:149], v17 offset:8192
    ds_read_b64_tr_b16 v[150:151], v17 offset:8704
    ds_read_b64_tr_b16 v[164:165], v17 offset:16384
    v_mfma_f32_32x32x16_bf16 v[68:83], v[188:191], v[236:239], v[68:83]
    ds_read_b64_tr_b16 v[166:167], v17 offset:16896
    ds_read_b128 v[120:123], v12 offset:0
    ds_read_b64_tr_b16 v[136:137], v17 offset:2048
    v_mfma_f32_32x32x16_bf16 v[36:51], v[208:211], v[192:195], v[36:51]
    ds_read_b64_tr_b16 v[138:139], v17 offset:2560
    ds_read_b64_tr_b16 v[152:153], v17 offset:10240
    ds_read_b64_tr_b16 v[154:155], v17 offset:10752
    v_mfma_f32_32x32x16_bf16 v[52:67], v[224:227], v[192:195], v[52:67]
    ds_read_b64_tr_b16 v[168:169], v17 offset:18432
    ds_read_b64_tr_b16 v[170:171], v17 offset:18944
    v_mfma_f32_32x32x16_bf16 v[68:83], v[192:195], v[240:243], v[68:83]
    s_waitcnt lgkmcnt(0)
    v_mfma_f32_32x32x16_bf16 v[36:51], v[132:135], v[116:119], v[36:51]
    ds_read_b128 v[124:127], v13 offset:0
    v_mfma_f32_16x16x32_bf16 v[84:87], v[32:35], v[132:135], v[84:87]
    ds_read_b64_tr_b16 v[140:141], v18 offset:0
    v_mfma_f32_32x32x16_bf16 v[52:67], v[148:151], v[116:119], v[52:67]
    ds_read_b64_tr_b16 v[142:143], v18 offset:512
    v_mfma_f32_16x16x32_bf16 v[88:91], v[32:35], v[148:151], v[88:91]
    ds_read_b64_tr_b16 v[156:157], v18 offset:8192
    v_mfma_f32_32x32x16_bf16 v[68:83], v[116:119], v[164:167], v[68:83]
    ds_read_b64_tr_b16 v[158:159], v18 offset:8704
    v_mfma_f32_16x16x32_bf16 v[92:95], v[32:35], v[164:167], v[92:95]
    ds_read_b64_tr_b16 v[172:173], v18 offset:16384
    v_mfma_f32_32x32x16_bf16 v[100:115], v[116:119], v[116:119], v[100:115]
    ds_read_b64_tr_b16 v[174:175], v18 offset:16896
    v_mfma_f32_16x16x32_bf16 v[96:99], v[32:35], v[116:119], v[96:99]
    ds_read_b128 v[128:131], v14 offset:0
    v_mfma_f32_32x32x16_bf16 v[36:51], v[136:139], v[120:123], v[36:51]
    ds_read_b64_tr_b16 v[144:145], v18 offset:2048
    v_mfma_f32_16x16x32_bf16 v[84:87], v[32:35], v[136:139], v[84:87]
    ds_read_b64_tr_b16 v[146:147], v18 offset:2560
    v_mfma_f32_32x32x16_bf16 v[52:67], v[152:155], v[120:123], v[52:67]
    ds_read_b64_tr_b16 v[160:161], v18 offset:10240
    v_mfma_f32_16x16x32_bf16 v[88:91], v[32:35], v[152:155], v[88:91]
    ds_read_b64_tr_b16 v[162:163], v18 offset:10752
    v_mfma_f32_32x32x16_bf16 v[68:83], v[120:123], v[168:171], v[68:83]
    ds_read_b64_tr_b16 v[176:177], v18 offset:18432
    v_mfma_f32_16x16x32_bf16 v[92:95], v[32:35], v[168:171], v[92:95]
    ds_read_b64_tr_b16 v[178:179], v18 offset:18944
    v_mfma_f32_32x32x16_bf16 v[100:115], v[120:123], v[120:123], v[100:115]
    v_mfma_f32_16x16x32_bf16 v[96:99], v[32:35], v[120:123], v[96:99]
    s_waitcnt lgkmcnt(0)
    s_barrier
    v_mfma_f32_32x32x16_bf16 v[36:51], v[140:143], v[124:127], v[36:51]
    ds_read_b128 v[180:183], v11 offset:32768
    ds_read_b64_tr_b16 v[196:197], v17 offset:32768
    ds_read_b64_tr_b16 v[198:199], v17 offset:33280
    v_mfma_f32_32x32x16_bf16 v[52:67], v[156:159], v[124:127], v[52:67]
    ds_read_b64_tr_b16 v[212:213], v17 offset:40960
    ds_read_b64_tr_b16 v[214:215], v17 offset:41472
    ds_read_b64_tr_b16 v[228:229], v17 offset:49152
    v_mfma_f32_32x32x16_bf16 v[68:83], v[124:127], v[172:175], v[68:83]
    ds_read_b64_tr_b16 v[230:231], v17 offset:49664
    ds_read_b128 v[184:187], v12 offset:32768
    ds_read_b64_tr_b16 v[200:201], v17 offset:34816
    v_mfma_f32_32x32x16_bf16 v[36:51], v[144:147], v[128:131], v[36:51]
    ds_read_b64_tr_b16 v[202:203], v17 offset:35328
    ds_read_b64_tr_b16 v[216:217], v17 offset:43008
    ds_read_b64_tr_b16 v[218:219], v17 offset:43520
    v_mfma_f32_32x32x16_bf16 v[52:67], v[160:163], v[128:131], v[52:67]
    ds_read_b64_tr_b16 v[232:233], v17 offset:51200
    ds_read_b64_tr_b16 v[234:235], v17 offset:51712
    v_mfma_f32_32x32x16_bf16 v[68:83], v[128:131], v[176:179], v[68:83]
    s_waitcnt lgkmcnt(0)
    v_mfma_f32_32x32x16_bf16 v[36:51], v[196:199], v[180:183], v[36:51]
    ds_read_b128 v[188:191], v13 offset:32768
    v_mfma_f32_16x16x32_bf16 v[84:87], v[32:35], v[196:199], v[84:87]
    ds_read_b64_tr_b16 v[204:205], v18 offset:32768
    v_mfma_f32_32x32x16_bf16 v[52:67], v[212:215], v[180:183], v[52:67]
    ds_read_b64_tr_b16 v[206:207], v18 offset:33280
    v_mfma_f32_16x16x32_bf16 v[88:91], v[32:35], v[212:215], v[88:91]
    ds_read_b64_tr_b16 v[220:221], v18 offset:40960
    v_mfma_f32_32x32x16_bf16 v[68:83], v[180:183], v[228:231], v[68:83]
    ds_read_b64_tr_b16 v[222:223], v18 offset:41472
    v_mfma_f32_16x16x32_bf16 v[92:95], v[32:35], v[228:231], v[92:95]
    ds_read_b64_tr_b16 v[236:237], v18 offset:49152
    v_mfma_f32_32x32x16_bf16 v[100:115], v[180:183], v[180:183], v[100:115]
    ds_read_b64_tr_b16 v[238:239], v18 offset:49664
    v_mfma_f32_16x16x32_bf16 v[96:99], v[32:35], v[180:183], v[96:99]
    ds_read_b128 v[192:195], v14 offset:32768
    v_mfma_f32_32x32x16_bf16 v[36:51], v[200:203], v[184:187], v[36:51]
    ds_read_b64_tr_b16 v[208:209], v18 offset:34816
    v_mfma_f32_16x16x32_bf16 v[84:87], v[32:35], v[200:203], v[84:87]
    ds_read_b64_tr_b16 v[210:211], v18 offset:35328
    v_mfma_f32_32x32x16_bf16 v[52:67], v[216:219], v[184:187], v[52:67]
    ds_read_b64_tr_b16 v[224:225], v18 offset:43008
    v_mfma_f32_16x16x32_bf16 v[88:91], v[32:35], v[216:219], v[88:91]
    ds_read_b64_tr_b16 v[226:227], v18 offset:43520
    v_mfma_f32_32x32x16_bf16 v[68:83], v[184:187], v[232:235], v[68:83]
    ds_read_b64_tr_b16 v[240:241], v18 offset:51200
    v_mfma_f32_16x16x32_bf16 v[92:95], v[32:35], v[232:235], v[92:95]
    ds_read_b64_tr_b16 v[242:243], v18 offset:51712
    v_mfma_f32_32x32x16_bf16 v[100:115], v[184:187], v[184:187], v[100:115]
    v_mfma_f32_16x16x32_bf16 v[96:99], v[32:35], v[184:187], v[96:99]
    s_waitcnt lgkmcnt(0)
    v_mfma_f32_32x32x16_bf16 v[36:51], v[204:207], v[188:191], v[36:51]
    v_mfma_f32_32x32x16_bf16 v[52:67], v[220:223], v[188:191], v[52:67]
    s_nop 8
    ds_write_b128 v245, v[100:103] offset:0
    ds_write_b128 v245, v[104:107] offset:1024
    ds_write_b128 v245, v[108:111] offset:2048
    ds_write_b128 v245, v[112:115] offset:3072
    v_mfma_f32_32x32x16_bf16 v[68:83], v[188:191], v[236:239], v[68:83]
    s_mov_b64 exec, 0xffff
    ds_write_b32 v23, v84 offset:0
    ds_write_b32 v23, v85 offset:64
    ds_write_b32 v23, v88 offset:128
    ds_write_b32 v23, v89 offset:192
    ds_write_b32 v23, v92 offset:256
    ds_write_b32 v23, v93 offset:320
    ds_write_b32 v23, v96 offset:384
    ds_write_b32 v23, v97 offset:448
    s_mov_b64 exec, -1
    v_mfma_f32_32x32x16_bf16 v[36:51], v[208:211], v[192:195], v[36:51]
    s_waitcnt lgkmcnt(0)
    s_barrier
    v_mfma_f32_32x32x16_bf16 v[52:67], v[224:227], v[192:195], v[52:67]
    v_mfma_f32_32x32x16_bf16 v[68:83], v[192:195], v[240:243], v[68:83]
    ds_read_b32 v20, v3
    ds_read_b32 v164, v4
    ds_read_b32 v19, v23 offset:384
    ds_read_b32 v165, v5 offset:384
    s_lshl_b32 s28, s24, 10
    s_add_u32 s28, s28, -4096
    v_add_u32 v2, 4294963200, v25
    v_xor_b32 v4, 1024, v2
    ds_read_b32 v21, v23 offset:256
    ds_read_b32 v166, v6 offset:256
    ds_read_b128 v[116:119], v2 offset:0
    ds_read_b128 v[120:123], v2 offset:32
    ds_read_b128 v[124:127], v2 offset:64
    ds_read_b128 v[128:131], v2 offset:96
    ds_read_b128 v[100:103], v4 offset:0
    ds_read_b128 v[104:107], v4 offset:32
    ds_read_b128 v[108:111], v4 offset:64
    ds_read_b128 v[112:115], v4 offset:96
    s_waitcnt lgkmcnt(8)
    v_add_f32 v19, v19, v165
    v_add_f32 v20, v20, v164
    v_add_f32 v21, v21, v166
    v_mul_f32 v19, 0x3b000000, v19
    v_mul_f32 v20, 0x3b000000, v20
    v_fma_f32 v20, -v19, v19, v20
    v_max_f32 v20, 0, v20
    v_add_f32 v20, 0x3727c5ac, v20
    v_rsq_f32 v20, v20
    ds_write_b32 v24, v19
    v_mul_f32 v22, 0x3eb8aa3b, v20
    ds_write_b32 v24, v20 offset:128
    ds_read_b128 v[132:135], v2 offset:128
    ds_read_b128 v[136:139], v2 offset:160
    ds_read_b128 v[140:143], v2 offset:192
    ds_read_b128 v[144:147], v2 offset:224
    s_waitcnt lgkmcnt(6)
    ds_read_b128 v[148:151], v4 offset:128
    ds_read_b128 v[152:155], v4 offset:160
    ds_read_b128 v[156:159], v4 offset:192
    ds_read_b128 v[160:163], v4 offset:224
    v_pk_add_f32 v[116:117], v[116:117], v[100:101] op_sel:[0,0] op_sel_hi:[1,1]
    v_pk_add_f32 v[118:119], v[118:119], v[102:103] op_sel:[0,0] op_sel_hi:[1,1]
    v_pk_add_f32 v[120:121], v[120:121], v[104:105] op_sel:[0,0] op_sel_hi:[1,1]
    v_pk_add_f32 v[122:123], v[122:123], v[106:107] op_sel:[0,0] op_sel_hi:[1,1]
    v_pk_fma_f32 v[36:37], v[18:19], v[116:117], v[36:37] op_sel:[1,0,0] op_sel_hi:[1,1,1] neg_lo:[1,0,0] neg_hi:[1,0,0]
    v_pk_fma_f32 v[38:39], v[18:19], v[118:119], v[38:39] op_sel:[1,0,0] op_sel_hi:[1,1,1] neg_lo:[1,0,0] neg_hi:[1,0,0]
    v_pk_fma_f32 v[40:41], v[18:19], v[120:121], v[40:41] op_sel:[1,0,0] op_sel_hi:[1,1,1] neg_lo:[1,0,0] neg_hi:[1,0,0]
    v_pk_fma_f32 v[42:43], v[18:19], v[122:123], v[42:43] op_sel:[1,0,0] op_sel_hi:[1,1,1] neg_lo:[1,0,0] neg_hi:[1,0,0]
    v_pk_mul_f32 v[36:37], v[22:23], v[36:37] op_sel:[0,0] op_sel_hi:[0,1]
    v_pk_mul_f32 v[38:39], v[22:23], v[38:39] op_sel:[0,0] op_sel_hi:[0,1]
    v_pk_mul_f32 v[40:41], v[22:23], v[40:41] op_sel:[0,0] op_sel_hi:[0,1]
    v_pk_mul_f32 v[42:43], v[22:23], v[42:43] op_sel:[0,0] op_sel_hi:[0,1]
    v_cvt_pk_bf16_f32 v36, v36, v37
    v_cvt_pk_bf16_f32 v37, v38, v39
    v_cvt_pk_bf16_f32 v38, v40, v41
    v_cvt_pk_bf16_f32 v39, v42, v43
    buffer_store_dwordx4 v[36:39], v26, s[20:23], s37 offen sc1
    v_pk_add_f32 v[124:125], v[124:125], v[108:109] op_sel:[0,0] op_sel_hi:[1,1]
    v_pk_add_f32 v[126:127], v[126:127], v[110:111] op_sel:[0,0] op_sel_hi:[1,1]
    v_pk_add_f32 v[128:129], v[128:129], v[112:113] op_sel:[0,0] op_sel_hi:[1,1]
    v_pk_add_f32 v[130:131], v[130:131], v[114:115] op_sel:[0,0] op_sel_hi:[1,1]
    v_pk_fma_f32 v[44:45], v[18:19], v[124:125], v[44:45] op_sel:[1,0,0] op_sel_hi:[1,1,1] neg_lo:[1,0,0] neg_hi:[1,0,0]
    v_pk_fma_f32 v[46:47], v[18:19], v[126:127], v[46:47] op_sel:[1,0,0] op_sel_hi:[1,1,1] neg_lo:[1,0,0] neg_hi:[1,0,0]
    v_pk_fma_f32 v[48:49], v[18:19], v[128:129], v[48:49] op_sel:[1,0,0] op_sel_hi:[1,1,1] neg_lo:[1,0,0] neg_hi:[1,0,0]
    v_pk_fma_f32 v[50:51], v[18:19], v[130:131], v[50:51] op_sel:[1,0,0] op_sel_hi:[1,1,1] neg_lo:[1,0,0] neg_hi:[1,0,0]
    v_pk_mul_f32 v[44:45], v[22:23], v[44:45] op_sel:[0,0] op_sel_hi:[0,1]
    v_pk_mul_f32 v[46:47], v[22:23], v[46:47] op_sel:[0,0] op_sel_hi:[0,1]
    v_pk_mul_f32 v[48:49], v[22:23], v[48:49] op_sel:[0,0] op_sel_hi:[0,1]
    v_pk_mul_f32 v[50:51], v[22:23], v[50:51] op_sel:[0,0] op_sel_hi:[0,1]
    v_cvt_pk_bf16_f32 v44, v44, v45
    v_cvt_pk_bf16_f32 v45, v46, v47
    v_cvt_pk_bf16_f32 v46, v48, v49
    v_cvt_pk_bf16_f32 v47, v50, v51
    buffer_store_dwordx4 v[44:47], v26, s[20:23], s38 offen sc1
    ds_read_b128 v[116:119], v25 offset:0
    ds_read_b128 v[120:123], v25 offset:32
    ds_read_b128 v[124:127], v25 offset:64
    ds_read_b128 v[128:131], v25 offset:96
    ds_read_b128 v[100:103], v25 offset:128
    ds_read_b128 v[104:107], v25 offset:160
    ds_read_b128 v[108:111], v25 offset:192
    ds_read_b128 v[112:115], v25 offset:224
    s_waitcnt lgkmcnt(8)
    v_pk_add_f32 v[132:133], v[132:133], v[148:149] op_sel:[0,0] op_sel_hi:[1,1]
    v_pk_add_f32 v[134:135], v[134:135], v[150:151] op_sel:[0,0] op_sel_hi:[1,1]
    v_pk_add_f32 v[136:137], v[136:137], v[152:153] op_sel:[0,0] op_sel_hi:[1,1]
    v_pk_add_f32 v[138:139], v[138:139], v[154:155] op_sel:[0,0] op_sel_hi:[1,1]
    v_pk_fma_f32 v[52:53], v[18:19], v[132:133], v[52:53] op_sel:[1,0,0] op_sel_hi:[1,1,1] neg_lo:[1,0,0] neg_hi:[1,0,0]
    v_pk_fma_f32 v[54:55], v[18:19], v[134:135], v[54:55] op_sel:[1,0,0] op_sel_hi:[1,1,1] neg_lo:[1,0,0] neg_hi:[1,0,0]
    v_pk_fma_f32 v[56:57], v[18:19], v[136:137], v[56:57] op_sel:[1,0,0] op_sel_hi:[1,1,1] neg_lo:[1,0,0] neg_hi:[1,0,0]
    v_pk_fma_f32 v[58:59], v[18:19], v[138:139], v[58:59] op_sel:[1,0,0] op_sel_hi:[1,1,1] neg_lo:[1,0,0] neg_hi:[1,0,0]
    v_pk_mul_f32 v[52:53], v[20:21], v[52:53] op_sel:[0,0] op_sel_hi:[0,1]
    v_pk_mul_f32 v[54:55], v[20:21], v[54:55] op_sel:[0,0] op_sel_hi:[0,1]
    v_pk_mul_f32 v[56:57], v[20:21], v[56:57] op_sel:[0,0] op_sel_hi:[0,1]
    v_pk_mul_f32 v[58:59], v[20:21], v[58:59] op_sel:[0,0] op_sel_hi:[0,1]
    v_cvt_pk_bf16_f32 v52, v52, v53
    v_cvt_pk_bf16_f32 v53, v54, v55
    v_cvt_pk_bf16_f32 v54, v56, v57
    v_cvt_pk_bf16_f32 v55, v58, v59
    buffer_store_dwordx4 v[52:55], v27, s[20:23], s39 offen sc1
    v_pk_add_f32 v[140:141], v[140:141], v[156:157] op_sel:[0,0] op_sel_hi:[1,1]
    v_pk_add_f32 v[142:143], v[142:143], v[158:159] op_sel:[0,0] op_sel_hi:[1,1]
    v_pk_add_f32 v[144:145], v[144:145], v[160:161] op_sel:[0,0] op_sel_hi:[1,1]
    v_pk_add_f32 v[146:147], v[146:147], v[162:163] op_sel:[0,0] op_sel_hi:[1,1]
    v_pk_fma_f32 v[60:61], v[18:19], v[140:141], v[60:61] op_sel:[1,0,0] op_sel_hi:[1,1,1] neg_lo:[1,0,0] neg_hi:[1,0,0]
    v_pk_fma_f32 v[62:63], v[18:19], v[142:143], v[62:63] op_sel:[1,0,0] op_sel_hi:[1,1,1] neg_lo:[1,0,0] neg_hi:[1,0,0]
    v_pk_fma_f32 v[64:65], v[18:19], v[144:145], v[64:65] op_sel:[1,0,0] op_sel_hi:[1,1,1] neg_lo:[1,0,0] neg_hi:[1,0,0]
    v_pk_fma_f32 v[66:67], v[18:19], v[146:147], v[66:67] op_sel:[1,0,0] op_sel_hi:[1,1,1] neg_lo:[1,0,0] neg_hi:[1,0,0]
    v_pk_mul_f32 v[60:61], v[20:21], v[60:61] op_sel:[0,0] op_sel_hi:[0,1]
    v_pk_mul_f32 v[62:63], v[20:21], v[62:63] op_sel:[0,0] op_sel_hi:[0,1]
    v_pk_mul_f32 v[64:65], v[20:21], v[64:65] op_sel:[0,0] op_sel_hi:[0,1]
    v_pk_mul_f32 v[66:67], v[20:21], v[66:67] op_sel:[0,0] op_sel_hi:[0,1]
    v_cvt_pk_bf16_f32 v60, v60, v61
    v_cvt_pk_bf16_f32 v61, v62, v63
    v_cvt_pk_bf16_f32 v62, v64, v65
    v_cvt_pk_bf16_f32 v63, v66, v67
    buffer_store_dwordx4 v[60:63], v27, s[20:23], s40 offen sc1
    s_waitcnt lgkmcnt(0)
    v_pk_fma_f32 v[68:69], v[20:21], v[116:117], v[68:69] op_sel:[1,0,0] op_sel_hi:[1,1,1] neg_lo:[1,0,0] neg_hi:[1,0,0]
    v_pk_fma_f32 v[70:71], v[20:21], v[118:119], v[70:71] op_sel:[1,0,0] op_sel_hi:[1,1,1] neg_lo:[1,0,0] neg_hi:[1,0,0]
    v_pk_fma_f32 v[72:73], v[20:21], v[120:121], v[72:73] op_sel:[1,0,0] op_sel_hi:[1,1,1] neg_lo:[1,0,0] neg_hi:[1,0,0]
    v_pk_fma_f32 v[74:75], v[20:21], v[122:123], v[74:75] op_sel:[1,0,0] op_sel_hi:[1,1,1] neg_lo:[1,0,0] neg_hi:[1,0,0]
    v_pk_mul_f32 v[68:69], v[100:101], v[68:69] op_sel:[0,0] op_sel_hi:[1,1]
    v_pk_mul_f32 v[70:71], v[102:103], v[70:71] op_sel:[0,0] op_sel_hi:[1,1]
    v_pk_mul_f32 v[72:73], v[104:105], v[72:73] op_sel:[0,0] op_sel_hi:[1,1]
    v_pk_mul_f32 v[74:75], v[106:107], v[74:75] op_sel:[0,0] op_sel_hi:[1,1]
    v_cvt_pk_bf16_f32 v68, v68, v69
    v_cvt_pk_bf16_f32 v69, v70, v71
    v_cvt_pk_bf16_f32 v70, v72, v73
    v_cvt_pk_bf16_f32 v71, v74, v75
    buffer_store_dwordx4 v[68:71], v28, s[20:23], s39 offen offset:1024 sc1
    v_pk_fma_f32 v[76:77], v[20:21], v[124:125], v[76:77] op_sel:[1,0,0] op_sel_hi:[1,1,1] neg_lo:[1,0,0] neg_hi:[1,0,0]
    v_pk_fma_f32 v[78:79], v[20:21], v[126:127], v[78:79] op_sel:[1,0,0] op_sel_hi:[1,1,1] neg_lo:[1,0,0] neg_hi:[1,0,0]
    v_pk_fma_f32 v[80:81], v[20:21], v[128:129], v[80:81] op_sel:[1,0,0] op_sel_hi:[1,1,1] neg_lo:[1,0,0] neg_hi:[1,0,0]
    v_pk_fma_f32 v[82:83], v[20:21], v[130:131], v[82:83] op_sel:[1,0,0] op_sel_hi:[1,1,1] neg_lo:[1,0,0] neg_hi:[1,0,0]
    v_pk_mul_f32 v[76:77], v[108:109], v[76:77] op_sel:[0,0] op_sel_hi:[1,1]
    v_pk_mul_f32 v[78:79], v[110:111], v[78:79] op_sel:[0,0] op_sel_hi:[1,1]
    v_pk_mul_f32 v[80:81], v[112:113], v[80:81] op_sel:[0,0] op_sel_hi:[1,1]
    v_pk_mul_f32 v[82:83], v[114:115], v[82:83] op_sel:[0,0] op_sel_hi:[1,1]
    v_cvt_pk_bf16_f32 v76, v76, v77
    v_cvt_pk_bf16_f32 v77, v78, v79
    v_cvt_pk_bf16_f32 v78, v80, v81
    v_cvt_pk_bf16_f32 v79, v82, v83
    buffer_store_dwordx4 v[76:79], v28, s[20:23], s39 offen offset:1280 sc1
L_end_2:
qkv_kernel_done:
    s_endpgm
    .globl ffn_kernel
    .p2align 8
    .type ffn_kernel,@function
ffn_kernel:
    s_cmp_ge_u32 s2, 256
    s_cbranch_scc1 ffn_kernel_done
    s_load_dwordx2 s[8:9], s[0:1], 72
    s_load_dwordx16 s[40:55], s[0:1], 0
    v_and_b32 v1, 63, v0
    v_lshrrev_b32 v4, 6, v0
    v_lshlrev_b32 v2, 4, v1
    v_readfirstlane_b32 s24, v4
    s_and_b32 s27, s2, 7
    s_lshl_b32 s25, s27, 2
    s_bfe_u32 s27, s2, 0x20003
    s_or_b32 s25, s25, s27
    s_lshr_b32 s33, s24, 2
    s_lshr_b32 s26, s2, 5
    s_lshl_b32 s26, s26, 3
    s_and_b32 s29, s24, 3
    s_lshl_b32 s27, s29, 1
    s_add_u32 s26, s26, s27
    s_add_u32 s26, s26, s33
    s_lshl_b32 s27, s25, 6
    s_add_u32 s27, s27, s26
    s_lshl_b32 s27, s27, 10
    s_xor_b32 s28, s27, 1024
    s_lshl_b32 s32, s29, 11
    s_lshl_b32 s29, s33, 16
    s_add_u32 s32, s32, s29
    s_lshl_b32 s31, s25, 17
    s_add_u32 s31, s31, s32
    s_add_u32 s31, s31, 0x200000
    s_waitcnt lgkmcnt(0)
    s_mov_b32 s12, s8
    s_mov_b32 s13, s9
    s_mov_b32 s14, 0x1800000
    s_mov_b32 s15, 0x00020000
    buffer_load_dwordx4 v[12:15], v2, s[12:15], s27 offen
    buffer_load_dwordx4 v[16:19], v2, s[12:15], s28 offen
    s_add_u32 m0, s32, 0
    s_add_u32 s29, s31, 0
    buffer_load_dwordx4 v2, s[12:15], s29 offen offset:0 lds
    buffer_load_dwordx4 v2, s[12:15], s29 offen offset:1024 lds
    v_mov_b32 v6, 0xdddd
    s_mov_b32 s34, 0x0000ffff
    s_mov_b32 s35, 0x0000ffff
    v_and_b32 v4, 27, v1
    v_cmp_eq_u32 vcc, 16, v4
    v_mov_b32 v5, 0x3f803f80
    s_nop 0
    v_cndmask_b32 v28, 0, v5, vcc
    v_cndmask_b32 v29, 0, v5, vcc
    v_cndmask_b32 v30, 0, v5, vcc
    v_cndmask_b32 v31, 0, v5, vcc
    v_cndmask_b32 v32, 0, v5, vcc
    v_cndmask_b32 v33, 0, v5, vcc
    v_cndmask_b32 v34, 0, v5, vcc
    v_cndmask_b32 v35, 0, v5, vcc
    v_cndmask_b32 v36, 0, v5, vcc
    v_cndmask_b32 v37, 0, v5, vcc
    v_cndmask_b32 v38, 0, v5, vcc
    v_cndmask_b32 v39, 0, v5, vcc
    v_cndmask_b32 v40, 0, v5, vcc
    v_cndmask_b32 v41, 0, v5, vcc
    v_cndmask_b32 v42, 0, v5, vcc
    v_cndmask_b32 v43, 0, v5, vcc
    v_and_b32 v4, 15, v1
    v_bfe_u32 v11, v1, 4, 1
    v_cmp_eq_u32 vcc, v4, v11
    s_nop 1
    v_cndmask_b32 v108, 0, v5, vcc
    v_cndmask_b32 v109, 0, v5, vcc
    v_cndmask_b32 v110, 0, v5, vcc
    v_cndmask_b32 v111, 0, v5, vcc
    s_mul_i32 s27, s24, 3072
    s_add_u32 s27, s27, 131072
    v_add_u32 v9, s27, v2
    s_lshr_b32 s36, s2, 3
    s_and_b32 s37, s2, 7
    s_mov_b32 s16, s48
    s_mov_b32 s17, s49
    s_mov_b32 s18, 0x1c0000
    s_mov_b32 s19, 0x00020000
    s_mov_b32 s20, s50
    s_mov_b32 s21, s51
    s_mov_b32 s22, 0x1c0000
    s_mov_b32 s23, 0x00020000
    s_cmp_ge_u32 s36, 28
    s_cselect_b32 s18, 0, s18
    s_cselect_b32 s22, 0, s22
    v_lshrrev_b32 v4, 3, v1
    v_mul_u32_u24 v118, 3584, v4
    v_and_b32 v5, 7, v1
    v_lshl_add_u32 v118, v5, 4, v118
    v_lshlrev_b32 v4, 10, v4
    v_lshlrev_b32 v11, 2, v11
    v_xor_b32 v5, v5, v11
    v_lshl_add_u32 v4, v5, 4, v4
    s_lshr_b32 s27, s2, 5
    s_lshl_b32 s27, s27, 7
    v_add_u32 v116, s27, v4
    v_add_u32 v117, 7168, v116
    v_lshlrev_b32 v119, 7, v1
    s_lshl_b32 s92, s37, 3
    s_add_u32 s92, s92, s24
    s_mul_i32 s92, s92, 28672
    s_lshl_b32 s29, s36, 7
    s_add_u32 s92, s92, s29
    s_lshl_b32 s93, s24, 10
    s_add_u32 s93, s93, 131072
    v_lshrrev_b32 v4, 5, v1
    v_bfe_u32 v5, v1, 2, 2
    v_lshl_add_u32 v4, v4, 2, v5
    v_lshlrev_b32 v4, 7, v4
    v_and_b32 v5, 3, v1
    v_lshl_add_u32 v4, v5, 3, v4
    v_bfe_u32 v5, v1, 4, 1
    v_lshl_add_u32 v4, v5, 13, v4
    s_lshr_b32 s27, s24, 1
    s_lshl_b32 s27, s27, 5
    s_and_b32 s29, s24, 1
    s_lshl_b32 s29, s29, 12
    s_add_u32 s27, s27, s29
    s_add_u32 s27, s27, 131072
    v_add_u32 v10, s27, v4
    s_lshl_b32 s27, s36, 2
    s_lshr_b32 s29, s24, 1
    s_add_u32 s28, s27, s29
    s_lshl_b32 s94, s28, 15
    s_lshl_b32 s29, s37, 12
    s_add_u32 s94, s94, s29
    s_and_b32 s27, s24, 1
    s_lshl_b32 s29, s27, 11
    s_add_u32 s94, s94, s29
    s_add_u32 s94, s94, 0x1400000
    s_lshl_b32 s95, s37, 1
    s_add_u32 s95, s95, s27
    s_mul_i32 s95, s95, 14336
    s_lshl_b32 s29, s28, 7
    s_add_u32 s95, s95, s29
    s_add_u32 s95, s95, 0x1310000
    s_cmp_ge_u32 s36, 28
    s_cmov_b32 s94, 0x40000000
    s_cmov_b32 s95, 0x40000000
    s_mul_i32 s96, s36, 57344
    s_lshl_b32 s29, s24, 13
    s_add_u32 s96, s96, s29
    s_and_b32 s28, s2, 1
    s_mul_i32 s98, s28, 1835008
    s_add_u32 s98, s98, s96
    s_add_u32 s98, s98, 0x1400000
    s_lshl_b32 s97, s36, 14
    s_add_u32 s97, s97, s29
    s_cmp_ge_u32 s24, 2
    s_cmov_b32 s97, 0x40000000
    s_bfe_u32 s29, s2, 0x20001
    s_lshl_b32 s29, s29, 3
    s_add_u32 s29, s29, s28
    s_lshr_b32 s28, s2, 6
    s_add_u32 s29, s29, s28
    s_lshl_b32 s29, s29, 16
    s_lshl_b32 s28, s36, 13
    s_add_u32 s29, s29, s28
    s_cmp_eq_u32 s24, 7
    s_cmov_b32 s96, s29
    s_cmov_b32 s98, 0x40000000
    s_cselect_b32 s56, s40, s52
    s_cselect_b32 s57, s41, s53
    s_mov_b32 s58, 0x1c0000
    s_cmov_b32 s58, 0x200000
    s_mov_b32 s59, 0x00020000
    s_lshl_b32 s99, s2, 7
    s_add_u32 s99, s99, 0x11e0000
    s_cmp_lg_u32 s24, 0
    s_cmov_b32 s99, 0x40000000
    s_and_b32 s27, s24, 1
    s_bfe_u32 s29, s24, 0x10001
    s_cmp_ge_u32 s24, 4
    s_cselect_b32 s60, s52, s44
    s_cselect_b32 s61, s53, s45
    s_mov_b32 s62, 0x80000
    s_cmov_b32 s62, 0x1c0000
    s_mov_b32 s63, 0x00020000
    s_mov_b32 s38, 0x8000
    s_cmov_b32 s38, 0x70000
    s_mul_i32 s27, s27, s38
    s_lshl_b32 s38, s38, 1
    s_cmp_lt_u32 s24, 4
    s_cmov_b32 s38, 0x40000
    s_mul_i32 s38, s38, s29
    s_add_u32 s38, s38, s27
    v_accvgpr_write_b32 a0, 0
    v_accvgpr_write_b32 a1, 0
    v_accvgpr_write_b32 a2, 0
    v_accvgpr_write_b32 a3, 0
    v_accvgpr_write_b32 a4, 0
    v_accvgpr_write_b32 a5, 0
    v_accvgpr_write_b32 a6, 0
    v_accvgpr_write_b32 a7, 0
    v_accvgpr_write_b32 a8, 0
    v_accvgpr_write_b32 a9, 0
    v_accvgpr_write_b32 a10, 0
    v_accvgpr_write_b32 a11, 0
    v_accvgpr_write_b32 a12, 0
    v_accvgpr_write_b32 a13, 0
    v_accvgpr_write_b32 a14, 0
    v_accvgpr_write_b32 a15, 0
    v_accvgpr_write_b32 a16, 0
    v_accvgpr_write_b32 a17, 0
    v_accvgpr_write_b32 a18, 0
    v_accvgpr_write_b32 a19, 0
    v_accvgpr_write_b32 a20, 0
    v_accvgpr_write_b32 a21, 0
    v_accvgpr_write_b32 a22, 0
    v_accvgpr_write_b32 a23, 0
    v_accvgpr_write_b32 a24, 0
    v_accvgpr_write_b32 a25, 0
    v_accvgpr_write_b32 a26, 0
    v_accvgpr_write_b32 a27, 0
    v_accvgpr_write_b32 a28, 0
    v_accvgpr_write_b32 a29, 0
    v_accvgpr_write_b32 a30, 0
    v_accvgpr_write_b32 a31, 0
    v_mov_b32 v7, 0xff800000
    v_mov_b32 v8, 0xff800000
    v_mov_b32 v3, v2
    s_mov_b32 s30, 1
    s_waitcnt vmcnt(0)
    s_barrier
L_maxl_7:
    ds_read_b128 v[24:27], v3
    v_add_u32 v3, 2048, v3
    s_waitcnt lgkmcnt(0)
    v_mfma_f32_32x32x16_bf16 v[44:59], v[24:27], v[12:15], 0
    v_mfma_f32_32x32x16_bf16 v[60:75], v[24:27], v[16:19], 0
    s_lshl_b32 s27, s33, 16
    v_add_u32 v3, s27, v2
    ds_read_b128 v[20:23], v3
    s_mov_b64 exec, s[34:35]
    ds_read_b128 v[28:31], v3 offset:1024
    ds_read_b128 v[32:35], v3 offset:1280
    s_mov_b64 exec, -1
    s_nop 3
    v_max3_f32 v7, v44, v45, v7
    v_max3_f32 v7, v46, v47, v7
    v_max3_f32 v7, v48, v49, v7
    v_max3_f32 v7, v50, v51, v7
    v_max3_f32 v7, v52, v53, v7
    v_max3_f32 v7, v54, v55, v7
    v_max3_f32 v7, v56, v57, v7
    v_max3_f32 v7, v58, v59, v7
    v_max3_f32 v8, v60, v61, v8
    v_max3_f32 v8, v62, v63, v8
    v_max3_f32 v8, v64, v65, v8
    v_max3_f32 v8, v66, v67, v8
    v_max3_f32 v8, v68, v69, v8
    v_max3_f32 v8, v70, v71, v8
    v_max3_f32 v8, v72, v73, v8
    v_max3_f32 v8, v74, v75, v8
    v_mov_b32 v4, v7
    v_mov_b32 v5, v8
    s_nop 1
    v_permlane32_swap_b32 v7, v4
    v_permlane32_swap_b32 v8, v5
    s_nop 1
    v_max_f32 v7, v7, v4
    v_max_f32 v8, v8, v5
    v_pk_mul_f32 v[76:77], v[6:7], -1.0 op_sel:[1,0] op_sel_hi:[1,0]
    v_pk_mul_f32 v[78:79], v[6:7], -1.0 op_sel:[1,0] op_sel_hi:[1,0]
    v_pk_mul_f32 v[80:81], v[6:7], -1.0 op_sel:[1,0] op_sel_hi:[1,0]
    v_pk_mul_f32 v[82:83], v[6:7], -1.0 op_sel:[1,0] op_sel_hi:[1,0]
    v_pk_mul_f32 v[84:85], v[6:7], -1.0 op_sel:[1,0] op_sel_hi:[1,0]
    v_pk_mul_f32 v[86:87], v[6:7], -1.0 op_sel:[1,0] op_sel_hi:[1,0]
    v_pk_mul_f32 v[88:89], v[6:7], -1.0 op_sel:[1,0] op_sel_hi:[1,0]
    v_pk_mul_f32 v[90:91], v[6:7], -1.0 op_sel:[1,0] op_sel_hi:[1,0]
    v_pk_mul_f32 v[92:93], v[8:9], -1.0 op_sel:[0,0] op_sel_hi:[0,0]
    v_pk_mul_f32 v[94:95], v[8:9], -1.0 op_sel:[0,0] op_sel_hi:[0,0]
    v_pk_mul_f32 v[96:97], v[8:9], -1.0 op_sel:[0,0] op_sel_hi:[0,0]
    v_pk_mul_f32 v[98:99], v[8:9], -1.0 op_sel:[0,0] op_sel_hi:[0,0]
    v_pk_mul_f32 v[100:101], v[8:9], -1.0 op_sel:[0,0] op_sel_hi:[0,0]
    v_pk_mul_f32 v[102:103], v[8:9], -1.0 op_sel:[0,0] op_sel_hi:[0,0]
    v_pk_mul_f32 v[104:105], v[8:9], -1.0 op_sel:[0,0] op_sel_hi:[0,0]
    v_pk_mul_f32 v[106:107], v[8:9], -1.0 op_sel:[0,0] op_sel_hi:[0,0]
    s_waitcnt lgkmcnt(0)
    s_nop 0
    v_mfma_f32_32x32x16_bf16 v[44:59], v[20:23], v[12:15], v[76:91]
    s_nop 11
    v_exp_f32 v44, v44
    v_exp_f32 v45, v45
    v_exp_f32 v46, v46
    ds_read_b128 v[24:27], v3 offset:2048
    s_mov_b64 exec, s[34:35]
    ds_read_b128 v[36:39], v3 offset:3072
    ds_read_b128 v[40:43], v3 offset:3328
    s_mov_b64 exec, -1
    v_exp_f32 v47, v47
    v_exp_f32 v48, v48
    v_mfma_f32_32x32x16_bf16 v[60:75], v[20:23], v[16:19], v[92:107]
    v_exp_f32 v49, v49
    v_exp_f32 v50, v50
    v_exp_f32 v51, v51
    s_add_u32 m0, s32, 8192
    s_add_u32 s29, s31, 8192
    buffer_load_dwordx4 v2, s[12:15], s29 offen offset:0 lds
    buffer_load_dwordx4 v2, s[12:15], s29 offen offset:1024 lds
    v_exp_f32 v52, v52
    v_exp_f32 v53, v53
    v_exp_f32 v54, v54
    v_smfmac_f32_32x32x32_bf16 a[0:15], v[28:31], v[44:51], v6
    v_exp_f32 v55, v55
    v_exp_f32 v56, v56
    v_exp_f32 v57, v57
    v_exp_f32 v58, v58
    v_exp_f32 v59, v59
    v_exp_f32 v60, v60
    v_exp_f32 v61, v61
    v_smfmac_f32_32x32x32_bf16 a[0:15], v[32:35], v[52:59], v6
    v_exp_f32 v62, v62
    v_exp_f32 v63, v63
    v_exp_f32 v64, v64
    s_waitcnt lgkmcnt(0)
    v_mfma_f32_32x32x16_bf16 v[44:59], v[24:27], v[12:15], v[76:91]
    v_exp_f32 v65, v65
    v_exp_f32 v66, v66
    v_exp_f32 v67, v67
    s_add_u32 m0, s32, 16384
    s_add_u32 s29, s31, 16384
    buffer_load_dwordx4 v2, s[12:15], s29 offen offset:0 lds
    buffer_load_dwordx4 v2, s[12:15], s29 offen offset:1024 lds
    v_exp_f32 v68, v68
    v_exp_f32 v69, v69
    v_exp_f32 v70, v70
    v_smfmac_f32_32x32x32_bf16 a[16:31], v[28:31], v[60:67], v6
    v_exp_f32 v71, v71
    v_exp_f32 v72, v72
    v_exp_f32 v73, v73
    v_exp_f32 v74, v74
    v_exp_f32 v75, v75
    v_exp_f32 v44, v44
    v_exp_f32 v45, v45
    v_smfmac_f32_32x32x32_bf16 a[16:31], v[32:35], v[68:75], v6
    v_exp_f32 v46, v46
    ds_read_b128 v[20:23], v3 offset:4096
    s_mov_b64 exec, s[34:35]
    ds_read_b128 v[28:31], v3 offset:5120
    ds_read_b128 v[32:35], v3 offset:5376
    s_mov_b64 exec, -1
    v_exp_f32 v47, v47
    v_exp_f32 v48, v48
    v_mfma_f32_32x32x16_bf16 v[60:75], v[24:27], v[16:19], v[92:107]
    v_exp_f32 v49, v49
    v_exp_f32 v50, v50
    v_exp_f32 v51, v51
    s_add_u32 m0, s32, 24576
    s_add_u32 s29, s31, 24576
    buffer_load_dwordx4 v2, s[12:15], s29 offen offset:0 lds
    buffer_load_dwordx4 v2, s[12:15], s29 offen offset:1024 lds
    v_exp_f32 v52, v52
    v_exp_f32 v53, v53
    v_exp_f32 v54, v54
    v_smfmac_f32_32x32x32_bf16 a[0:15], v[36:39], v[44:51], v6
    v_exp_f32 v55, v55
    v_exp_f32 v56, v56
    v_exp_f32 v57, v57
    v_exp_f32 v58, v58
    v_exp_f32 v59, v59
    v_exp_f32 v60, v60
    v_exp_f32 v61, v61
    v_smfmac_f32_32x32x32_bf16 a[0:15], v[40:43], v[52:59], v6
    v_exp_f32 v62, v62
    v_exp_f32 v63, v63
    v_exp_f32 v64, v64
    s_waitcnt lgkmcnt(0)
    v_mfma_f32_32x32x16_bf16 v[44:59], v[20:23], v[12:15], v[76:91]
    v_exp_f32 v65, v65
    v_exp_f32 v66, v66
    v_exp_f32 v67, v67
    s_add_u32 m0, s32, 32768
    s_add_u32 s29, s31, 32768
    buffer_load_dwordx4 v2, s[12:15], s29 offen offset:0 lds
    buffer_load_dwordx4 v2, s[12:15], s29 offen offset:1024 lds
    v_exp_f32 v68, v68
    v_exp_f32 v69, v69
    v_exp_f32 v70, v70
    v_smfmac_f32_32x32x32_bf16 a[16:31], v[36:39], v[60:67], v6
    v_exp_f32 v71, v71
    v_exp_f32 v72, v72
    v_exp_f32 v73, v73
    v_exp_f32 v74, v74
    v_exp_f32 v75, v75
    v_exp_f32 v44, v44
    v_exp_f32 v45, v45
    v_smfmac_f32_32x32x32_bf16 a[16:31], v[40:43], v[68:75], v6
    v_exp_f32 v46, v46
    ds_read_b128 v[24:27], v3 offset:6144
    s_mov_b64 exec, s[34:35]
    ds_read_b128 v[36:39], v3 offset:7168
    ds_read_b128 v[40:43], v3 offset:7424
    s_mov_b64 exec, -1
    v_exp_f32 v47, v47
    v_exp_f32 v48, v48
    v_mfma_f32_32x32x16_bf16 v[60:75], v[20:23], v[16:19], v[92:107]
    v_exp_f32 v49, v49
    v_exp_f32 v50, v50
    v_exp_f32 v51, v51
    v_exp_f32 v52, v52
    v_exp_f32 v53, v53
    v_exp_f32 v54, v54
    v_smfmac_f32_32x32x32_bf16 a[0:15], v[28:31], v[44:51], v6
    v_exp_f32 v55, v55
    v_exp_f32 v56, v56
    v_exp_f32 v57, v57
    v_exp_f32 v58, v58
    v_exp_f32 v59, v59
    v_exp_f32 v60, v60
    v_exp_f32 v61, v61
    v_smfmac_f32_32x32x32_bf16 a[0:15], v[32:35], v[52:59], v6
    v_exp_f32 v62, v62
    v_exp_f32 v63, v63
    v_exp_f32 v64, v64
    s_waitcnt lgkmcnt(0)
    v_mfma_f32_32x32x16_bf16 v[44:59], v[24:27], v[12:15], v[76:91]
    v_exp_f32 v65, v65
    v_exp_f32 v66, v66
    v_exp_f32 v67, v67
    s_add_u32 m0, s32, 40960
    s_add_u32 s29, s31, 40960
    buffer_load_dwordx4 v2, s[12:15], s29 offen offset:0 lds
    buffer_load_dwordx4 v2, s[12:15], s29 offen offset:1024 lds
    v_exp_f32 v68, v68
    v_exp_f32 v69, v69
    v_exp_f32 v70, v70
    v_smfmac_f32_32x32x32_bf16 a[16:31], v[28:31], v[60:67], v6
    v_exp_f32 v71, v71
    v_exp_f32 v72, v72
    v_exp_f32 v73, v73
    v_exp_f32 v74, v74
    v_exp_f32 v75, v75
    s_waitcnt vmcnt(8)
    s_barrier
    v_exp_f32 v44, v44
    v_exp_f32 v45, v45
    v_smfmac_f32_32x32x32_bf16 a[16:31], v[32:35], v[68:75], v6
    v_exp_f32 v46, v46
    ds_read_b128 v[20:23], v3 offset:8192
    s_mov_b64 exec, s[34:35]
    ds_read_b128 v[28:31], v3 offset:9216
    ds_read_b128 v[32:35], v3 offset:9472
    s_mov_b64 exec, -1
    v_exp_f32 v47, v47
    v_exp_f32 v48, v48
    v_mfma_f32_32x32x16_bf16 v[60:75], v[24:27], v[16:19], v[92:107]
    v_exp_f32 v49, v49
    v_exp_f32 v50, v50
    v_exp_f32 v51, v51
    v_exp_f32 v52, v52
    v_exp_f32 v53, v53
    v_exp_f32 v54, v54
    v_smfmac_f32_32x32x32_bf16 a[0:15], v[36:39], v[44:51], v6
    v_exp_f32 v55, v55
    v_exp_f32 v56, v56
    v_exp_f32 v57, v57
    v_exp_f32 v58, v58
    v_exp_f32 v59, v59
    v_exp_f32 v60, v60
    v_exp_f32 v61, v61
    v_smfmac_f32_32x32x32_bf16 a[0:15], v[40:43], v[52:59], v6
    v_exp_f32 v62, v62
    v_exp_f32 v63, v63
    v_exp_f32 v64, v64
    s_waitcnt lgkmcnt(0)
    v_mfma_f32_32x32x16_bf16 v[44:59], v[20:23], v[12:15], v[76:91]
    v_exp_f32 v65, v65
    v_exp_f32 v66, v66
    v_exp_f32 v67, v67
    s_add_u32 m0, s32, 49152
    s_add_u32 s29, s31, 49152
    buffer_load_dwordx4 v2, s[12:15], s29 offen offset:0 lds
    buffer_load_dwordx4 v2, s[12:15], s29 offen offset:1024 lds
    v_exp_f32 v68, v68
    v_exp_f32 v69, v69
    v_exp_f32 v70, v70
    v_smfmac_f32_32x32x32_bf16 a[16:31], v[36:39], v[60:67], v6
    v_exp_f32 v71, v71
    v_exp_f32 v72, v72
    v_exp_f32 v73, v73
    v_exp_f32 v74, v74
    v_exp_f32 v75, v75
    v_exp_f32 v44, v44
    v_exp_f32 v45, v45
    v_smfmac_f32_32x32x32_bf16 a[16:31], v[40:43], v[68:75], v6
    v_exp_f32 v46, v46
    ds_read_b128 v[24:27], v3 offset:10240
    s_mov_b64 exec, s[34:35]
    ds_read_b128 v[36:39], v3 offset:11264
    ds_read_b128 v[40:43], v3 offset:11520
    s_mov_b64 exec, -1
    v_exp_f32 v47, v47
    v_exp_f32 v48, v48
    v_mfma_f32_32x32x16_bf16 v[60:75], v[20:23], v[16:19], v[92:107]
    v_exp_f32 v49, v49
    v_exp_f32 v50, v50
    v_exp_f32 v51, v51
    v_exp_f32 v52, v52
    v_exp_f32 v53, v53
    v_exp_f32 v54, v54
    v_smfmac_f32_32x32x32_bf16 a[0:15], v[28:31], v[44:51], v6
    v_exp_f32 v55, v55
    v_exp_f32 v56, v56
    v_exp_f32 v57, v57
    v_exp_f32 v58, v58
    v_exp_f32 v59, v59
    v_exp_f32 v60, v60
    v_exp_f32 v61, v61
    v_smfmac_f32_32x32x32_bf16 a[0:15], v[32:35], v[52:59], v6
    v_exp_f32 v62, v62
    v_exp_f32 v63, v63
    v_exp_f32 v64, v64
    s_waitcnt lgkmcnt(0)
    v_mfma_f32_32x32x16_bf16 v[44:59], v[24:27], v[12:15], v[76:91]
    v_exp_f32 v65, v65
    v_exp_f32 v66, v66
    v_exp_f32 v67, v67
    s_add_u32 m0, s32, 57344
    s_add_u32 s29, s31, 57344
    buffer_load_dwordx4 v2, s[12:15], s29 offen offset:0 lds
    buffer_load_dwordx4 v2, s[12:15], s29 offen offset:1024 lds
    v_exp_f32 v68, v68
    v_exp_f32 v69, v69
    v_exp_f32 v70, v70
    v_smfmac_f32_32x32x32_bf16 a[16:31], v[28:31], v[60:67], v6
    v_exp_f32 v71, v71
    v_exp_f32 v72, v72
    v_exp_f32 v73, v73
    v_exp_f32 v74, v74
    v_exp_f32 v75, v75
    v_exp_f32 v44, v44
    v_exp_f32 v45, v45
    v_smfmac_f32_32x32x32_bf16 a[16:31], v[32:35], v[68:75], v6
    v_exp_f32 v46, v46
    ds_read_b128 v[20:23], v3 offset:12288
    s_mov_b64 exec, s[34:35]
    ds_read_b128 v[28:31], v3 offset:13312
    ds_read_b128 v[32:35], v3 offset:13568
    s_mov_b64 exec, -1
    v_exp_f32 v47, v47
    v_exp_f32 v48, v48
    v_mfma_f32_32x32x16_bf16 v[60:75], v[24:27], v[16:19], v[92:107]
    v_exp_f32 v49, v49
    v_exp_f32 v50, v50
    v_exp_f32 v51, v51
    v_exp_f32 v52, v52
    v_exp_f32 v53, v53
    v_exp_f32 v54, v54
    v_smfmac_f32_32x32x32_bf16 a[0:15], v[36:39], v[44:51], v6
    v_exp_f32 v55, v55
    v_exp_f32 v56, v56
    v_exp_f32 v57, v57
    v_exp_f32 v58, v58
    v_exp_f32 v59, v59
    v_exp_f32 v60, v60
    v_exp_f32 v61, v61
    v_smfmac_f32_32x32x32_bf16 a[0:15], v[40:43], v[52:59], v6
    v_exp_f32 v62, v62
    v_exp_f32 v63, v63
    v_exp_f32 v64, v64
    s_waitcnt lgkmcnt(0)
    v_mfma_f32_32x32x16_bf16 v[44:59], v[20:23], v[12:15], v[76:91]
    v_exp_f32 v65, v65
    v_exp_f32 v66, v66
    v_exp_f32 v67, v67
    s_mov_b32 m0, s93
    s_nop 0
    buffer_load_dwordx4 v118, s[16:19], s92 offen lds
    s_add_u32 m0, s93, 8192
    s_nop 0
    buffer_load_dwordx4 v118, s[20:23], s92 offen lds
    v_exp_f32 v68, v68
    v_exp_f32 v69, v69
    v_exp_f32 v70, v70
    v_smfmac_f32_32x32x32_bf16 a[16:31], v[36:39], v[60:67], v6
    v_exp_f32 v71, v71
    v_exp_f32 v72, v72
    v_exp_f32 v73, v73
    v_exp_f32 v74, v74
    v_exp_f32 v75, v75
    v_exp_f32 v44, v44
    v_exp_f32 v45, v45
    v_smfmac_f32_32x32x32_bf16 a[16:31], v[40:43], v[68:75], v6
    v_exp_f32 v46, v46
    ds_read_b128 v[24:27], v3 offset:14336
    s_mov_b64 exec, s[34:35]
    ds_read_b128 v[36:39], v3 offset:15360
    ds_read_b128 v[40:43], v3 offset:15616
    s_mov_b64 exec, -1
    v_exp_f32 v47, v47
    v_exp_f32 v48, v48
    v_mfma_f32_32x32x16_bf16 v[60:75], v[20:23], v[16:19], v[92:107]
    v_exp_f32 v49, v49
    v_exp_f32 v50, v50
    v_exp_f32 v51, v51
    v_exp_f32 v52, v52
    v_exp_f32 v53, v53
    v_exp_f32 v54, v54
    v_smfmac_f32_32x32x32_bf16 a[0:15], v[28:31], v[44:51], v6
    v_exp_f32 v55, v55
    v_exp_f32 v56, v56
    v_exp_f32 v57, v57
    v_exp_f32 v58, v58
    v_exp_f32 v59, v59
    v_exp_f32 v60, v60
    v_exp_f32 v61, v61
    v_smfmac_f32_32x32x32_bf16 a[0:15], v[32:35], v[52:59], v6
    v_exp_f32 v62, v62
    v_exp_f32 v63, v63
    v_exp_f32 v64, v64
    s_waitcnt lgkmcnt(0)
    v_mfma_f32_32x32x16_bf16 v[44:59], v[24:27], v[12:15], v[76:91]
    v_exp_f32 v65, v65
    v_exp_f32 v66, v66
    v_exp_f32 v67, v67
    v_exp_f32 v68, v68
    v_exp_f32 v69, v69
    v_exp_f32 v70, v70
    v_smfmac_f32_32x32x32_bf16 a[16:31], v[28:31], v[60:67], v6
    v_exp_f32 v71, v71
    v_exp_f32 v72, v72
    v_exp_f32 v73, v73
    v_exp_f32 v74, v74
    v_exp_f32 v75, v75
    s_waitcnt vmcnt(10)
    s_barrier
    v_exp_f32 v44, v44
    v_exp_f32 v45, v45
    v_smfmac_f32_32x32x32_bf16 a[16:31], v[32:35], v[68:75], v6
    v_exp_f32 v46, v46
    ds_read_b128 v[20:23], v3 offset:16384
    s_mov_b64 exec, s[34:35]
    ds_read_b128 v[28:31], v3 offset:17408
    ds_read_b128 v[32:35], v3 offset:17664
    s_mov_b64 exec, -1
    v_exp_f32 v47, v47
    v_exp_f32 v48, v48
    v_mfma_f32_32x32x16_bf16 v[60:75], v[24:27], v[16:19], v[92:107]
    v_exp_f32 v49, v49
    v_exp_f32 v50, v50
    v_exp_f32 v51, v51
    v_exp_f32 v52, v52
    v_exp_f32 v53, v53
    v_exp_f32 v54, v54
    v_smfmac_f32_32x32x32_bf16 a[0:15], v[36:39], v[44:51], v6
    v_exp_f32 v55, v55
    v_exp_f32 v56, v56
    v_exp_f32 v57, v57
    v_exp_f32 v58, v58
    v_exp_f32 v59, v59
    v_exp_f32 v60, v60
    v_exp_f32 v61, v61
    v_smfmac_f32_32x32x32_bf16 a[0:15], v[40:43], v[52:59], v6
    v_exp_f32 v62, v62
    v_exp_f32 v63, v63
    v_exp_f32 v64, v64
    s_waitcnt lgkmcnt(0)
    v_mfma_f32_32x32x16_bf16 v[44:59], v[20:23], v[12:15], v[76:91]
    v_exp_f32 v65, v65
    v_exp_f32 v66, v66
    v_exp_f32 v67, v67
    v_exp_f32 v68, v68
    v_exp_f32 v69, v69
    v_exp_f32 v70, v70
    v_smfmac_f32_32x32x32_bf16 a[16:31], v[36:39], v[60:67], v6
    v_exp_f32 v71, v71
    v_exp_f32 v72, v72
    v_exp_f32 v73, v73
    v_exp_f32 v74, v74
    v_exp_f32 v75, v75
    v_exp_f32 v44, v44
    v_exp_f32 v45, v45
    v_smfmac_f32_32x32x32_bf16 a[16:31], v[40:43], v[68:75], v6
    v_exp_f32 v46, v46
    ds_read_b128 v[24:27], v3 offset:18432
    s_mov_b64 exec, s[34:35]
    ds_read_b128 v[36:39], v3 offset:19456
    ds_read_b128 v[40:43], v3 offset:19712
    s_mov_b64 exec, -1
    v_exp_f32 v47, v47
    v_exp_f32 v48, v48
    v_mfma_f32_32x32x16_bf16 v[60:75], v[20:23], v[16:19], v[92:107]
    v_exp_f32 v49, v49
    v_exp_f32 v50, v50
    v_exp_f32 v51, v51
    buffer_load_dword v11, v119, s[56:59], s96 offen
    buffer_load_dword v11, v119, s[60:63], s97 offen
    v_exp_f32 v52, v52
    v_exp_f32 v53, v53
    v_exp_f32 v54, v54
    v_smfmac_f32_32x32x32_bf16 a[0:15], v[28:31], v[44:51], v6
    v_exp_f32 v55, v55
    v_exp_f32 v56, v56
    v_exp_f32 v57, v57
    v_exp_f32 v58, v58
    v_exp_f32 v59, v59
    v_exp_f32 v60, v60
    v_exp_f32 v61, v61
    v_smfmac_f32_32x32x32_bf16 a[0:15], v[32:35], v[52:59], v6
    v_exp_f32 v62, v62
    v_exp_f32 v63, v63
    v_exp_f32 v64, v64
    s_waitcnt lgkmcnt(0)
    v_mfma_f32_32x32x16_bf16 v[44:59], v[24:27], v[12:15], v[76:91]
    v_exp_f32 v65, v65
    v_exp_f32 v66, v66
    v_exp_f32 v67, v67
    v_exp_f32 v68, v68
    v_exp_f32 v69, v69
    v_exp_f32 v70, v70
    v_smfmac_f32_32x32x32_bf16 a[16:31], v[28:31], v[60:67], v6
    v_exp_f32 v71, v71
    v_exp_f32 v72, v72
    v_exp_f32 v73, v73
    v_exp_f32 v74, v74
    v_exp_f32 v75, v75
    v_exp_f32 v44, v44
    v_exp_f32 v45, v45
    v_smfmac_f32_32x32x32_bf16 a[16:31], v[32:35], v[68:75], v6
    v_exp_f32 v46, v46
    ds_read_b128 v[20:23], v3 offset:20480
    s_mov_b64 exec, s[34:35]
    ds_read_b128 v[28:31], v3 offset:21504
    ds_read_b128 v[32:35], v3 offset:21760
    s_mov_b64 exec, -1
    v_exp_f32 v47, v47
    v_exp_f32 v48, v48
    v_mfma_f32_32x32x16_bf16 v[60:75], v[24:27], v[16:19], v[92:107]
    v_exp_f32 v49, v49
    v_exp_f32 v50, v50
    v_exp_f32 v51, v51
    v_exp_f32 v52, v52
    v_exp_f32 v53, v53
    v_exp_f32 v54, v54
    v_smfmac_f32_32x32x32_bf16 a[0:15], v[36:39], v[44:51], v6
    v_exp_f32 v55, v55
    v_exp_f32 v56, v56
    v_exp_f32 v57, v57
    v_exp_f32 v58, v58
    v_exp_f32 v59, v59
    v_exp_f32 v60, v60
    v_exp_f32 v61, v61
    v_smfmac_f32_32x32x32_bf16 a[0:15], v[40:43], v[52:59], v6
    v_exp_f32 v62, v62
    v_exp_f32 v63, v63
    v_exp_f32 v64, v64
    s_waitcnt lgkmcnt(0)
    v_mfma_f32_32x32x16_bf16 v[44:59], v[20:23], v[12:15], v[76:91]
    v_exp_f32 v65, v65
    v_exp_f32 v66, v66
    v_exp_f32 v67, v67
    v_exp_f32 v68, v68
    v_exp_f32 v69, v69
    v_exp_f32 v70, v70
    v_smfmac_f32_32x32x32_bf16 a[16:31], v[36:39], v[60:67], v6
    v_exp_f32 v71, v71
    v_exp_f32 v72, v72
    v_exp_f32 v73, v73
    v_exp_f32 v74, v74
    v_exp_f32 v75, v75
    v_exp_f32 v44, v44
    v_exp_f32 v45, v45
    v_smfmac_f32_32x32x32_bf16 a[16:31], v[40:43], v[68:75], v6
    v_exp_f32 v46, v46
    ds_read_b128 v[24:27], v3 offset:22528
    s_mov_b64 exec, s[34:35]
    ds_read_b128 v[36:39], v3 offset:23552
    ds_read_b128 v[40:43], v3 offset:23808
    s_mov_b64 exec, -1
    v_exp_f32 v47, v47
    v_exp_f32 v48, v48
    v_mfma_f32_32x32x16_bf16 v[60:75], v[20:23], v[16:19], v[92:107]
    v_exp_f32 v49, v49
    v_exp_f32 v50, v50
    v_exp_f32 v51, v51
    v_exp_f32 v52, v52
    v_exp_f32 v53, v53
    v_exp_f32 v54, v54
    v_smfmac_f32_32x32x32_bf16 a[0:15], v[28:31], v[44:51], v6
    v_exp_f32 v55, v55
    v_exp_f32 v56, v56
    v_exp_f32 v57, v57
    v_exp_f32 v58, v58
    v_exp_f32 v59, v59
    v_exp_f32 v60, v60
    v_exp_f32 v61, v61
    v_smfmac_f32_32x32x32_bf16 a[0:15], v[32:35], v[52:59], v6
    v_exp_f32 v62, v62
    v_exp_f32 v63, v63
    v_exp_f32 v64, v64
    s_waitcnt lgkmcnt(0)
    v_mfma_f32_32x32x16_bf16 v[44:59], v[24:27], v[12:15], v[76:91]
    v_exp_f32 v65, v65
    v_exp_f32 v66, v66
    v_exp_f32 v67, v67
    v_exp_f32 v68, v68
    v_exp_f32 v69, v69
    v_exp_f32 v70, v70
    v_smfmac_f32_32x32x32_bf16 a[16:31], v[28:31], v[60:67], v6
    v_exp_f32 v71, v71
    v_exp_f32 v72, v72
    v_exp_f32 v73, v73
    v_exp_f32 v74, v74
    v_exp_f32 v75, v75
    v_exp_f32 v44, v44
    v_exp_f32 v45, v45
    v_smfmac_f32_32x32x32_bf16 a[16:31], v[32:35], v[68:75], v6
    v_exp_f32 v46, v46
    ds_read_b128 v[20:23], v3 offset:24576
    s_mov_b64 exec, s[34:35]
    ds_read_b128 v[28:31], v3 offset:25600
    ds_read_b128 v[32:35], v3 offset:25856
    s_mov_b64 exec, -1
    v_exp_f32 v47, v47
    v_exp_f32 v48, v48
    v_mfma_f32_32x32x16_bf16 v[60:75], v[24:27], v[16:19], v[92:107]
    v_exp_f32 v49, v49
    v_exp_f32 v50, v50
    v_exp_f32 v51, v51
    v_exp_f32 v52, v52
    v_exp_f32 v53, v53
    v_exp_f32 v54, v54
    v_smfmac_f32_32x32x32_bf16 a[0:15], v[36:39], v[44:51], v6
    v_exp_f32 v55, v55
    v_exp_f32 v56, v56
    v_exp_f32 v57, v57
    v_exp_f32 v58, v58
    v_exp_f32 v59, v59
    v_exp_f32 v60, v60
    v_exp_f32 v61, v61
    v_smfmac_f32_32x32x32_bf16 a[0:15], v[40:43], v[52:59], v6
    v_exp_f32 v62, v62
    v_exp_f32 v63, v63
    v_exp_f32 v64, v64
    s_waitcnt lgkmcnt(0)
    v_mfma_f32_32x32x16_bf16 v[44:59], v[20:23], v[12:15], v[76:91]
    v_exp_f32 v65, v65
    v_exp_f32 v66, v66
    v_exp_f32 v67, v67
    v_exp_f32 v68, v68
    v_exp_f32 v69, v69
    v_exp_f32 v70, v70
    v_smfmac_f32_32x32x32_bf16 a[16:31], v[36:39], v[60:67], v6
    v_exp_f32 v71, v71
    v_exp_f32 v72, v72
    v_exp_f32 v73, v73
    v_exp_f32 v74, v74
    v_exp_f32 v75, v75
    v_exp_f32 v44, v44
    v_exp_f32 v45, v45
    v_smfmac_f32_32x32x32_bf16 a[16:31], v[40:43], v[68:75], v6
    v_exp_f32 v46, v46
    ds_read_b128 v[24:27], v3 offset:26624
    s_mov_b64 exec, s[34:35]
    ds_read_b128 v[36:39], v3 offset:27648
    ds_read_b128 v[40:43], v3 offset:27904
    s_mov_b64 exec, -1
    v_exp_f32 v47, v47
    v_exp_f32 v48, v48
    v_mfma_f32_32x32x16_bf16 v[60:75], v[20:23], v[16:19], v[92:107]
    v_exp_f32 v49, v49
    v_exp_f32 v50, v50
    v_exp_f32 v51, v51
    v_exp_f32 v52, v52
    v_exp_f32 v53, v53
    v_exp_f32 v54, v54
    v_smfmac_f32_32x32x32_bf16 a[0:15], v[28:31], v[44:51], v6
    v_exp_f32 v55, v55
    v_exp_f32 v56, v56
    v_exp_f32 v57, v57
    v_exp_f32 v58, v58
    v_exp_f32 v59, v59
    v_exp_f32 v60, v60
    v_exp_f32 v61, v61
    v_smfmac_f32_32x32x32_bf16 a[0:15], v[32:35], v[52:59], v6
    v_exp_f32 v62, v62
    v_exp_f32 v63, v63
    v_exp_f32 v64, v64
    s_waitcnt lgkmcnt(0)
    v_mfma_f32_32x32x16_bf16 v[44:59], v[24:27], v[12:15], v[76:91]
    v_exp_f32 v65, v65
    v_exp_f32 v66, v66
    v_exp_f32 v67, v67
    v_exp_f32 v68, v68
    v_exp_f32 v69, v69
    v_exp_f32 v70, v70
    v_smfmac_f32_32x32x32_bf16 a[16:31], v[28:31], v[60:67], v6
    v_exp_f32 v71, v71
    v_exp_f32 v72, v72
    v_exp_f32 v73, v73
    v_exp_f32 v74, v74
    v_exp_f32 v75, v75
    v_exp_f32 v44, v44
    v_exp_f32 v45, v45
    v_smfmac_f32_32x32x32_bf16 a[16:31], v[32:35], v[68:75], v6
    v_exp_f32 v46, v46
    ds_read_b128 v[20:23], v3 offset:28672
    s_mov_b64 exec, s[34:35]
    ds_read_b128 v[28:31], v3 offset:29696
    ds_read_b128 v[32:35], v3 offset:29952
    s_mov_b64 exec, -1
    v_exp_f32 v47, v47
    v_exp_f32 v48, v48
    v_mfma_f32_32x32x16_bf16 v[60:75], v[24:27], v[16:19], v[92:107]
    v_exp_f32 v49, v49
    v_exp_f32 v50, v50
    v_exp_f32 v51, v51
    v_exp_f32 v52, v52
    v_exp_f32 v53, v53
    v_exp_f32 v54, v54
    v_smfmac_f32_32x32x32_bf16 a[0:15], v[36:39], v[44:51], v6
    v_exp_f32 v55, v55
    v_exp_f32 v56, v56
    v_exp_f32 v57, v57
    v_exp_f32 v58, v58
    v_exp_f32 v59, v59
    v_exp_f32 v60, v60
    v_exp_f32 v61, v61
    v_smfmac_f32_32x32x32_bf16 a[0:15], v[40:43], v[52:59], v6
    v_exp_f32 v62, v62
    v_exp_f32 v63, v63
    v_exp_f32 v64, v64
    s_waitcnt lgkmcnt(0)
    v_mfma_f32_32x32x16_bf16 v[44:59], v[20:23], v[12:15], v[76:91]
    v_exp_f32 v65, v65
    v_exp_f32 v66, v66
    v_exp_f32 v67, v67
    v_exp_f32 v68, v68
    v_exp_f32 v69, v69
    v_exp_f32 v70, v70
    v_smfmac_f32_32x32x32_bf16 a[16:31], v[36:39], v[60:67], v6
    v_exp_f32 v71, v71
    v_exp_f32 v72, v72
    v_exp_f32 v73, v73
    v_exp_f32 v74, v74
    v_exp_f32 v75, v75
    v_exp_f32 v44, v44
    v_exp_f32 v45, v45
    v_smfmac_f32_32x32x32_bf16 a[16:31], v[40:43], v[68:75], v6
    v_exp_f32 v46, v46
    ds_read_b128 v[24:27], v3 offset:30720
    s_mov_b64 exec, s[34:35]
    ds_read_b128 v[36:39], v3 offset:31744
    ds_read_b128 v[40:43], v3 offset:32000
    s_mov_b64 exec, -1
    v_exp_f32 v47, v47
    v_exp_f32 v48, v48
    v_mfma_f32_32x32x16_bf16 v[60:75], v[20:23], v[16:19], v[92:107]
    v_exp_f32 v49, v49
    v_exp_f32 v50, v50
    v_exp_f32 v51, v51
    v_exp_f32 v52, v52
    v_exp_f32 v53, v53
    v_exp_f32 v54, v54
    v_smfmac_f32_32x32x32_bf16 a[0:15], v[28:31], v[44:51], v6
    v_exp_f32 v55, v55
    v_exp_f32 v56, v56
    v_exp_f32 v57, v57
    v_exp_f32 v58, v58
    v_exp_f32 v59, v59
    v_exp_f32 v60, v60
    v_exp_f32 v61, v61
    v_smfmac_f32_32x32x32_bf16 a[0:15], v[32:35], v[52:59], v6
    v_exp_f32 v62, v62
    v_exp_f32 v63, v63
    v_exp_f32 v64, v64
    s_waitcnt lgkmcnt(0)
    v_mfma_f32_32x32x16_bf16 v[44:59], v[24:27], v[12:15], v[76:91]
    v_exp_f32 v65, v65
    v_exp_f32 v66, v66
    v_exp_f32 v67, v67
    v_exp_f32 v68, v68
    v_exp_f32 v69, v69
    v_exp_f32 v70, v70
    v_smfmac_f32_32x32x32_bf16 a[16:31], v[28:31], v[60:67], v6
    v_exp_f32 v71, v71
    v_exp_f32 v72, v72
    v_exp_f32 v73, v73
    v_exp_f32 v74, v74
    v_exp_f32 v75, v75
    s_waitcnt vmcnt(2)
    s_barrier
    v_exp_f32 v44, v44
    v_exp_f32 v45, v45
    v_smfmac_f32_32x32x32_bf16 a[16:31], v[32:35], v[68:75], v6
    v_exp_f32 v46, v46
    ds_read_b128 v[20:23], v3 offset:32768
    s_mov_b64 exec, s[34:35]
    ds_read_b128 v[28:31], v3 offset:33792
    ds_read_b128 v[32:35], v3 offset:34048
    s_mov_b64 exec, -1
    v_exp_f32 v47, v47
    v_exp_f32 v48, v48
    v_mfma_f32_32x32x16_bf16 v[60:75], v[24:27], v[16:19], v[92:107]
    v_exp_f32 v49, v49
    v_exp_f32 v50, v50
    v_exp_f32 v51, v51
    ds_read_b64_tr_b16 a[32:33], v10 offset:0
    ds_read_b64_tr_b16 a[34:35], v10 offset:1024
    ds_read_b64_tr_b16 a[36:37], v10 offset:2048
    ds_read_b64_tr_b16 a[38:39], v10 offset:3072
    v_exp_f32 v52, v52
    v_exp_f32 v53, v53
    v_exp_f32 v54, v54
    v_smfmac_f32_32x32x32_bf16 a[0:15], v[36:39], v[44:51], v6
    v_exp_f32 v55, v55
    v_exp_f32 v56, v56
    v_exp_f32 v57, v57
    v_exp_f32 v58, v58
    v_exp_f32 v59, v59
    v_exp_f32 v60, v60
    v_exp_f32 v61, v61
    v_smfmac_f32_32x32x32_bf16 a[0:15], v[40:43], v[52:59], v6
    v_exp_f32 v62, v62
    v_exp_f32 v63, v63
    v_exp_f32 v64, v64
    s_waitcnt lgkmcnt(0)
    v_mfma_f32_32x32x16_bf16 v[44:59], v[20:23], v[12:15], v[76:91]
    v_exp_f32 v65, v65
    v_exp_f32 v66, v66
    v_exp_f32 v67, v67
    v_exp_f32 v68, v68
    v_exp_f32 v69, v69
    v_exp_f32 v70, v70
    v_smfmac_f32_32x32x32_bf16 a[16:31], v[36:39], v[60:67], v6
    v_exp_f32 v71, v71
    v_exp_f32 v72, v72
    v_exp_f32 v73, v73
    v_exp_f32 v74, v74
    v_exp_f32 v75, v75
    v_exp_f32 v44, v44
    v_exp_f32 v45, v45
    v_smfmac_f32_32x32x32_bf16 a[16:31], v[40:43], v[68:75], v6
    v_exp_f32 v46, v46
    ds_read_b128 v[24:27], v3 offset:34816
    s_mov_b64 exec, s[34:35]
    ds_read_b128 v[36:39], v3 offset:35840
    ds_read_b128 v[40:43], v3 offset:36096
    s_mov_b64 exec, -1
    v_exp_f32 v47, v47
    v_exp_f32 v48, v48
    v_mfma_f32_32x32x16_bf16 v[60:75], v[20:23], v[16:19], v[92:107]
    v_exp_f32 v49, v49
    v_exp_f32 v50, v50
    v_exp_f32 v51, v51
    buffer_store_dwordx4 a[32:35], v2, s[12:15], s94 offen offset:0 sc1
    v_mfma_f32_16x16x32_bf16 v[112:115], v[108:111], a[32:35], 0
    buffer_store_dwordx4 a[36:39], v2, s[12:15], s94 offen offset:1024 sc1
    v_mfma_f32_16x16x32_bf16 v[112:115], v[108:111], a[36:39], v[112:115]
    v_exp_f32 v52, v52
    v_exp_f32 v53, v53
    v_exp_f32 v54, v54
    v_smfmac_f32_32x32x32_bf16 a[0:15], v[28:31], v[44:51], v6
    v_exp_f32 v55, v55
    v_exp_f32 v56, v56
    v_exp_f32 v57, v57
    v_exp_f32 v58, v58
    v_exp_f32 v59, v59
    v_exp_f32 v60, v60
    v_exp_f32 v61, v61
    v_smfmac_f32_32x32x32_bf16 a[0:15], v[32:35], v[52:59], v6
    v_exp_f32 v62, v62
    v_exp_f32 v63, v63
    v_exp_f32 v64, v64
    s_waitcnt lgkmcnt(0)
    v_mfma_f32_32x32x16_bf16 v[44:59], v[24:27], v[12:15], v[76:91]
    v_exp_f32 v65, v65
    v_exp_f32 v66, v66
    v_exp_f32 v67, v67
    v_exp_f32 v68, v68
    v_exp_f32 v69, v69
    v_exp_f32 v70, v70
    v_smfmac_f32_32x32x32_bf16 a[16:31], v[28:31], v[60:67], v6
    v_exp_f32 v71, v71
    v_exp_f32 v72, v72
    v_exp_f32 v73, v73
    v_exp_f32 v74, v74
    v_exp_f32 v75, v75
    v_exp_f32 v44, v44
    v_exp_f32 v45, v45
    v_smfmac_f32_32x32x32_bf16 a[16:31], v[32:35], v[68:75], v6
    v_exp_f32 v46, v46
    ds_read_b128 v[20:23], v3 offset:36864
    s_mov_b64 exec, s[34:35]
    ds_read_b128 v[28:31], v3 offset:37888
    ds_read_b128 v[32:35], v3 offset:38144
    s_mov_b64 exec, -1
    v_exp_f32 v47, v47
    v_exp_f32 v48, v48
    v_mfma_f32_32x32x16_bf16 v[60:75], v[24:27], v[16:19], v[92:107]
    v_exp_f32 v49, v49
    v_exp_f32 v50, v50
    v_exp_f32 v51, v51
    v_lshlrev_b32 v4, 2, v1
    s_mov_b64 exec, 0xffff
    buffer_store_dword v112, v4, s[12:15], s95 offen sc1
    buffer_store_dword v113, v4, s[12:15], s95 offen offset:64 sc1
    s_mov_b64 exec, -1
    v_exp_f32 v52, v52
    v_exp_f32 v53, v53
    v_exp_f32 v54, v54
    v_smfmac_f32_32x32x32_bf16 a[0:15], v[36:39], v[44:51], v6
    v_exp_f32 v55, v55
    v_exp_f32 v56, v56
    v_exp_f32 v57, v57
    v_exp_f32 v58, v58
    v_exp_f32 v59, v59
    v_exp_f32 v60, v60
    v_exp_f32 v61, v61
    v_smfmac_f32_32x32x32_bf16 a[0:15], v[40:43], v[52:59], v6
    v_exp_f32 v62, v62
    v_exp_f32 v63, v63
    v_exp_f32 v64, v64
    s_waitcnt lgkmcnt(0)
    v_mfma_f32_32x32x16_bf16 v[44:59], v[20:23], v[12:15], v[76:91]
    v_exp_f32 v65, v65
    v_exp_f32 v66, v66
    v_exp_f32 v67, v67
    v_exp_f32 v68, v68
    v_exp_f32 v69, v69
    v_exp_f32 v70, v70
    v_smfmac_f32_32x32x32_bf16 a[16:31], v[36:39], v[60:67], v6
    v_exp_f32 v71, v71
    v_exp_f32 v72, v72
    v_exp_f32 v73, v73
    v_exp_f32 v74, v74
    v_exp_f32 v75, v75
    v_exp_f32 v44, v44
    v_exp_f32 v45, v45
    v_smfmac_f32_32x32x32_bf16 a[16:31], v[40:43], v[68:75], v6
    v_exp_f32 v46, v46
    ds_read_b128 v[24:27], v3 offset:38912
    s_mov_b64 exec, s[34:35]
    ds_read_b128 v[36:39], v3 offset:39936
    ds_read_b128 v[40:43], v3 offset:40192
    s_mov_b64 exec, -1
    v_exp_f32 v47, v47
    v_exp_f32 v48, v48
    v_mfma_f32_32x32x16_bf16 v[60:75], v[20:23], v[16:19], v[92:107]
    v_exp_f32 v49, v49
    v_exp_f32 v50, v50
    v_exp_f32 v51, v51
    v_exp_f32 v52, v52
    v_exp_f32 v53, v53
    v_exp_f32 v54, v54
    v_smfmac_f32_32x32x32_bf16 a[0:15], v[28:31], v[44:51], v6
    v_exp_f32 v55, v55
    v_exp_f32 v56, v56
    v_exp_f32 v57, v57
    v_exp_f32 v58, v58
    v_exp_f32 v59, v59
    v_exp_f32 v60, v60
    v_exp_f32 v61, v61
    v_smfmac_f32_32x32x32_bf16 a[0:15], v[32:35], v[52:59], v6
    v_exp_f32 v62, v62
    v_exp_f32 v63, v63
    v_exp_f32 v64, v64
    s_waitcnt lgkmcnt(0)
    v_mfma_f32_32x32x16_bf16 v[44:59], v[24:27], v[12:15], v[76:91]
    v_exp_f32 v65, v65
    v_exp_f32 v66, v66
    v_exp_f32 v67, v67
    v_exp_f32 v68, v68
    v_exp_f32 v69, v69
    v_exp_f32 v70, v70
    v_smfmac_f32_32x32x32_bf16 a[16:31], v[28:31], v[60:67], v6
    v_exp_f32 v71, v71
    v_exp_f32 v72, v72
    v_exp_f32 v73, v73
    v_exp_f32 v74, v74
    v_exp_f32 v75, v75
    v_exp_f32 v44, v44
    v_exp_f32 v45, v45
    v_smfmac_f32_32x32x32_bf16 a[16:31], v[32:35], v[68:75], v6
    v_exp_f32 v46, v46
    ds_read_b128 v[20:23], v3 offset:40960
    s_mov_b64 exec, s[34:35]
    ds_read_b128 v[28:31], v3 offset:41984
    ds_read_b128 v[32:35], v3 offset:42240
    s_mov_b64 exec, -1
    v_exp_f32 v47, v47
    v_exp_f32 v48, v48
    v_mfma_f32_32x32x16_bf16 v[60:75], v[24:27], v[16:19], v[92:107]
    v_exp_f32 v49, v49
    v_exp_f32 v50, v50
    v_exp_f32 v51, v51
    v_exp_f32 v52, v52
    v_exp_f32 v53, v53
    v_exp_f32 v54, v54
    v_smfmac_f32_32x32x32_bf16 a[0:15], v[36:39], v[44:51], v6
    v_exp_f32 v55, v55
    v_exp_f32 v56, v56
    v_exp_f32 v57, v57
    v_exp_f32 v58, v58
    v_exp_f32 v59, v59
    v_exp_f32 v60, v60
    v_exp_f32 v61, v61
    v_smfmac_f32_32x32x32_bf16 a[0:15], v[40:43], v[52:59], v6
    v_exp_f32 v62, v62
    v_exp_f32 v63, v63
    v_exp_f32 v64, v64
    s_waitcnt lgkmcnt(0)
    v_mfma_f32_32x32x16_bf16 v[44:59], v[20:23], v[12:15], v[76:91]
    v_exp_f32 v65, v65
    v_exp_f32 v66, v66
    v_exp_f32 v67, v67
    s_mul_i32 s27, s33, 3221258240
    s_add_u32 s27, s27, s38
    s_add_u32 s27, s27, 0x40000000
    buffer_load_dwordx4 a[48:51], v116, s[60:63], s27 offen offset:0
    buffer_load_dwordx4 a[52:55], v117, s[60:63], s27 offen offset:1024
    v_exp_f32 v68, v68
    v_exp_f32 v69, v69
    v_exp_f32 v70, v70
    v_smfmac_f32_32x32x32_bf16 a[16:31], v[36:39], v[60:67], v6
    v_exp_f32 v71, v71
    v_exp_f32 v72, v72
    v_exp_f32 v73, v73
    v_exp_f32 v74, v74
    v_exp_f32 v75, v75
    v_exp_f32 v44, v44
    v_exp_f32 v45, v45
    v_smfmac_f32_32x32x32_bf16 a[16:31], v[40:43], v[68:75], v6
    v_exp_f32 v46, v46
    ds_read_b128 v[24:27], v3 offset:43008
    s_mov_b64 exec, s[34:35]
    ds_read_b128 v[36:39], v3 offset:44032
    ds_read_b128 v[40:43], v3 offset:44288
    s_mov_b64 exec, -1
    v_exp_f32 v47, v47
    v_exp_f32 v48, v48
    v_mfma_f32_32x32x16_bf16 v[60:75], v[20:23], v[16:19], v[92:107]
    v_exp_f32 v49, v49
    v_exp_f32 v50, v50
    v_exp_f32 v51, v51
    v_exp_f32 v52, v52
    v_exp_f32 v53, v53
    v_exp_f32 v54, v54
    v_smfmac_f32_32x32x32_bf16 a[0:15], v[28:31], v[44:51], v6
    v_exp_f32 v55, v55
    v_exp_f32 v56, v56
    v_exp_f32 v57, v57
    v_exp_f32 v58, v58
    v_exp_f32 v59, v59
    v_exp_f32 v60, v60
    v_exp_f32 v61, v61
    v_smfmac_f32_32x32x32_bf16 a[0:15], v[32:35], v[52:59], v6
    v_exp_f32 v62, v62
    v_exp_f32 v63, v63
    v_exp_f32 v64, v64
    s_waitcnt lgkmcnt(0)
    v_mfma_f32_32x32x16_bf16 v[44:59], v[24:27], v[12:15], v[76:91]
    v_exp_f32 v65, v65
    v_exp_f32 v66, v66
    v_exp_f32 v67, v67
    s_mul_i32 s27, s33, 3221274624
    s_add_u32 s27, s27, s38
    s_add_u32 s27, s27, 0x40000000
    buffer_load_dwordx4 a[56:59], v116, s[60:63], s27 offen offset:0
    buffer_load_dwordx4 a[60:63], v117, s[60:63], s27 offen offset:1024
    v_exp_f32 v68, v68
    v_exp_f32 v69, v69
    v_exp_f32 v70, v70
    v_smfmac_f32_32x32x32_bf16 a[16:31], v[28:31], v[60:67], v6
    v_exp_f32 v71, v71
    v_exp_f32 v72, v72
    v_exp_f32 v73, v73
    v_exp_f32 v74, v74
    v_exp_f32 v75, v75
    v_exp_f32 v44, v44
    v_exp_f32 v45, v45
    v_smfmac_f32_32x32x32_bf16 a[16:31], v[32:35], v[68:75], v6
    v_exp_f32 v46, v46
    ds_read_b128 v[20:23], v3 offset:45056
    s_mov_b64 exec, s[34:35]
    ds_read_b128 v[28:31], v3 offset:46080
    ds_read_b128 v[32:35], v3 offset:46336
    s_mov_b64 exec, -1
    v_exp_f32 v47, v47
    v_exp_f32 v48, v48
    v_mfma_f32_32x32x16_bf16 v[60:75], v[24:27], v[16:19], v[92:107]
    v_exp_f32 v49, v49
    v_exp_f32 v50, v50
    v_exp_f32 v51, v51
    v_exp_f32 v52, v52
    v_exp_f32 v53, v53
    v_exp_f32 v54, v54
    v_smfmac_f32_32x32x32_bf16 a[0:15], v[36:39], v[44:51], v6
    v_exp_f32 v55, v55
    v_exp_f32 v56, v56
    v_exp_f32 v57, v57
    v_exp_f32 v58, v58
    v_exp_f32 v59, v59
    v_exp_f32 v60, v60
    v_exp_f32 v61, v61
    v_smfmac_f32_32x32x32_bf16 a[0:15], v[40:43], v[52:59], v6
    v_exp_f32 v62, v62
    v_exp_f32 v63, v63
    v_exp_f32 v64, v64
    s_waitcnt lgkmcnt(0)
    v_mfma_f32_32x32x16_bf16 v[44:59], v[20:23], v[12:15], v[76:91]
    v_exp_f32 v65, v65
    v_exp_f32 v66, v66
    v_exp_f32 v67, v67
    s_mul_i32 s27, s33, 147456
    s_add_u32 s27, s27, s38
    s_add_u32 s27, s27, 0x0
    buffer_load_dwordx4 a[64:67], v116, s[60:63], s27 offen offset:0
    buffer_load_dwordx4 a[68:71], v117, s[60:63], s27 offen offset:1024
    v_exp_f32 v68, v68
    v_exp_f32 v69, v69
    v_exp_f32 v70, v70
    v_smfmac_f32_32x32x32_bf16 a[16:31], v[36:39], v[60:67], v6
    v_exp_f32 v71, v71
    v_exp_f32 v72, v72
    v_exp_f32 v73, v73
    v_exp_f32 v74, v74
    v_exp_f32 v75, v75
    v_exp_f32 v44, v44
    v_exp_f32 v45, v45
    v_smfmac_f32_32x32x32_bf16 a[16:31], v[40:43], v[68:75], v6
    v_exp_f32 v46, v46
    ds_read_b128 v[24:27], v3 offset:47104
    s_mov_b64 exec, s[34:35]
    ds_read_b128 v[36:39], v3 offset:48128
    ds_read_b128 v[40:43], v3 offset:48384
    s_mov_b64 exec, -1
    v_exp_f32 v47, v47
    v_exp_f32 v48, v48
    v_mfma_f32_32x32x16_bf16 v[60:75], v[20:23], v[16:19], v[92:107]
    v_exp_f32 v49, v49
    v_exp_f32 v50, v50
    v_exp_f32 v51, v51
    v_exp_f32 v52, v52
    v_exp_f32 v53, v53
    v_exp_f32 v54, v54
    v_smfmac_f32_32x32x32_bf16 a[0:15], v[28:31], v[44:51], v6
    v_exp_f32 v55, v55
    v_exp_f32 v56, v56
    v_exp_f32 v57, v57
    v_exp_f32 v58, v58
    v_exp_f32 v59, v59
    v_exp_f32 v60, v60
    v_exp_f32 v61, v61
    v_smfmac_f32_32x32x32_bf16 a[0:15], v[32:35], v[52:59], v6
    v_exp_f32 v62, v62
    v_exp_f32 v63, v63
    v_exp_f32 v64, v64
    s_waitcnt lgkmcnt(0)
    v_mfma_f32_32x32x16_bf16 v[44:59], v[24:27], v[12:15], v[76:91]
    v_exp_f32 v65, v65
    v_exp_f32 v66, v66
    v_exp_f32 v67, v67
    s_mul_i32 s27, s33, 147456
    s_add_u32 s27, s27, s38
    s_add_u32 s27, s27, 0x4000
    buffer_load_dwordx4 a[72:75], v116, s[60:63], s27 offen offset:0
    buffer_load_dwordx4 a[76:79], v117, s[60:63], s27 offen offset:1024
    v_exp_f32 v68, v68
    v_exp_f32 v69, v69
    v_exp_f32 v70, v70
    v_smfmac_f32_32x32x32_bf16 a[16:31], v[28:31], v[60:67], v6
    v_exp_f32 v71, v71
    v_exp_f32 v72, v72
    v_exp_f32 v73, v73
    v_exp_f32 v74, v74
    v_exp_f32 v75, v75
    s_waitcnt vmcnt(8)
    s_barrier
    v_exp_f32 v44, v44
    v_exp_f32 v45, v45
    v_smfmac_f32_32x32x32_bf16 a[16:31], v[32:35], v[68:75], v6
    v_exp_f32 v46, v46
    ds_read_b128 v[20:23], v3 offset:49152
    s_mov_b64 exec, s[34:35]
    ds_read_b128 v[28:31], v3 offset:50176
    ds_read_b128 v[32:35], v3 offset:50432
    s_mov_b64 exec, -1
    v_exp_f32 v47, v47
    v_exp_f32 v48, v48
    v_mfma_f32_32x32x16_bf16 v[60:75], v[24:27], v[16:19], v[92:107]
    v_exp_f32 v49, v49
    v_exp_f32 v50, v50
    v_exp_f32 v51, v51
    v_exp_f32 v52, v52
    v_exp_f32 v53, v53
    v_exp_f32 v54, v54
    v_smfmac_f32_32x32x32_bf16 a[0:15], v[36:39], v[44:51], v6
    v_exp_f32 v55, v55
    v_exp_f32 v56, v56
    v_exp_f32 v57, v57
    v_exp_f32 v58, v58
    v_exp_f32 v59, v59
    v_exp_f32 v60, v60
    v_exp_f32 v61, v61
    v_smfmac_f32_32x32x32_bf16 a[0:15], v[40:43], v[52:59], v6
    v_exp_f32 v62, v62
    v_exp_f32 v63, v63
    v_exp_f32 v64, v64
    s_waitcnt lgkmcnt(0)
    v_mfma_f32_32x32x16_bf16 v[44:59], v[20:23], v[12:15], v[76:91]
    v_exp_f32 v65, v65
    v_exp_f32 v66, v66
    v_exp_f32 v67, v67
    v_mov_b32 v5, 1
    v_mov_b32 v4, 0
    buffer_store_dword v5, v4, s[12:15], s99 offen sc1
    v_exp_f32 v68, v68
    v_exp_f32 v69, v69
    v_exp_f32 v70, v70
    v_smfmac_f32_32x32x32_bf16 a[16:31], v[36:39], v[60:67], v6
    v_exp_f32 v71, v71
    v_exp_f32 v72, v72
    v_exp_f32 v73, v73
    v_exp_f32 v74, v74
    v_exp_f32 v75, v75
    v_exp_f32 v44, v44
    v_exp_f32 v45, v45
    v_smfmac_f32_32x32x32_bf16 a[16:31], v[40:43], v[68:75], v6
    v_exp_f32 v46, v46
    ds_read_b128 v[24:27], v3 offset:51200
    s_mov_b64 exec, s[34:35]
    ds_read_b128 v[36:39], v3 offset:52224
    ds_read_b128 v[40:43], v3 offset:52480
    s_mov_b64 exec, -1
    v_exp_f32 v47, v47
    v_exp_f32 v48, v48
    v_mfma_f32_32x32x16_bf16 v[60:75], v[20:23], v[16:19], v[92:107]
    v_exp_f32 v49, v49
    v_exp_f32 v50, v50
    v_exp_f32 v51, v51
    s_mul_i32 s27, s33, 196608
    s_add_u32 s27, s27, s38
    s_add_u32 s27, s27, 0x10000
    buffer_load_dwordx4 a[80:83], v116, s[60:63], s27 offen offset:0
    buffer_load_dwordx4 a[84:87], v117, s[60:63], s27 offen offset:1024
    v_exp_f32 v52, v52
    v_exp_f32 v53, v53
    v_exp_f32 v54, v54
    v_smfmac_f32_32x32x32_bf16 a[0:15], v[28:31], v[44:51], v6
    v_exp_f32 v55, v55
    v_exp_f32 v56, v56
    v_exp_f32 v57, v57
    v_exp_f32 v58, v58
    v_exp_f32 v59, v59
    v_exp_f32 v60, v60
    v_exp_f32 v61, v61
    v_smfmac_f32_32x32x32_bf16 a[0:15], v[32:35], v[52:59], v6
    v_exp_f32 v62, v62
    v_exp_f32 v63, v63
    v_exp_f32 v64, v64
    s_waitcnt lgkmcnt(0)
    v_mfma_f32_32x32x16_bf16 v[44:59], v[24:27], v[12:15], v[76:91]
    v_exp_f32 v65, v65
    v_exp_f32 v66, v66
    v_exp_f32 v67, v67
    v_exp_f32 v68, v68
    v_exp_f32 v69, v69
    v_exp_f32 v70, v70
    v_smfmac_f32_32x32x32_bf16 a[16:31], v[28:31], v[60:67], v6
    v_exp_f32 v71, v71
    v_exp_f32 v72, v72
    v_exp_f32 v73, v73
    v_exp_f32 v74, v74
    v_exp_f32 v75, v75
    v_exp_f32 v44, v44
    v_exp_f32 v45, v45
    v_smfmac_f32_32x32x32_bf16 a[16:31], v[32:35], v[68:75], v6
    v_exp_f32 v46, v46
    ds_read_b128 v[20:23], v3 offset:53248
    s_mov_b64 exec, s[34:35]
    ds_read_b128 v[28:31], v3 offset:54272
    ds_read_b128 v[32:35], v3 offset:54528
    s_mov_b64 exec, -1
    v_exp_f32 v47, v47
    v_exp_f32 v48, v48
    v_mfma_f32_32x32x16_bf16 v[60:75], v[24:27], v[16:19], v[92:107]
    v_exp_f32 v49, v49
    v_exp_f32 v50, v50
    v_exp_f32 v51, v51
    s_mul_i32 s27, s33, 196608
    s_add_u32 s27, s27, s38
    s_add_u32 s27, s27, 0x14000
    buffer_load_dwordx4 a[88:91], v116, s[60:63], s27 offen offset:0
    buffer_load_dwordx4 a[92:95], v117, s[60:63], s27 offen offset:1024
    v_exp_f32 v52, v52
    v_exp_f32 v53, v53
    v_exp_f32 v54, v54
    v_smfmac_f32_32x32x32_bf16 a[0:15], v[36:39], v[44:51], v6
    v_exp_f32 v55, v55
    v_exp_f32 v56, v56
    v_exp_f32 v57, v57
    v_exp_f32 v58, v58
    v_exp_f32 v59, v59
    v_exp_f32 v60, v60
    v_exp_f32 v61, v61
    v_smfmac_f32_32x32x32_bf16 a[0:15], v[40:43], v[52:59], v6
    v_exp_f32 v62, v62
    v_exp_f32 v63, v63
    v_exp_f32 v64, v64
    s_waitcnt lgkmcnt(0)
    v_mfma_f32_32x32x16_bf16 v[44:59], v[20:23], v[12:15], v[76:91]
    v_exp_f32 v65, v65
    v_exp_f32 v66, v66
    v_exp_f32 v67, v67
    v_exp_f32 v68, v68
    v_exp_f32 v69, v69
    v_exp_f32 v70, v70
    v_smfmac_f32_32x32x32_bf16 a[16:31], v[36:39], v[60:67], v6
    v_exp_f32 v71, v71
    v_exp_f32 v72, v72
    v_exp_f32 v73, v73
    v_exp_f32 v74, v74
    v_exp_f32 v75, v75
    v_exp_f32 v44, v44
    v_exp_f32 v45, v45
    v_smfmac_f32_32x32x32_bf16 a[16:31], v[40:43], v[68:75], v6
    v_exp_f32 v46, v46
    ds_read_b128 v[24:27], v3 offset:55296
    s_mov_b64 exec, s[34:35]
    ds_read_b128 v[36:39], v3 offset:56320
    ds_read_b128 v[40:43], v3 offset:56576
    s_mov_b64 exec, -1
    v_exp_f32 v47, v47
    v_exp_f32 v48, v48
    v_mfma_f32_32x32x16_bf16 v[60:75], v[20:23], v[16:19], v[92:107]
    v_exp_f32 v49, v49
    v_exp_f32 v50, v50
    v_exp_f32 v51, v51
    s_mul_i32 s27, s33, 245760
    s_add_u32 s27, s27, s38
    s_add_u32 s27, s27, 0x20000
    buffer_load_dwordx4 a[96:99], v116, s[60:63], s27 offen offset:0
    buffer_load_dwordx4 a[100:103], v117, s[60:63], s27 offen offset:1024
    v_exp_f32 v52, v52
    v_exp_f32 v53, v53
    v_exp_f32 v54, v54
    v_smfmac_f32_32x32x32_bf16 a[0:15], v[28:31], v[44:51], v6
    v_exp_f32 v55, v55
    v_exp_f32 v56, v56
    v_exp_f32 v57, v57
    v_exp_f32 v58, v58
    v_exp_f32 v59, v59
    v_exp_f32 v60, v60
    v_exp_f32 v61, v61
    v_smfmac_f32_32x32x32_bf16 a[0:15], v[32:35], v[52:59], v6
    v_exp_f32 v62, v62
    v_exp_f32 v63, v63
    v_exp_f32 v64, v64
    s_waitcnt lgkmcnt(0)
    v_mfma_f32_32x32x16_bf16 v[44:59], v[24:27], v[12:15], v[76:91]
    v_exp_f32 v65, v65
    v_exp_f32 v66, v66
    v_exp_f32 v67, v67
    v_exp_f32 v68, v68
    v_exp_f32 v69, v69
    v_exp_f32 v70, v70
    v_smfmac_f32_32x32x32_bf16 a[16:31], v[28:31], v[60:67], v6
    v_exp_f32 v71, v71
    v_exp_f32 v72, v72
    v_exp_f32 v73, v73
    v_exp_f32 v74, v74
    v_exp_f32 v75, v75
    v_exp_f32 v44, v44
    v_exp_f32 v45, v45
    v_smfmac_f32_32x32x32_bf16 a[16:31], v[32:35], v[68:75], v6
    v_exp_f32 v46, v46
    ds_read_b128 v[20:23], v3 offset:57344
    s_mov_b64 exec, s[34:35]
    ds_read_b128 v[28:31], v3 offset:58368
    ds_read_b128 v[32:35], v3 offset:58624
    s_mov_b64 exec, -1
    v_exp_f32 v47, v47
    v_exp_f32 v48, v48
    v_mfma_f32_32x32x16_bf16 v[60:75], v[24:27], v[16:19], v[92:107]
    v_exp_f32 v49, v49
    v_exp_f32 v50, v50
    v_exp_f32 v51, v51
    buffer_load_dword v11, v119, s[12:15], s98 offen sc1
    v_exp_f32 v52, v52
    v_exp_f32 v53, v53
    v_exp_f32 v54, v54
    v_smfmac_f32_32x32x32_bf16 a[0:15], v[36:39], v[44:51], v6
    v_exp_f32 v55, v55
    v_exp_f32 v56, v56
    v_exp_f32 v57, v57
    v_exp_f32 v58, v58
    v_exp_f32 v59, v59
    v_exp_f32 v60, v60
    v_exp_f32 v61, v61
    v_smfmac_f32_32x32x32_bf16 a[0:15], v[40:43], v[52:59], v6
    v_exp_f32 v62, v62
    v_exp_f32 v63, v63
    v_exp_f32 v64, v64
    s_waitcnt lgkmcnt(0)
    v_mfma_f32_32x32x16_bf16 v[44:59], v[20:23], v[12:15], v[76:91]
    v_exp_f32 v65, v65
    v_exp_f32 v66, v66
    v_exp_f32 v67, v67
    s_mul_i32 s27, s33, 245760
    s_add_u32 s27, s27, s38
    s_add_u32 s27, s27, 0x24000
    buffer_load_dwordx4 a[104:107], v116, s[60:63], s27 offen offset:0
    buffer_load_dwordx4 a[108:111], v117, s[60:63], s27 offen offset:1024
    v_exp_f32 v68, v68
    v_exp_f32 v69, v69
    v_exp_f32 v70, v70
    v_smfmac_f32_32x32x32_bf16 a[16:31], v[36:39], v[60:67], v6
    v_exp_f32 v71, v71
    v_exp_f32 v72, v72
    v_exp_f32 v73, v73
    v_exp_f32 v74, v74
    v_exp_f32 v75, v75
    v_exp_f32 v44, v44
    v_exp_f32 v45, v45
    v_smfmac_f32_32x32x32_bf16 a[16:31], v[40:43], v[68:75], v6
    v_exp_f32 v46, v46
    ds_read_b128 v[24:27], v3 offset:59392
    s_mov_b64 exec, s[34:35]
    ds_read_b128 v[36:39], v3 offset:60416
    ds_read_b128 v[40:43], v3 offset:60672
    s_mov_b64 exec, -1
    v_exp_f32 v47, v47
    v_exp_f32 v48, v48
    v_mfma_f32_32x32x16_bf16 v[60:75], v[20:23], v[16:19], v[92:107]
    v_exp_f32 v49, v49
    v_exp_f32 v50, v50
    v_exp_f32 v51, v51
    v_exp_f32 v52, v52
    v_exp_f32 v53, v53
    v_exp_f32 v54, v54
    v_smfmac_f32_32x32x32_bf16 a[0:15], v[28:31], v[44:51], v6
    v_exp_f32 v55, v55
    v_exp_f32 v56, v56
    v_exp_f32 v57, v57
    v_exp_f32 v58, v58
    v_exp_f32 v59, v59
    v_exp_f32 v60, v60
    v_exp_f32 v61, v61
    v_smfmac_f32_32x32x32_bf16 a[0:15], v[32:35], v[52:59], v6
    v_exp_f32 v62, v62
    v_exp_f32 v63, v63
    v_exp_f32 v64, v64
    s_waitcnt lgkmcnt(0)
    v_mfma_f32_32x32x16_bf16 v[44:59], v[24:27], v[12:15], v[76:91]
    v_exp_f32 v65, v65
    v_exp_f32 v66, v66
    v_exp_f32 v67, v67
    s_mul_i32 s27, s33, 4294836224
    s_add_u32 s27, s27, s38
    s_add_u32 s27, s27, 0x30000
    buffer_load_dwordx4 a[112:115], v116, s[60:63], s27 offen offset:0
    buffer_load_dwordx4 a[116:119], v117, s[60:63], s27 offen offset:1024
    v_exp_f32 v68, v68
    v_exp_f32 v69, v69
    v_exp_f32 v70, v70
    v_smfmac_f32_32x32x32_bf16 a[16:31], v[28:31], v[60:67], v6
    v_exp_f32 v71, v71
    v_exp_f32 v72, v72
    v_exp_f32 v73, v73
    v_exp_f32 v74, v74
    v_exp_f32 v75, v75
    v_exp_f32 v44, v44
    v_exp_f32 v45, v45
    v_smfmac_f32_32x32x32_bf16 a[16:31], v[32:35], v[68:75], v6
    v_exp_f32 v46, v46
    ds_read_b128 v[20:23], v3 offset:61440
    s_mov_b64 exec, s[34:35]
    ds_read_b128 v[28:31], v3 offset:62464
    ds_read_b128 v[32:35], v3 offset:62720
    s_mov_b64 exec, -1
    v_exp_f32 v47, v47
    v_exp_f32 v48, v48
    v_mfma_f32_32x32x16_bf16 v[60:75], v[24:27], v[16:19], v[92:107]
    v_exp_f32 v49, v49
    v_exp_f32 v50, v50
    v_exp_f32 v51, v51
    v_exp_f32 v52, v52
    v_exp_f32 v53, v53
    v_exp_f32 v54, v54
    v_smfmac_f32_32x32x32_bf16 a[0:15], v[36:39], v[44:51], v6
    v_exp_f32 v55, v55
    v_exp_f32 v56, v56
    v_exp_f32 v57, v57
    v_exp_f32 v58, v58
    v_exp_f32 v59, v59
    v_exp_f32 v60, v60
    v_exp_f32 v61, v61
    v_smfmac_f32_32x32x32_bf16 a[0:15], v[40:43], v[52:59], v6
    v_exp_f32 v62, v62
    v_exp_f32 v63, v63
    v_exp_f32 v64, v64
    s_waitcnt lgkmcnt(0)
    v_mfma_f32_32x32x16_bf16 v[44:59], v[20:23], v[12:15], v[76:91]
    v_exp_f32 v65, v65
    v_exp_f32 v66, v66
    v_exp_f32 v67, v67
    s_mul_i32 s27, s33, 4294836224
    s_add_u32 s27, s27, s38
    s_add_u32 s27, s27, 0x34000
    buffer_load_dwordx4 a[120:123], v116, s[60:63], s27 offen offset:0
    buffer_load_dwordx4 a[124:127], v117, s[60:63], s27 offen offset:1024
    v_exp_f32 v68, v68
    v_exp_f32 v69, v69
    v_exp_f32 v70, v70
    v_smfmac_f32_32x32x32_bf16 a[16:31], v[36:39], v[60:67], v6
    v_exp_f32 v71, v71
    v_exp_f32 v72, v72
    v_exp_f32 v73, v73
    v_exp_f32 v74, v74
    v_exp_f32 v75, v75
    v_exp_f32 v44, v44
    v_exp_f32 v45, v45
    v_smfmac_f32_32x32x32_bf16 a[16:31], v[40:43], v[68:75], v6
    v_exp_f32 v46, v46
    ds_read_b128 v[24:27], v3 offset:63488
    s_mov_b64 exec, s[34:35]
    ds_read_b128 v[36:39], v3 offset:64512
    ds_read_b128 v[40:43], v3 offset:64768
    s_mov_b64 exec, -1
    v_exp_f32 v47, v47
    v_exp_f32 v48, v48
    v_mfma_f32_32x32x16_bf16 v[60:75], v[20:23], v[16:19], v[92:107]
    v_exp_f32 v49, v49
    v_exp_f32 v50, v50
    v_exp_f32 v51, v51
    s_cmp_lg_u32 s24, 0
    s_cbranch_scc1 L_nct_8
    s_getpc_b64 s[16:17]
L_pc_9:
    s_sub_u32 s16, s16, L_pc_9-TEXT_START
    s_subb_u32 s17, s17, 0
    s_bfe_u32 s27, s2, 0x30003
    s_lshl_b32 s27, s27, 13
    v_add_u32 v112, s27, v119
    v_min_u32 v112, TEXT_END-TEXT_START-4, v112
    v_mov_b32 v113, s17
    v_add_co_u32 v112, vcc, s16, v112
    s_nop 1
    v_addc_co_u32 v113, vcc, 0, v113, vcc
    global_load_dword v11, v[112:113], off
L_nct_8:
    v_exp_f32 v52, v52
    v_exp_f32 v53, v53
    v_exp_f32 v54, v54
    v_smfmac_f32_32x32x32_bf16 a[0:15], v[28:31], v[44:51], v6
    v_exp_f32 v55, v55
    v_exp_f32 v56, v56
    v_exp_f32 v57, v57
    v_exp_f32 v58, v58
    v_exp_f32 v59, v59
    v_exp_f32 v60, v60
    v_exp_f32 v61, v61
    v_smfmac_f32_32x32x32_bf16 a[0:15], v[32:35], v[52:59], v6
    v_exp_f32 v62, v62
    v_exp_f32 v63, v63
    v_exp_f32 v64, v64
    s_waitcnt lgkmcnt(0)
    v_mfma_f32_32x32x16_bf16 v[44:59], v[24:27], v[12:15], v[76:91]
    v_exp_f32 v65, v65
    v_exp_f32 v66, v66
    v_exp_f32 v67, v67
    v_exp_f32 v68, v68
    v_exp_f32 v69, v69
    v_exp_f32 v70, v70
    v_smfmac_f32_32x32x32_bf16 a[16:31], v[28:31], v[60:67], v6
    v_exp_f32 v71, v71
    v_exp_f32 v72, v72
    v_exp_f32 v73, v73
    v_exp_f32 v74, v74
    v_exp_f32 v75, v75
    v_exp_f32 v44, v44
    v_exp_f32 v45, v45
    v_smfmac_f32_32x32x32_bf16 a[16:31], v[32:35], v[68:75], v6
    v_exp_f32 v46, v46
    v_exp_f32 v47, v47
    v_exp_f32 v48, v48
    v_mfma_f32_32x32x16_bf16 v[60:75], v[24:27], v[16:19], v[92:107]
    v_exp_f32 v49, v49
    v_exp_f32 v50, v50
    v_exp_f32 v51, v51
    v_exp_f32 v52, v52
    v_exp_f32 v53, v53
    v_exp_f32 v54, v54
    v_smfmac_f32_32x32x32_bf16 a[0:15], v[36:39], v[44:51], v6
    v_exp_f32 v55, v55
    v_exp_f32 v56, v56
    v_exp_f32 v57, v57
    v_exp_f32 v58, v58
    v_exp_f32 v59, v59
    v_exp_f32 v60, v60
    v_exp_f32 v61, v61
    v_smfmac_f32_32x32x32_bf16 a[0:15], v[40:43], v[52:59], v6
    v_exp_f32 v62, v62
    v_exp_f32 v63, v63
    v_exp_f32 v64, v64
    v_exp_f32 v65, v65
    v_exp_f32 v66, v66
    v_exp_f32 v67, v67
    v_exp_f32 v68, v68
    v_exp_f32 v69, v69
    v_exp_f32 v70, v70
    v_smfmac_f32_32x32x32_bf16 a[16:31], v[36:39], v[60:67], v6
    v_exp_f32 v71, v71
    v_exp_f32 v72, v72
    v_exp_f32 v73, v73
    v_exp_f32 v74, v74
    v_exp_f32 v75, v75
    s_nop 1
    v_smfmac_f32_32x32x32_bf16 a[16:31], v[40:43], v[68:75], v6
    s_mov_b32 s27, 0x5e800000
    s_xor_b32 s28, s24, 4
    s_mul_i32 s28, s28, 3072
    s_add_u32 s28, s28, 131072
    v_add_u32 v5, s28, v2
    v_accvgpr_read_b32 v76, a0
    v_accvgpr_read_b32 v77, a1
    v_accvgpr_read_b32 v78, a2
    v_accvgpr_read_b32 v79, a3
    v_accvgpr_read_b32 v80, a4
    v_accvgpr_read_b32 v81, a5
    v_accvgpr_read_b32 v82, a6
    v_accvgpr_read_b32 v83, a7
    v_accvgpr_read_b32 v84, a8
    ds_write_b128 v9, a[16:19]
    ds_write_b128 v9, a[20:23] offset:1024
    ds_write_b128 v9, a[24:27] offset:2048
    v_accvgpr_read_b32 v4, a24
    s_nop 0
    v_add_f32 v4, v4, v84
    v_cmp_ngt_f32 vcc, s27, v4
    s_lshl_b32 s29, s24, 2
    s_add_u32 s29, s29, 155648
    v_mov_b32 v7, s29
    s_or_b32 s29, vcc_lo, vcc_hi
    v_mov_b32 v8, s29
    ds_write_b32 v7, v8
    v_and_b32 v7, 7, v1
    v_lshlrev_b32 v7, 2, v7
    v_add_u32 v7, 155648, v7
    s_waitcnt lgkmcnt(0)
    s_barrier
    ds_read_b128 v[44:47], v5
    ds_read_b128 v[48:51], v5 offset:1024
    ds_read_b128 v[52:55], v5 offset:2048
    ds_read_b32 v8, v7
    s_lshl_b32 s28, s26, 5
    s_add_u32 s28, s28, s25
    s_waitcnt lgkmcnt(0)
    v_cmp_ne_u32 vcc, 0, v8
    s_nop 0
    s_cbranch_vccnz L_fallback_5
L_attok_6:
    v_add_f32 v84, v84, v52
    v_rcp_f32 v4, v84
    v_add_f32 v76, v76, v44
    v_add_f32 v77, v77, v45
    v_add_f32 v78, v78, v46
    v_add_f32 v79, v79, v47
    v_add_f32 v80, v80, v48
    v_add_f32 v81, v81, v49
    v_add_f32 v82, v82, v50
    v_add_f32 v83, v83, v51
    v_mul_f32 v76, v4, v76
    v_mul_f32 v77, v4, v77
    v_mul_f32 v78, v4, v78
    v_mul_f32 v79, v4, v79
    v_mul_f32 v80, v4, v80
    v_mul_f32 v81, v4, v81
    v_mul_f32 v82, v4, v82
    v_mul_f32 v83, v4, v83
    v_cvt_pk_bf16_f32 v76, v76, v77
    v_cvt_pk_bf16_f32 v77, v78, v79
    v_cvt_pk_bf16_f32 v78, v80, v81
    v_cvt_pk_bf16_f32 v79, v82, v83
    s_lshl_b32 s27, s28, 10
    s_add_u32 s27, s27, 0x600000
    buffer_store_dwordx4 v[76:79], v2, s[12:15], s27 offen sc1
    s_lshl_b32 s60, s28, 7
    s_add_u32 s60, s60, 0x11a0000
    s_barrier
    s_mov_b64 s[4:5], s[44:45]
    s_mov_b64 s[6:7], s[40:41]
    s_mov_b64 s[48:49], s[52:53]
    s_mov_b64 s[50:51], s[54:55]
    v_and_b32 v1, 63, v0
    v_lshrrev_b32 v3, 6, v0
    v_lshlrev_b32 v2, 4, v1
    v_readfirstlane_b32 s47, v3
    s_bfe_u32 s25, s2, 0x20001
    s_lshl_b32 s25, s25, 2
    s_bfe_u32 s31, s2, 0x20003
    s_or_b32 s25, s25, s31
    s_lshr_b32 s26, s2, 5
    s_and_b32 s33, s2, 1
    s_lshl_b32 s27, s33, 3
    s_or_b32 s27, s27, s26
    s_and_b32 s24, s47, 3
    s_and_b32 s28, s24, 1
    s_lshr_b32 s29, s24, 1
    s_lshl_b32 s55, s25, 2
    s_lshl_b32 s33, s33, 1
    s_add_u32 s30, s55, s33
    s_add_u32 s30, s30, s28
    s_add_u32 s55, s55, s24
    s_cmp_lt_u32 s47, 4
    s_cbranch_scc1 L_cprog_10
    v_lshrrev_b32 v3, 3, v1
    v_lshlrev_b32 v3, 10, v3
    v_and_b32 v4, 7, v1
    v_bfe_u32 v5, v1, 4, 1
    v_lshlrev_b32 v5, 2, v5
    v_xor_b32 v4, v4, v5
    v_lshl_add_u32 v3, v4, 4, v3
    s_lshl_b32 s32, s26, 7
    v_add_u32 v6, s32, v3
    v_add_u32 v7, 7168, v6
    s_lshl_b32 s36, s29, 13
    s_lshl_b32 s32, s28, 12
    s_add_u32 s36, s36, s32
    s_lshl_b32 s46, s24, 10
    s_lshl_b32 s52, s29, 18
    s_lshl_b32 s31, s28, 15
    s_add_u32 s52, s52, s31
    s_mul_i32 s53, s29, 917504
    s_mul_i32 s31, s28, 458752
    s_add_u32 s53, s53, s31
    s_mul_i32 s44, s27, 229376
    s_add_u32 s44, s44, s46
    s_add_u32 s44, s44, 0x1400000
    s_waitcnt lgkmcnt(0)
    s_mov_b32 s12, s8
    s_mov_b32 s13, s9
    s_mov_b32 s14, 0x1800000
    s_mov_b32 s15, 0x00020000
    s_mov_b32 s16, s4
    s_mov_b32 s17, s5
    s_mov_b32 s18, 0x80000
    s_mov_b32 s19, 0x00020000
    s_mov_b32 s40, s6
    s_mov_b32 s41, s7
    s_mov_b32 s42, 0x200000
    s_mov_b32 s43, 0x00020000
    s_mov_b32 s20, s48
    s_mov_b32 s21, s49
    s_mov_b32 s22, 0x1c0000
    s_mov_b32 s23, 0x00020000
    v_add_u32 v72, s36, v2
    v_add_u32 v73, 0x10000, v72
    v_add_u32 v74, 0x20000, v72
    s_mul_i32 s31, s27, 7
    s_lshr_b32 s31, s31, 2
    s_lshl_b32 s31, s31, 3
    v_min_u32 v3, 23, v1
    v_add_u32 v3, s31, v3
    v_min_u32 v3, 223, v3
    v_lshlrev_b32 v9, 7, v3
    s_mov_b32 s33, 0x11e0000
    buffer_load_dword v8, v9, s[12:15], s33 offen sc1
    v_lshrrev_b32 v3, 3, v1
    v_lshlrev_b32 v3, 10, v3
    v_and_b32 v4, 7, v1
    v_lshrrev_b32 v5, 4, v1
    v_xor_b32 v4, v4, v5
    v_lshl_add_u32 v3, v4, 4, v3
    v_xor_b32 v4, 64, v3
    v_add_u32 v4, 7168, v4
    s_lshr_b32 s31, s30, 1
    s_lshl_b32 s31, s31, 16
    s_lshl_b32 s32, s24, 14
    s_add_u32 s31, s31, s32
    s_lshl_b32 s32, s26, 7
    s_add_u32 s31, s31, s32
    s_lshl_b32 s32, s24, 11
    s_add_u32 m0, s32, 147456
    s_nop 0
    buffer_load_dwordx4 v3, s[40:43], s31 offen lds
    buffer_load_dwordx4 v4, s[40:43], s31 offen offset:1024 lds
    s_waitcnt vmcnt(0)
    v_mov_b32 v10, 1
    v_mov_b32 v11, 0
    s_mov_b64 exec, 1
    buffer_store_dword v10, v11, s[12:15], s60 offen sc1
    s_mov_b64 exec, -1
    s_barrier
    s_mov_b32 s47, 0x20000
L_pspin_12:
    v_cmp_ne_u32 vcc, 1, v8
    s_sub_u32 s47, s47, 1
    s_cbranch_scc1 L_pok_13
    s_cbranch_vccz L_pok_13
    buffer_load_dword v8, v9, s[12:15], s33 offen sc1
    s_waitcnt vmcnt(0)
    s_branch L_pspin_12
L_pok_13:
    s_add_u32 m0, s46, 0
    s_add_u32 s35, s44, 0x0
    buffer_load_dwordx4 v2, s[12:15], s35 offen sc1 lds
    s_add_u32 m0, s46, 4096
    s_add_u32 s35, s44, 0x1000
    buffer_load_dwordx4 v2, s[12:15], s35 offen sc1 lds
    s_add_u32 m0, s46, 8192
    s_add_u32 s35, s44, 0x2000
    buffer_load_dwordx4 v2, s[12:15], s35 offen sc1 lds
    s_add_u32 m0, s46, 12288
    s_add_u32 s35, s44, 0x3000
    buffer_load_dwordx4 v2, s[12:15], s35 offen sc1 lds
    s_add_u32 m0, s46, 16384
    s_add_u32 s35, s44, 0x4000
    buffer_load_dwordx4 v2, s[12:15], s35 offen sc1 lds
    s_add_u32 m0, s46, 20480
    s_add_u32 s35, s44, 0x5000
    buffer_load_dwordx4 v2, s[12:15], s35 offen sc1 lds
    s_add_u32 m0, s46, 24576
    s_add_u32 s35, s44, 0x6000
    buffer_load_dwordx4 v2, s[12:15], s35 offen sc1 lds
    s_add_u32 m0, s46, 28672
    s_add_u32 s35, s44, 0x7000
    buffer_load_dwordx4 v2, s[12:15], s35 offen sc1 lds
    s_mul_i32 s31, s27, 896
    s_add_u32 s31, s31, 0x1310000
    s_cmp_eq_u32 s24, 0
    s_cselect_b32 s31, s31, 0x40000000
    buffer_load_dwordx4 v[8:11], v2, s[12:15], s31 offen sc1
    s_add_u32 s31, s31, 14336
    buffer_load_dwordx4 v[12:15], v2, s[12:15], s31 offen sc1
    s_add_u32 s31, s31, 14336
    buffer_load_dwordx4 v[16:19], v2, s[12:15], s31 offen sc1
    s_add_u32 s31, s31, 14336
    buffer_load_dwordx4 v[20:23], v2, s[12:15], s31 offen sc1
    s_add_u32 s31, s31, 14336
    buffer_load_dwordx4 v[24:27], v2, s[12:15], s31 offen sc1
    s_add_u32 s31, s31, 14336
    buffer_load_dwordx4 v[28:31], v2, s[12:15], s31 offen sc1
    s_add_u32 s31, s31, 14336
    buffer_load_dwordx4 v[32:35], v2, s[12:15], s31 offen sc1
    s_add_u32 s31, s31, 14336
    buffer_load_dwordx4 v[36:39], v2, s[12:15], s31 offen sc1
    s_add_u32 s31, s31, 14336
    buffer_load_dwordx4 v[40:43], v2, s[12:15], s31 offen sc1
    s_add_u32 s31, s31, 14336
    buffer_load_dwordx4 v[44:47], v2, s[12:15], s31 offen sc1
    s_add_u32 s31, s31, 14336
    buffer_load_dwordx4 v[48:51], v2, s[12:15], s31 offen sc1
    s_add_u32 s31, s31, 14336
    buffer_load_dwordx4 v[52:55], v2, s[12:15], s31 offen sc1
    s_add_u32 s31, s31, 14336
    buffer_load_dwordx4 v[56:59], v2, s[12:15], s31 offen sc1
    s_add_u32 s31, s31, 14336
    buffer_load_dwordx4 v[60:63], v2, s[12:15], s31 offen sc1
    s_add_u32 s31, s31, 14336
    buffer_load_dwordx4 v[64:67], v2, s[12:15], s31 offen sc1
    s_add_u32 s31, s31, 14336
    buffer_load_dwordx4 v[68:71], v2, s[12:15], s31 offen sc1
    s_add_u32 m0, s46, 32768
    s_add_u32 s35, s44, 0x8000
    buffer_load_dwordx4 v2, s[12:15], s35 offen sc1 lds
    s_add_u32 m0, s46, 36864
    s_add_u32 s35, s44, 0x9000
    buffer_load_dwordx4 v2, s[12:15], s35 offen sc1 lds
    s_add_u32 m0, s46, 40960
    s_add_u32 s35, s44, 0xa000
    buffer_load_dwordx4 v2, s[12:15], s35 offen sc1 lds
    s_add_u32 m0, s46, 45056
    s_add_u32 s35, s44, 0xb000
    buffer_load_dwordx4 v2, s[12:15], s35 offen sc1 lds
    s_add_u32 m0, s46, 49152
    s_add_u32 s35, s44, 0xc000
    buffer_load_dwordx4 v2, s[12:15], s35 offen sc1 lds
    s_add_u32 m0, s46, 53248
    s_add_u32 s35, s44, 0xd000
    buffer_load_dwordx4 v2, s[12:15], s35 offen sc1 lds
    s_add_u32 m0, s46, 57344
    s_add_u32 s35, s44, 0xe000
    buffer_load_dwordx4 v2, s[12:15], s35 offen sc1 lds
    s_add_u32 m0, s46, 61440
    s_add_u32 s35, s44, 0xf000
    buffer_load_dwordx4 v2, s[12:15], s35 offen sc1 lds
    s_barrier
    s_waitcnt vmcnt(8)
    v_pk_add_f32 v[8:9], v[8:9], v[12:13] op_sel:[0,0] op_sel_hi:[1,1]
    v_pk_add_f32 v[10:11], v[10:11], v[14:15] op_sel:[0,0] op_sel_hi:[1,1]
    v_pk_add_f32 v[8:9], v[8:9], v[16:17] op_sel:[0,0] op_sel_hi:[1,1]
    v_pk_add_f32 v[10:11], v[10:11], v[18:19] op_sel:[0,0] op_sel_hi:[1,1]
    v_pk_add_f32 v[8:9], v[8:9], v[20:21] op_sel:[0,0] op_sel_hi:[1,1]
    v_pk_add_f32 v[10:11], v[10:11], v[22:23] op_sel:[0,0] op_sel_hi:[1,1]
    v_pk_add_f32 v[8:9], v[8:9], v[24:25] op_sel:[0,0] op_sel_hi:[1,1]
    v_pk_add_f32 v[10:11], v[10:11], v[26:27] op_sel:[0,0] op_sel_hi:[1,1]
    v_pk_add_f32 v[8:9], v[8:9], v[28:29] op_sel:[0,0] op_sel_hi:[1,1]
    v_pk_add_f32 v[10:11], v[10:11], v[30:31] op_sel:[0,0] op_sel_hi:[1,1]
    v_pk_add_f32 v[8:9], v[8:9], v[32:33] op_sel:[0,0] op_sel_hi:[1,1]
    v_pk_add_f32 v[10:11], v[10:11], v[34:35] op_sel:[0,0] op_sel_hi:[1,1]
    v_pk_add_f32 v[8:9], v[8:9], v[36:37] op_sel:[0,0] op_sel_hi:[1,1]
    v_pk_add_f32 v[10:11], v[10:11], v[38:39] op_sel:[0,0] op_sel_hi:[1,1]
    v_pk_add_f32 v[8:9], v[8:9], v[40:41] op_sel:[0,0] op_sel_hi:[1,1]
    v_pk_add_f32 v[10:11], v[10:11], v[42:43] op_sel:[0,0] op_sel_hi:[1,1]
    v_pk_add_f32 v[8:9], v[8:9], v[44:45] op_sel:[0,0] op_sel_hi:[1,1]
    v_pk_add_f32 v[10:11], v[10:11], v[46:47] op_sel:[0,0] op_sel_hi:[1,1]
    v_pk_add_f32 v[8:9], v[8:9], v[48:49] op_sel:[0,0] op_sel_hi:[1,1]
    v_pk_add_f32 v[10:11], v[10:11], v[50:51] op_sel:[0,0] op_sel_hi:[1,1]
    v_pk_add_f32 v[8:9], v[8:9], v[52:53] op_sel:[0,0] op_sel_hi:[1,1]
    v_pk_add_f32 v[10:11], v[10:11], v[54:55] op_sel:[0,0] op_sel_hi:[1,1]
    v_pk_add_f32 v[8:9], v[8:9], v[56:57] op_sel:[0,0] op_sel_hi:[1,1]
    v_pk_add_f32 v[10:11], v[10:11], v[58:59] op_sel:[0,0] op_sel_hi:[1,1]
    v_pk_add_f32 v[8:9], v[8:9], v[60:61] op_sel:[0,0] op_sel_hi:[1,1]
    v_pk_add_f32 v[10:11], v[10:11], v[62:63] op_sel:[0,0] op_sel_hi:[1,1]
    v_pk_add_f32 v[8:9], v[8:9], v[64:65] op_sel:[0,0] op_sel_hi:[1,1]
    v_pk_add_f32 v[10:11], v[10:11], v[66:67] op_sel:[0,0] op_sel_hi:[1,1]
    v_pk_add_f32 v[8:9], v[8:9], v[68:69] op_sel:[0,0] op_sel_hi:[1,1]
    v_pk_add_f32 v[10:11], v[10:11], v[70:71] op_sel:[0,0] op_sel_hi:[1,1]
    s_add_u32 s31, s46, 155648
    v_add_u32 v3, s31, v2
    ds_write_b128 v3, v[8:11]
    s_add_u32 m0, s46, 65536
    s_add_u32 s35, s44, 0x10000
    buffer_load_dwordx4 v2, s[12:15], s35 offen sc1 lds
    s_add_u32 m0, s46, 69632
    s_add_u32 s35, s44, 0x11000
    buffer_load_dwordx4 v2, s[12:15], s35 offen sc1 lds
    s_add_u32 m0, s46, 73728
    s_add_u32 s35, s44, 0x12000
    buffer_load_dwordx4 v2, s[12:15], s35 offen sc1 lds
    s_add_u32 m0, s46, 77824
    s_add_u32 s35, s44, 0x13000
    buffer_load_dwordx4 v2, s[12:15], s35 offen sc1 lds
    s_add_u32 m0, s46, 81920
    s_add_u32 s35, s44, 0x14000
    buffer_load_dwordx4 v2, s[12:15], s35 offen sc1 lds
    s_add_u32 m0, s46, 86016
    s_add_u32 s35, s44, 0x15000
    buffer_load_dwordx4 v2, s[12:15], s35 offen sc1 lds
    s_add_u32 m0, s46, 90112
    s_add_u32 s35, s44, 0x16000
    buffer_load_dwordx4 v2, s[12:15], s35 offen sc1 lds
    s_add_u32 m0, s46, 94208
    s_add_u32 s35, s44, 0x17000
    buffer_load_dwordx4 v2, s[12:15], s35 offen sc1 lds
    s_add_u32 m0, s46, 98304
    s_add_u32 s35, s44, 0x18000
    buffer_load_dwordx4 v2, s[12:15], s35 offen sc1 lds
    s_add_u32 m0, s46, 102400
    s_add_u32 s35, s44, 0x19000
    buffer_load_dwordx4 v2, s[12:15], s35 offen sc1 lds
    s_add_u32 m0, s46, 106496
    s_add_u32 s35, s44, 0x1a000
    buffer_load_dwordx4 v2, s[12:15], s35 offen sc1 lds
    s_add_u32 m0, s46, 110592
    s_add_u32 s35, s44, 0x1b000
    buffer_load_dwordx4 v2, s[12:15], s35 offen sc1 lds
    s_waitcnt vmcnt(12) lgkmcnt(0)
    s_barrier
    s_barrier
    s_add_u32 m0, s46, 114688
    s_add_u32 s35, s44, 0x1c000
    buffer_load_dwordx4 v2, s[12:15], s35 offen sc1 lds
    s_add_u32 m0, s46, 118784
    s_add_u32 s35, s44, 0x1d000
    buffer_load_dwordx4 v2, s[12:15], s35 offen sc1 lds
    s_add_u32 m0, s46, 122880
    s_add_u32 s35, s44, 0x1e000
    buffer_load_dwordx4 v2, s[12:15], s35 offen sc1 lds
    s_add_u32 m0, s46, 126976
    s_add_u32 s35, s44, 0x1f000
    buffer_load_dwordx4 v2, s[12:15], s35 offen sc1 lds
    s_add_u32 m0, s36, 131072
    s_add_u32 s35, s53, 0
    buffer_load_dwordx4 v6, s[20:23], s35 offen offset:0 lds
    buffer_load_dwordx4 v7, s[20:23], s35 offen offset:1024 lds
    s_add_u32 m0, s36, 133120
    s_add_u32 s35, s53, 16384
    buffer_load_dwordx4 v6, s[20:23], s35 offen offset:0 lds
    buffer_load_dwordx4 v7, s[20:23], s35 offen offset:1024 lds
    s_add_u32 s35, s53, 98304
    buffer_load_dwordx4 a[0:3], v6, s[20:23], s35 offen offset:0
    buffer_load_dwordx4 a[4:7], v7, s[20:23], s35 offen offset:1024
    s_add_u32 s35, s53, 180224
    buffer_load_dwordx4 a[8:11], v6, s[20:23], s35 offen offset:0
    buffer_load_dwordx4 a[12:15], v7, s[20:23], s35 offen offset:1024
    s_waitcnt vmcnt(8)
    s_barrier
    s_barrier
    s_add_u32 m0, s46, 0
    s_add_u32 s35, s44, 0x20000
    buffer_load_dwordx4 v2, s[12:15], s35 offen sc1 lds
    s_add_u32 m0, s46, 4096
    s_add_u32 s35, s44, 0x21000
    buffer_load_dwordx4 v2, s[12:15], s35 offen sc1 lds
    s_add_u32 m0, s46, 8192
    s_add_u32 s35, s44, 0x22000
    buffer_load_dwordx4 v2, s[12:15], s35 offen sc1 lds
    s_add_u32 m0, s46, 12288
    s_add_u32 s35, s44, 0x23000
    buffer_load_dwordx4 v2, s[12:15], s35 offen sc1 lds
    s_add_u32 m0, s46, 16384
    s_add_u32 s35, s44, 0x24000
    buffer_load_dwordx4 v2, s[12:15], s35 offen sc1 lds
    s_add_u32 m0, s46, 20480
    s_add_u32 s35, s44, 0x25000
    buffer_load_dwordx4 v2, s[12:15], s35 offen sc1 lds
    s_add_u32 m0, s46, 24576
    s_add_u32 s35, s44, 0x26000
    buffer_load_dwordx4 v2, s[12:15], s35 offen sc1 lds
    s_add_u32 m0, s46, 28672
    s_add_u32 s35, s44, 0x27000
    buffer_load_dwordx4 v2, s[12:15], s35 offen sc1 lds
    s_add_u32 m0, s46, 32768
    s_add_u32 s35, s44, 0x28000
    buffer_load_dwordx4 v2, s[12:15], s35 offen sc1 lds
    s_add_u32 m0, s46, 36864
    s_add_u32 s35, s44, 0x29000
    buffer_load_dwordx4 v2, s[12:15], s35 offen sc1 lds
    s_add_u32 m0, s46, 40960
    s_add_u32 s35, s44, 0x2a000
    buffer_load_dwordx4 v2, s[12:15], s35 offen sc1 lds
    s_add_u32 m0, s46, 45056
    s_add_u32 s35, s44, 0x2b000
    buffer_load_dwordx4 v2, s[12:15], s35 offen sc1 lds
    s_add_u32 m0, s46, 49152
    s_add_u32 s35, s44, 0x2c000
    buffer_load_dwordx4 v2, s[12:15], s35 offen sc1 lds
    s_add_u32 m0, s46, 53248
    s_add_u32 s35, s44, 0x2d000
    buffer_load_dwordx4 v2, s[12:15], s35 offen sc1 lds
    s_add_u32 m0, s46, 57344
    s_add_u32 s35, s44, 0x2e000
    buffer_load_dwordx4 v2, s[12:15], s35 offen sc1 lds
    s_add_u32 m0, s46, 61440
    s_add_u32 s35, s44, 0x2f000
    buffer_load_dwordx4 v2, s[12:15], s35 offen sc1 lds
    s_add_u32 s35, s53, 196608
    buffer_load_dwordx4 a[16:19], v6, s[20:23], s35 offen offset:0
    buffer_load_dwordx4 a[20:23], v7, s[20:23], s35 offen offset:1024
    s_add_u32 s35, s53, 212992
    buffer_load_dwordx4 a[24:27], v6, s[20:23], s35 offen offset:0
    buffer_load_dwordx4 a[28:31], v7, s[20:23], s35 offen offset:1024
    s_add_u32 s35, s53, 294912
    buffer_load_dwordx4 a[32:35], v6, s[20:23], s35 offen offset:0
    buffer_load_dwordx4 a[36:39], v7, s[20:23], s35 offen offset:1024
    s_add_u32 s35, s53, 311296
    buffer_load_dwordx4 a[40:43], v6, s[20:23], s35 offen offset:0
    buffer_load_dwordx4 a[44:47], v7, s[20:23], s35 offen offset:1024
    s_waitcnt vmcnt(8)
    s_barrier
    s_barrier
    s_add_u32 m0, s46, 65536
    s_add_u32 s35, s44, 0x30000
    buffer_load_dwordx4 v2, s[12:15], s35 offen sc1 lds
    s_add_u32 m0, s46, 69632
    s_add_u32 s35, s44, 0x31000
    buffer_load_dwordx4 v2, s[12:15], s35 offen sc1 lds
    s_add_u32 m0, s46, 73728
    s_add_u32 s35, s44, 0x32000
    buffer_load_dwordx4 v2, s[12:15], s35 offen sc1 lds
    s_add_u32 m0, s46, 77824
    s_add_u32 s35, s44, 0x33000
    buffer_load_dwordx4 v2, s[12:15], s35 offen sc1 lds
    s_add_u32 m0, s46, 81920
    s_add_u32 s35, s44, 0x34000
    buffer_load_dwordx4 v2, s[12:15], s35 offen sc1 lds
    s_add_u32 m0, s46, 86016
    s_add_u32 s35, s44, 0x35000
    buffer_load_dwordx4 v2, s[12:15], s35 offen sc1 lds
    s_add_u32 m0, s46, 90112
    s_add_u32 s35, s44, 0x36000
    buffer_load_dwordx4 v2, s[12:15], s35 offen sc1 lds
    s_add_u32 m0, s46, 94208
    s_add_u32 s35, s44, 0x37000
    buffer_load_dwordx4 v2, s[12:15], s35 offen sc1 lds
    s_add_u32 m0, s36, 98304
    s_add_u32 s35, s53, 114688
    buffer_load_dwordx4 v6, s[20:23], s35 offen offset:0 lds
    buffer_load_dwordx4 v7, s[20:23], s35 offen offset:1024 lds
    s_add_u32 m0, s36, 100352
    s_add_u32 s35, s53, 131072
    buffer_load_dwordx4 v6, s[20:23], s35 offen offset:0 lds
    buffer_load_dwordx4 v7, s[20:23], s35 offen offset:1024 lds
    s_add_u32 m0, s36, 114688
    s_add_u32 s35, s53, 229376
    buffer_load_dwordx4 v6, s[20:23], s35 offen offset:0 lds
    buffer_load_dwordx4 v7, s[20:23], s35 offen offset:1024 lds
    s_add_u32 m0, s36, 116736
    s_add_u32 s35, s53, 245760
    buffer_load_dwordx4 v6, s[20:23], s35 offen offset:0 lds
    buffer_load_dwordx4 v7, s[20:23], s35 offen offset:1024 lds
    s_add_u32 s35, s53, 327680
    buffer_load_dwordx4 v[76:79], v6, s[20:23], s35 offen offset:0
    buffer_load_dwordx4 v[80:83], v7, s[20:23], s35 offen offset:1024
    s_add_u32 s35, s53, 409600
    buffer_load_dwordx4 v[84:87], v6, s[20:23], s35 offen offset:0
    buffer_load_dwordx4 v[88:91], v7, s[20:23], s35 offen offset:1024
    s_add_u32 s35, s53, 425984
    buffer_load_dwordx4 v[92:95], v6, s[20:23], s35 offen offset:0
    buffer_load_dwordx4 v[96:99], v7, s[20:23], s35 offen offset:1024
    s_add_u32 s35, s53, 442368
    buffer_load_dwordx4 v[100:103], v6, s[20:23], s35 offen offset:0
    buffer_load_dwordx4 v[104:107], v7, s[20:23], s35 offen offset:1024
    s_waitcnt vmcnt(16)
    s_barrier
    s_barrier
    s_add_u32 m0, s36, 0
    s_add_u32 s35, s53, 344064
    buffer_load_dwordx4 v6, s[20:23], s35 offen offset:0 lds
    buffer_load_dwordx4 v7, s[20:23], s35 offen offset:1024 lds
    s_add_u32 m0, s36, 2048
    s_add_u32 s35, s53, 360448
    buffer_load_dwordx4 v6, s[20:23], s35 offen offset:0 lds
    buffer_load_dwordx4 v7, s[20:23], s35 offen offset:1024 lds
    ds_write_b128 v72, a[48:51] offset:16384
    ds_write_b128 v72, a[52:55] offset:17408
    ds_write_b128 v72, a[56:59] offset:18432
    ds_write_b128 v72, a[60:63] offset:19456
    ds_write_b128 v72, a[64:67] offset:32768
    ds_write_b128 v72, a[68:71] offset:33792
    ds_write_b128 v72, a[72:75] offset:34816
    ds_write_b128 v72, a[76:79] offset:35840
    ds_write_b128 v72, a[80:83] offset:49152
    ds_write_b128 v72, a[84:87] offset:50176
    ds_write_b128 v72, a[88:91] offset:51200
    ds_write_b128 v72, a[92:95] offset:52224
    s_waitcnt lgkmcnt(0)
    s_barrier
    ds_write_b128 v73, a[96:99] offset:0
    ds_write_b128 v73, a[100:103] offset:1024
    ds_write_b128 v73, a[104:107] offset:2048
    ds_write_b128 v73, a[108:111] offset:3072
    ds_write_b128 v73, a[112:115] offset:16384
    ds_write_b128 v73, a[116:119] offset:17408
    ds_write_b128 v73, a[120:123] offset:18432
    ds_write_b128 v73, a[124:127] offset:19456
    s_waitcnt vmcnt(16) lgkmcnt(0)
    s_barrier
    s_waitcnt vmcnt(12) lgkmcnt(0)
    s_barrier
    ds_write_b128 v74, a[0:3] offset:0
    ds_write_b128 v74, a[4:7] offset:1024
    ds_write_b128 v74, a[8:11] offset:2048
    ds_write_b128 v74, a[12:15] offset:3072
    s_waitcnt vmcnt(0) lgkmcnt(0)
    s_barrier
    ds_write_b128 v73, a[16:19] offset:32768
    ds_write_b128 v73, a[20:23] offset:33792
    ds_write_b128 v73, a[24:27] offset:34816
    ds_write_b128 v73, a[28:31] offset:35840
    s_waitcnt lgkmcnt(0)
    s_barrier
    ds_write_b128 v73, a[32:35] offset:49152
    ds_write_b128 v73, a[36:39] offset:50176
    ds_write_b128 v73, a[40:43] offset:51200
    ds_write_b128 v73, a[44:47] offset:52224
    s_waitcnt lgkmcnt(0)
    s_barrier
    ds_write_b128 v72, v[76:79] offset:0
    ds_write_b128 v72, v[80:83] offset:1024
    ds_write_b128 v72, v[84:87] offset:2048
    ds_write_b128 v72, v[88:91] offset:3072
    s_waitcnt lgkmcnt(0)
    s_barrier
    ds_write_b128 v72, v[92:95] offset:16384
    ds_write_b128 v72, v[96:99] offset:17408
    ds_write_b128 v72, v[100:103] offset:18432
    ds_write_b128 v72, v[104:107] offset:19456
    s_waitcnt lgkmcnt(0)
    s_barrier
    s_waitcnt lgkmcnt(0)
    s_barrier
    s_waitcnt lgkmcnt(0)
    s_barrier
    s_waitcnt lgkmcnt(0)
    s_barrier
    s_waitcnt lgkmcnt(0)
    s_barrier
    s_waitcnt lgkmcnt(0)
    s_barrier
    s_waitcnt lgkmcnt(0)
    s_barrier
    s_branch L_end_11
L_cprog_10:
    s_lshl_b32 s34, s30, 5
    s_lshl_b32 s31, s29, 4
    s_add_u32 s34, s34, s31
    s_lshl_b32 s34, s34, 10
    s_add_u32 s34, s34, 0x600000
    s_waitcnt lgkmcnt(0)
    s_mov_b32 s12, s8
    s_mov_b32 s13, s9
    s_mov_b32 s14, 0x1800000
    s_mov_b32 s15, 0x00020000
    s_mov_b32 s40, s50
    s_mov_b32 s41, s51
    s_mov_b32 s42, 0x200000
    s_mov_b32 s43, 0x00020000
    s_lshl_b32 s31, s29, 13
    s_lshl_b32 s33, s28, 12
    s_add_u32 s31, s31, s33
    s_add_u32 s31, s31, 65536
    v_add_u32 v5, s31, v2
    s_waitcnt vmcnt(1)
    ds_write_b128 v5, a[64:67] offset:0
    ds_write_b128 v5, a[68:71] offset:1024
    ds_write_b128 v5, a[72:75] offset:2048
    ds_write_b128 v5, a[76:79] offset:3072
    ds_write_b128 v5, a[80:83] offset:16384
    ds_write_b128 v5, a[84:87] offset:17408
    ds_write_b128 v5, a[88:91] offset:18432
    ds_write_b128 v5, a[92:95] offset:19456
    ds_write_b128 v5, a[96:99] offset:32768
    ds_write_b128 v5, a[100:103] offset:33792
    ds_write_b128 v5, a[104:107] offset:34816
    ds_write_b128 v5, a[108:111] offset:35840
    ds_write_b128 v5, a[112:115] offset:49152
    ds_write_b128 v5, a[116:119] offset:50176
    ds_write_b128 v5, a[120:123] offset:51200
    ds_write_b128 v5, a[124:127] offset:52224
    v_lshrrev_b32 v3, 5, v1
    v_lshlrev_b32 v22, 4, v3
    v_add_u32 v22, 155648, v22
    v_bfe_u32 v4, v1, 2, 2
    v_lshl_add_u32 v3, v3, 2, v4
    v_lshlrev_b32 v3, 7, v3
    v_bfe_u32 v4, v1, 3, 1
    v_xor_b32 v4, s29, v4
    v_lshl_add_u32 v3, v4, 6, v3
    v_bfe_u32 v4, v1, 4, 1
    v_lshl_add_u32 v3, v4, 5, v3
    v_and_b32 v4, 3, v1
    v_lshl_add_u32 v3, v4, 3, v3
    s_lshl_b32 s31, s29, 13
    v_add_u32 v11, s31, v3
    v_xor_b32 v12, 64, v11
    v_add_u32 v13, 0x10000, v11
    v_add_u32 v14, 0x10000, v12
    v_add_u32 v15, 0x20000, v11
    v_add_u32 v16, 0x20000, v12
    v_add_u32 v17, 0x10000, v2
    v_and_b32 v3, 31, v1
    v_lshlrev_b32 v8, 10, v3
    v_lshrrev_b32 v4, 5, v1
    v_lshl_add_u32 v8, v4, 4, v8
    s_lshl_b32 s31, s30, 15
    s_lshl_b32 s32, s26, 7
    s_add_u32 s31, s31, s32
    s_lshl_b32 s32, s29, 6
    s_add_u32 s31, s31, s32
    v_add_u32 v8, s31, v8
    s_lshl_b32 s37, s30, 5
    s_lshl_b32 s32, s26, 2
    s_add_u32 s37, s37, s32
    s_lshl_b32 s32, s29, 1
    s_add_u32 s37, s37, s32
    s_lshl_b32 s37, s37, 10
    s_add_u32 s37, s37, 0x800000
    s_lshl_b32 s39, s30, 11
    s_lshl_b32 s31, s26, 8
    s_add_u32 s39, s39, s31
    s_lshl_b32 s31, s29, 7
    s_add_u32 s39, s39, s31
    s_add_u32 s39, s39, 0x1100000
    s_lshl_b32 s38, s55, 11
    s_add_u32 s38, s38, 0x1100000
    v_and_b32 v7, 15, v1
    v_lshlrev_b32 v7, 7, v7
    v_lshlrev_b32 v9, 2, v1
    v_mov_b32 v10, 1
    s_mul_i32 s54, s30, 112
    s_mul_i32 s31, s29, 56
    s_add_u32 s54, s54, s31
    s_lshl_b32 s54, s54, 10
    s_add_u32 s54, s54, 0xa00000
    s_mul_i32 s45, s55, 112
    s_mul_i32 s31, s27, 7
    s_add_u32 s45, s45, s31
    s_lshl_b32 s45, s45, 10
    s_add_u32 s45, s45, 0xa00000
    s_waitcnt vmcnt(0)
    v_mov_b32 v3, 1
    v_mov_b32 v4, 0
    s_mov_b64 exec, 1
    buffer_store_dword v3, v4, s[12:15], s60 offen sc1
    s_mov_b64 exec, -1
    s_mov_b32 s33, s38
    s_lshl_b32 s38, s30, 12
    s_lshl_b32 s31, s29, 11
    s_add_u32 s38, s38, s31
    s_add_u32 s38, s38, 0x11a0000
    s_mov_b32 s56, s34
    s_mov_b32 s58, 8
    v_mov_b32 v36, 0
    v_mov_b32 v37, 0
    v_mov_b32 v38, 0
    v_mov_b32 v39, 0
    buffer_load_dwordx4 a[0:3], v2, s[12:15], s34 offen offset:0 sc1
    buffer_load_dwordx4 a[4:7], v2, s[12:15], s34 offen offset:1024 sc1
    buffer_load_dwordx4 a[8:11], v2, s[12:15], s34 offen offset:2048 sc1
    buffer_load_dwordx4 a[12:15], v2, s[12:15], s34 offen offset:3072 sc1
    s_add_u32 s34, s34, 4096
    buffer_load_dwordx4 a[16:19], v2, s[12:15], s34 offen offset:0 sc1
    buffer_load_dwordx4 a[20:23], v2, s[12:15], s34 offen offset:1024 sc1
    buffer_load_dwordx4 a[24:27], v2, s[12:15], s34 offen offset:2048 sc1
    buffer_load_dwordx4 a[28:31], v2, s[12:15], s34 offen offset:3072 sc1
    s_add_u32 s34, s34, 4096
    buffer_load_dwordx4 a[32:35], v2, s[12:15], s34 offen offset:0 sc1
    buffer_load_dwordx4 a[36:39], v2, s[12:15], s34 offen offset:1024 sc1
    buffer_load_dwordx4 a[40:43], v2, s[12:15], s34 offen offset:2048 sc1
    buffer_load_dwordx4 a[44:47], v2, s[12:15], s34 offen offset:3072 sc1
    s_add_u32 s34, s34, 4096
    buffer_load_dwordx4 a[48:51], v2, s[12:15], s34 offen offset:0 sc1
    buffer_load_dwordx4 a[52:55], v2, s[12:15], s34 offen offset:1024 sc1
    buffer_load_dwordx4 a[56:59], v2, s[12:15], s34 offen offset:2048 sc1
    buffer_load_dwordx4 a[60:63], v2, s[12:15], s34 offen offset:3072 sc1
    s_add_u32 s34, s34, 4096
    s_waitcnt lgkmcnt(0)
    s_barrier
L_wtop_14:
    ds_read_b64_tr_b16 v[40:41], v13 offset:0
    ds_read_b64_tr_b16 v[42:43], v13 offset:1024
    ds_read_b64_tr_b16 v[44:45], v14 offset:0
    ds_read_b64_tr_b16 v[46:47], v14 offset:1024
    ds_read_b64_tr_b16 v[48:49], v13 offset:2048
    ds_read_b64_tr_b16 v[50:51], v13 offset:3072
    ds_read_b64_tr_b16 v[52:53], v14 offset:2048
    ds_read_b64_tr_b16 v[54:55], v14 offset:3072
    ds_read_b64_tr_b16 v[56:57], v13 offset:4096
    ds_read_b64_tr_b16 v[58:59], v13 offset:5120
    ds_read_b64_tr_b16 v[60:61], v14 offset:4096
    ds_read_b64_tr_b16 v[62:63], v14 offset:5120
    s_waitcnt vmcnt(12) lgkmcnt(8)
    v_mfma_f32_16x16x32_bf16 v[32:35], v[36:39], a[0:3], 0
    v_mfma_f32_16x16x32_bf16 v[32:35], v[36:39], a[4:7], v[32:35]
    v_mfma_f32_16x16x32_bf16 v[32:35], v[36:39], a[8:11], v[32:35]
    v_mfma_f32_16x16x32_bf16 v[32:35], v[36:39], a[12:15], v[32:35]
    s_nop 7
L_vt_15:
    v_cmp_u_f32 vcc, v32, v32
    s_nop 0
    s_cbranch_vccnz L_vs_16
L_vd_17:
    v_mfma_f32_32x32x16_bf16 v[64:79], v[40:43], a[0:3], 0
    v_mfma_f32_32x32x16_bf16 v[80:95], v[44:47], a[0:3], 0
    ds_read_b64_tr_b16 v[40:41], v13 offset:6144
    ds_read_b64_tr_b16 v[42:43], v13 offset:7168
    ds_read_b64_tr_b16 v[44:45], v14 offset:6144
    ds_read_b64_tr_b16 v[46:47], v14 offset:7168
    s_waitcnt lgkmcnt(8)
    v_mfma_f32_32x32x16_bf16 v[64:79], v[48:51], a[4:7], v[64:79]
    v_mfma_f32_32x32x16_bf16 v[80:95], v[52:55], a[4:7], v[80:95]
    ds_read_b64_tr_b16 v[48:49], v13 offset:16384
    ds_read_b64_tr_b16 v[50:51], v13 offset:17408
    ds_read_b64_tr_b16 v[52:53], v14 offset:16384
    ds_read_b64_tr_b16 v[54:55], v14 offset:17408
    s_waitcnt lgkmcnt(8)
    v_mfma_f32_32x32x16_bf16 v[64:79], v[56:59], a[8:11], v[64:79]
    v_mfma_f32_32x32x16_bf16 v[80:95], v[60:63], a[8:11], v[80:95]
    ds_read_b64_tr_b16 v[56:57], v13 offset:18432
    ds_read_b64_tr_b16 v[58:59], v13 offset:19456
    ds_read_b64_tr_b16 v[60:61], v14 offset:18432
    ds_read_b64_tr_b16 v[62:63], v14 offset:19456
    s_waitcnt lgkmcnt(8)
    v_mfma_f32_32x32x16_bf16 v[64:79], v[40:43], a[12:15], v[64:79]
    v_mfma_f32_32x32x16_bf16 v[80:95], v[44:47], a[12:15], v[80:95]
    ds_read_b64_tr_b16 v[40:41], v13 offset:20480
    ds_read_b64_tr_b16 v[42:43], v13 offset:21504
    ds_read_b64_tr_b16 v[44:45], v14 offset:20480
    ds_read_b64_tr_b16 v[46:47], v14 offset:21504
    s_waitcnt vmcnt(8) lgkmcnt(8)
    v_mfma_f32_16x16x32_bf16 v[32:35], v[36:39], a[16:19], 0
    v_mfma_f32_16x16x32_bf16 v[32:35], v[36:39], a[20:23], v[32:35]
    v_mfma_f32_16x16x32_bf16 v[32:35], v[36:39], a[24:27], v[32:35]
    v_mfma_f32_16x16x32_bf16 v[32:35], v[36:39], a[28:31], v[32:35]
    s_nop 7
L_vt_18:
    v_cmp_u_f32 vcc, v32, v32
    s_nop 0
    s_cbranch_vccnz L_vs_19
L_vd_20:
    v_mfma_f32_32x32x16_bf16 v[64:79], v[48:51], a[16:19], v[64:79]
    v_mfma_f32_32x32x16_bf16 v[80:95], v[52:55], a[16:19], v[80:95]
    ds_read_b64_tr_b16 v[48:49], v13 offset:22528
    ds_read_b64_tr_b16 v[50:51], v13 offset:23552
    ds_read_b64_tr_b16 v[52:53], v14 offset:22528
    ds_read_b64_tr_b16 v[54:55], v14 offset:23552
    s_waitcnt lgkmcnt(8)
    v_mfma_f32_32x32x16_bf16 v[64:79], v[56:59], a[20:23], v[64:79]
    v_mfma_f32_32x32x16_bf16 v[80:95], v[60:63], a[20:23], v[80:95]
    ds_read_b64_tr_b16 v[56:57], v13 offset:32768
    ds_read_b64_tr_b16 v[58:59], v13 offset:33792
    ds_read_b64_tr_b16 v[60:61], v14 offset:32768
    ds_read_b64_tr_b16 v[62:63], v14 offset:33792
    s_waitcnt lgkmcnt(8)
    v_mfma_f32_32x32x16_bf16 v[64:79], v[40:43], a[24:27], v[64:79]
    v_mfma_f32_32x32x16_bf16 v[80:95], v[44:47], a[24:27], v[80:95]
    ds_read_b64_tr_b16 v[40:41], v13 offset:34816
    ds_read_b64_tr_b16 v[42:43], v13 offset:35840
    ds_read_b64_tr_b16 v[44:45], v14 offset:34816
    ds_read_b64_tr_b16 v[46:47], v14 offset:35840
    s_waitcnt lgkmcnt(8)
    v_mfma_f32_32x32x16_bf16 v[64:79], v[48:51], a[28:31], v[64:79]
    v_mfma_f32_32x32x16_bf16 v[80:95], v[52:55], a[28:31], v[80:95]
    ds_read_b64_tr_b16 v[48:49], v13 offset:36864
    ds_read_b64_tr_b16 v[50:51], v13 offset:37888
    ds_read_b64_tr_b16 v[52:53], v14 offset:36864
    ds_read_b64_tr_b16 v[54:55], v14 offset:37888
    s_waitcnt vmcnt(4) lgkmcnt(8)
    v_mfma_f32_16x16x32_bf16 v[32:35], v[36:39], a[32:35], 0
    v_mfma_f32_16x16x32_bf16 v[32:35], v[36:39], a[36:39], v[32:35]
    v_mfma_f32_16x16x32_bf16 v[32:35], v[36:39], a[40:43], v[32:35]
    v_mfma_f32_16x16x32_bf16 v[32:35], v[36:39], a[44:47], v[32:35]
    s_nop 7
L_vt_21:
    v_cmp_u_f32 vcc, v32, v32
    s_nop 0
    s_cbranch_vccnz L_vs_22
L_vd_23:
    v_mfma_f32_32x32x16_bf16 v[64:79], v[56:59], a[32:35], v[64:79]
    v_mfma_f32_32x32x16_bf16 v[80:95], v[60:63], a[32:35], v[80:95]
    ds_read_b64_tr_b16 v[56:57], v13 offset:38912
    ds_read_b64_tr_b16 v[58:59], v13 offset:39936
    ds_read_b64_tr_b16 v[60:61], v14 offset:38912
    ds_read_b64_tr_b16 v[62:63], v14 offset:39936
    s_waitcnt lgkmcnt(8)
    v_mfma_f32_32x32x16_bf16 v[64:79], v[40:43], a[36:39], v[64:79]
    v_mfma_f32_32x32x16_bf16 v[80:95], v[44:47], a[36:39], v[80:95]
    ds_read_b64_tr_b16 v[40:41], v13 offset:49152
    ds_read_b64_tr_b16 v[42:43], v13 offset:50176
    ds_read_b64_tr_b16 v[44:45], v14 offset:49152
    ds_read_b64_tr_b16 v[46:47], v14 offset:50176
    s_waitcnt lgkmcnt(8)
    v_mfma_f32_32x32x16_bf16 v[64:79], v[48:51], a[40:43], v[64:79]
    v_mfma_f32_32x32x16_bf16 v[80:95], v[52:55], a[40:43], v[80:95]
    ds_read_b64_tr_b16 v[48:49], v13 offset:51200
    ds_read_b64_tr_b16 v[50:51], v13 offset:52224
    ds_read_b64_tr_b16 v[52:53], v14 offset:51200
    ds_read_b64_tr_b16 v[54:55], v14 offset:52224
    s_waitcnt lgkmcnt(8)
    v_mfma_f32_32x32x16_bf16 v[64:79], v[56:59], a[44:47], v[64:79]
    v_mfma_f32_32x32x16_bf16 v[80:95], v[60:63], a[44:47], v[80:95]
    ds_read_b64_tr_b16 v[56:57], v13 offset:53248
    ds_read_b64_tr_b16 v[58:59], v13 offset:54272
    ds_read_b64_tr_b16 v[60:61], v14 offset:53248
    ds_read_b64_tr_b16 v[62:63], v14 offset:54272
    s_waitcnt vmcnt(0) lgkmcnt(8)
    v_mfma_f32_16x16x32_bf16 v[32:35], v[36:39], a[48:51], 0
    v_mfma_f32_16x16x32_bf16 v[32:35], v[36:39], a[52:55], v[32:35]
    v_mfma_f32_16x16x32_bf16 v[32:35], v[36:39], a[56:59], v[32:35]
    v_mfma_f32_16x16x32_bf16 v[32:35], v[36:39], a[60:63], v[32:35]
    s_nop 7
L_vt_24:
    v_cmp_u_f32 vcc, v32, v32
    s_nop 0
    s_cbranch_vccnz L_vs_25
L_vd_26:
    v_mfma_f32_32x32x16_bf16 v[64:79], v[40:43], a[48:51], v[64:79]
    v_mfma_f32_32x32x16_bf16 v[80:95], v[44:47], a[48:51], v[80:95]
    ds_read_b64_tr_b16 v[40:41], v13 offset:55296
    ds_read_b64_tr_b16 v[42:43], v13 offset:56320
    ds_read_b64_tr_b16 v[44:45], v14 offset:55296
    ds_read_b64_tr_b16 v[46:47], v14 offset:56320
    s_waitcnt lgkmcnt(8)
    v_mfma_f32_32x32x16_bf16 v[64:79], v[48:51], a[52:55], v[64:79]
    v_mfma_f32_32x32x16_bf16 v[80:95], v[52:55], a[52:55], v[80:95]
    s_waitcnt lgkmcnt(4)
    v_mfma_f32_32x32x16_bf16 v[64:79], v[56:59], a[56:59], v[64:79]
    v_mfma_f32_32x32x16_bf16 v[80:95], v[60:63], a[56:59], v[80:95]
    s_waitcnt lgkmcnt(0)
    v_mfma_f32_32x32x16_bf16 v[64:79], v[40:43], a[60:63], v[64:79]
    v_mfma_f32_32x32x16_bf16 v[80:95], v[44:47], a[60:63], v[80:95]
    s_mov_b32 s38, s33
    v_and_b32 v3, 31, v1
    v_bfe_u32 v4, v1, 1, 3
    s_lshl_b32 s31, s29, 2
    v_xor_b32 v4, s31, v4
    v_lshlrev_b32 v3, 7, v3
    v_lshrrev_b32 v5, 5, v1
    v_lshl_add_u32 v3, v5, 3, v3
    s_lshl_b32 s31, s28, 12
    s_add_u32 s31, s31, 147456
    v_add_u32 v3, s31, v3
    v_xor_b32 v5, 0, v4
    v_lshl_add_u32 v5, v5, 4, v3
    ds_read_b64 v[32:33], v5
    v_xor_b32 v5, 1, v4
    v_lshl_add_u32 v5, v5, 4, v3
    ds_read_b64 v[34:35], v5
    v_xor_b32 v5, 2, v4
    v_lshl_add_u32 v5, v5, 4, v3
    ds_read_b64 v[36:37], v5
    v_xor_b32 v5, 3, v4
    v_lshl_add_u32 v5, v5, 4, v3
    ds_read_b64 v[38:39], v5
    s_lshl_b32 s31, s24, 12
    s_add_u32 s31, s31, 131072
    v_add_u32 v3, s31, v2
    v_xor_b32 v4, 8192, v3
    ds_write_b128 v3, v[80:83] offset:0
    ds_write_b128 v3, v[84:87] offset:1024
    ds_write_b128 v3, v[88:91] offset:2048
    ds_write_b128 v3, v[92:95] offset:3072
    s_waitcnt lgkmcnt(0)
    s_barrier
    ds_read_b128 v[80:83], v4 offset:0
    ds_read_b128 v[84:87], v4 offset:1024
    ds_read_b128 v[88:91], v4 offset:2048
    ds_read_b128 v[92:95], v4 offset:3072
    v_lshlrev_b32 v96, 16, v32
    v_and_b32 v97, 0xffff0000, v32
    v_lshlrev_b32 v98, 16, v33
    v_and_b32 v99, 0xffff0000, v33
    v_lshlrev_b32 v100, 16, v34
    v_and_b32 v101, 0xffff0000, v34
    v_lshlrev_b32 v102, 16, v35
    v_and_b32 v103, 0xffff0000, v35
    v_lshlrev_b32 v104, 16, v36
    v_and_b32 v105, 0xffff0000, v36
    v_lshlrev_b32 v106, 16, v37
    v_and_b32 v107, 0xffff0000, v37
    v_lshlrev_b32 v108, 16, v38
    v_and_b32 v109, 0xffff0000, v38
    v_lshlrev_b32 v110, 16, v39
    v_and_b32 v111, 0xffff0000, v39
    v_pk_add_f32 v[64:65], v[64:65], v[96:97] op_sel:[0,0] op_sel_hi:[1,1]
    v_pk_add_f32 v[66:67], v[66:67], v[98:99] op_sel:[0,0] op_sel_hi:[1,1]
    v_pk_add_f32 v[68:69], v[68:69], v[100:101] op_sel:[0,0] op_sel_hi:[1,1]
    v_pk_add_f32 v[70:71], v[70:71], v[102:103] op_sel:[0,0] op_sel_hi:[1,1]
    v_pk_add_f32 v[72:73], v[72:73], v[104:105] op_sel:[0,0] op_sel_hi:[1,1]
    v_pk_add_f32 v[74:75], v[74:75], v[106:107] op_sel:[0,0] op_sel_hi:[1,1]
    v_pk_add_f32 v[76:77], v[76:77], v[108:109] op_sel:[0,0] op_sel_hi:[1,1]
    v_pk_add_f32 v[78:79], v[78:79], v[110:111] op_sel:[0,0] op_sel_hi:[1,1]
    s_waitcnt lgkmcnt(0)
    v_pk_add_f32 v[64:65], v[64:65], v[80:81] op_sel:[0,0] op_sel_hi:[1,1]
    v_pk_add_f32 v[66:67], v[66:67], v[82:83] op_sel:[0,0] op_sel_hi:[1,1]
    v_pk_add_f32 v[68:69], v[68:69], v[84:85] op_sel:[0,0] op_sel_hi:[1,1]
    v_pk_add_f32 v[70:71], v[70:71], v[86:87] op_sel:[0,0] op_sel_hi:[1,1]
    v_pk_add_f32 v[72:73], v[72:73], v[88:89] op_sel:[0,0] op_sel_hi:[1,1]
    v_pk_add_f32 v[74:75], v[74:75], v[90:91] op_sel:[0,0] op_sel_hi:[1,1]
    v_pk_add_f32 v[76:77], v[76:77], v[92:93] op_sel:[0,0] op_sel_hi:[1,1]
    v_pk_add_f32 v[78:79], v[78:79], v[94:95] op_sel:[0,0] op_sel_hi:[1,1]
    v_cvt_pk_bf16_f32 v24, v64, v65
    v_cvt_pk_bf16_f32 v25, v66, v67
    v_cvt_pk_bf16_f32 v26, v68, v69
    v_cvt_pk_bf16_f32 v27, v70, v71
    v_cvt_pk_bf16_f32 v28, v72, v73
    v_cvt_pk_bf16_f32 v29, v74, v75
    v_cvt_pk_bf16_f32 v30, v76, v77
    v_cvt_pk_bf16_f32 v31, v78, v79
    buffer_store_dwordx4 v[24:27], v2, s[12:15], s37 offen sc1
    buffer_store_dwordx4 v[28:31], v2, s[12:15], s37 offen offset:1024 sc1
    v_mov_b32 v32, 0
    v_mov_b32 v33, 0
    v_mov_b32 v5, 0x3f803f80
    v_dot2c_f32_bf16 v32, v24, v5
    v_dot2c_f32_bf16 v33, v24, v24
    v_dot2c_f32_bf16 v32, v25, v5
    v_dot2c_f32_bf16 v33, v25, v25
    v_dot2c_f32_bf16 v32, v26, v5
    v_dot2c_f32_bf16 v33, v26, v26
    v_dot2c_f32_bf16 v32, v27, v5
    v_dot2c_f32_bf16 v33, v27, v27
    v_dot2c_f32_bf16 v32, v28, v5
    v_dot2c_f32_bf16 v33, v28, v28
    v_dot2c_f32_bf16 v32, v29, v5
    v_dot2c_f32_bf16 v33, v29, v29
    v_dot2c_f32_bf16 v32, v30, v5
    v_dot2c_f32_bf16 v33, v30, v30
    v_dot2c_f32_bf16 v32, v31, v5
    v_dot2c_f32_bf16 v33, v31, v31
    s_lshl_b32 s31, s30, 4
    s_lshl_b32 s32, s26, 1
    s_add_u32 s31, s31, s32
    s_add_u32 s31, s31, s29
    s_lshl_b32 s31, s31, 8
    s_add_u32 s31, s31, 0x1200000
    v_mov_b32 v3, v32
    s_nop 1
    v_permlane32_swap_b32 v32, v3
    s_nop 1
    v_add_f32 v32, v32, v3
    v_mov_b32 v3, v33
    s_nop 1
    v_permlane32_swap_b32 v33, v3
    s_nop 1
    v_add_f32 v33, v33, v3
    v_and_b32 v3, 31, v1
    v_lshlrev_b32 v3, 3, v3
    buffer_store_dwordx2 v[32:33], v3, s[12:15], s31 offen sc1
    s_lshl_b32 s34, s55, 15
    s_add_u32 s34, s34, 0x800000
    s_lshl_b32 s32, s55, 12
    s_add_u32 s32, s32, 0x1200000
    v_lshlrev_b32 v3, 3, v1
    s_waitcnt vmcnt(0)
    s_add_u32 s31, s39, 0
    s_mov_b64 exec, 1
    buffer_store_dword v10, v9, s[12:15], s31 offen sc1
    s_mov_b64 exec, -1
    s_mov_b32 s56, s34
    s_mov_b32 s57, s38
    s_mov_b32 s59, s32
    s_mov_b32 s58, 8
    buffer_load_dwordx4 a[0:3], v2, s[12:15], s34 offen offset:0 sc1
    buffer_load_dwordx4 a[4:7], v2, s[12:15], s34 offen offset:1024 sc1
    buffer_load_dwordx4 a[8:11], v2, s[12:15], s34 offen offset:2048 sc1
    buffer_load_dwordx4 a[12:15], v2, s[12:15], s34 offen offset:3072 sc1
    s_add_u32 s34, s34, 4096
    buffer_load_dwordx4 a[16:19], v2, s[12:15], s34 offen offset:0 sc1
    buffer_load_dwordx4 a[20:23], v2, s[12:15], s34 offen offset:1024 sc1
    buffer_load_dwordx4 a[24:27], v2, s[12:15], s34 offen offset:2048 sc1
    buffer_load_dwordx4 a[28:31], v2, s[12:15], s34 offen offset:3072 sc1
    s_add_u32 s34, s34, 4096
    buffer_load_dwordx4 a[32:35], v2, s[12:15], s34 offen offset:0 sc1
    buffer_load_dwordx4 a[36:39], v2, s[12:15], s34 offen offset:1024 sc1
    buffer_load_dwordx4 a[40:43], v2, s[12:15], s34 offen offset:2048 sc1
    buffer_load_dwordx4 a[44:47], v2, s[12:15], s34 offen offset:3072 sc1
    s_add_u32 s34, s34, 4096
    buffer_load_dwordx4 a[48:51], v2, s[12:15], s34 offen offset:0 sc1
    buffer_load_dwordx4 a[52:55], v2, s[12:15], s34 offen offset:1024 sc1
    buffer_load_dwordx4 a[56:59], v2, s[12:15], s34 offen offset:2048 sc1
    buffer_load_dwordx4 a[60:63], v2, s[12:15], s34 offen offset:3072 sc1
    s_add_u32 s34, s34, 4096
    v_mov_b32 v36, 0
    v_mov_b32 v37, 0
    v_mov_b32 v38, 0
    v_mov_b32 v39, 0
    s_barrier
    ds_read_b128 v[40:43], v2 offset:0
    ds_read_b128 v[44:47], v2 offset:32768
    ds_read_b128 v[48:51], v2 offset:1024
    ds_read_b128 v[52:55], v2 offset:33792
    ds_read_b128 v[56:59], v2 offset:2048
    s_waitcnt vmcnt(12)
    v_mfma_f32_16x16x32_bf16 v[32:35], v[36:39], a[0:3], 0
    v_mfma_f32_16x16x32_bf16 v[32:35], v[36:39], a[4:7], v[32:35]
    v_mfma_f32_16x16x32_bf16 v[32:35], v[36:39], a[8:11], v[32:35]
    v_mfma_f32_16x16x32_bf16 v[32:35], v[36:39], a[12:15], v[32:35]
    s_nop 7
L_vt_27:
    v_cmp_u_f32 vcc, v32, v32
    s_nop 0
    s_cbranch_vccnz L_vs_28
L_vd_29:
    s_waitcnt lgkmcnt(3)
    v_mfma_f32_32x32x16_bf16 v[64:79], v[40:43], a[0:3], 0
    buffer_load_dwordx4 a[64:67], v2, s[12:15], s34 offen offset:0 sc1
    buffer_load_dwordx4 a[68:71], v2, s[12:15], s34 offen offset:1024 sc1
    buffer_load_dwordx4 a[72:75], v2, s[12:15], s34 offen offset:2048 sc1
    buffer_load_dwordx4 a[76:79], v2, s[12:15], s34 offen offset:3072 sc1
    s_add_u32 s34, s34, 4096
    ds_read_b128 v[60:63], v2 offset:34816
    v_mfma_f32_32x32x16_bf16 v[80:95], v[44:47], a[0:3], 0
    ds_read_b128 v[40:43], v2 offset:3072
    s_waitcnt lgkmcnt(3)
    v_mfma_f32_32x32x16_bf16 v[64:79], v[48:51], a[4:7], v[64:79]
    ds_read_b128 v[44:47], v2 offset:35840
    v_mfma_f32_32x32x16_bf16 v[80:95], v[52:55], a[4:7], v[80:95]
    ds_read_b128 v[48:51], v2 offset:4096
    s_waitcnt vmcnt(12)
    v_mfma_f32_16x16x32_bf16 v[32:35], v[36:39], a[16:19], 0
    v_mfma_f32_16x16x32_bf16 v[32:35], v[36:39], a[20:23], v[32:35]
    v_mfma_f32_16x16x32_bf16 v[32:35], v[36:39], a[24:27], v[32:35]
    v_mfma_f32_16x16x32_bf16 v[32:35], v[36:39], a[28:31], v[32:35]
    s_waitcnt lgkmcnt(3)
    v_mfma_f32_32x32x16_bf16 v[64:79], v[56:59], a[8:11], v[64:79]
    buffer_load_dwordx4 a[80:83], v2, s[12:15], s34 offen offset:0 sc1
    buffer_load_dwordx4 a[84:87], v2, s[12:15], s34 offen offset:1024 sc1
    buffer_load_dwordx4 a[88:91], v2, s[12:15], s34 offen offset:2048 sc1
    buffer_load_dwordx4 a[92:95], v2, s[12:15], s34 offen offset:3072 sc1
    s_add_u32 s34, s34, 4096
    ds_read_b128 v[52:55], v2 offset:36864
    v_mfma_f32_32x32x16_bf16 v[80:95], v[60:63], a[8:11], v[80:95]
    ds_read_b128 v[56:59], v2 offset:5120
    s_waitcnt lgkmcnt(3)
    v_mfma_f32_32x32x16_bf16 v[64:79], v[40:43], a[12:15], v[64:79]
    ds_read_b128 v[60:63], v2 offset:37888
    v_mfma_f32_32x32x16_bf16 v[80:95], v[44:47], a[12:15], v[80:95]
    ds_read_b128 v[40:43], v2 offset:6144
L_vt_30:
    v_cmp_u_f32 vcc, v32, v32
    s_nop 0
    s_cbranch_vccnz L_vs_31
L_vd_32:
    s_waitcnt lgkmcnt(3)
    v_mfma_f32_32x32x16_bf16 v[64:79], v[48:51], a[16:19], v[64:79]
    buffer_load_dwordx4 a[96:99], v2, s[12:15], s34 offen offset:0 sc1
    buffer_load_dwordx4 a[100:103], v2, s[12:15], s34 offen offset:1024 sc1
    buffer_load_dwordx4 a[104:107], v2, s[12:15], s34 offen offset:2048 sc1
    buffer_load_dwordx4 a[108:111], v2, s[12:15], s34 offen offset:3072 sc1
    s_add_u32 s34, s34, 4096
    ds_read_b128 v[44:47], v2 offset:38912
    v_mfma_f32_32x32x16_bf16 v[80:95], v[52:55], a[16:19], v[80:95]
    ds_read_b128 v[48:51], v2 offset:7168
    s_waitcnt lgkmcnt(3)
    v_mfma_f32_32x32x16_bf16 v[64:79], v[56:59], a[20:23], v[64:79]
    ds_read_b128 v[52:55], v2 offset:39936
    v_mfma_f32_32x32x16_bf16 v[80:95], v[60:63], a[20:23], v[80:95]
    ds_read_b128 v[56:59], v2 offset:8192
    s_waitcnt vmcnt(16)
    v_mfma_f32_16x16x32_bf16 v[32:35], v[36:39], a[32:35], 0
    v_mfma_f32_16x16x32_bf16 v[32:35], v[36:39], a[36:39], v[32:35]
    v_mfma_f32_16x16x32_bf16 v[32:35], v[36:39], a[40:43], v[32:35]
    v_mfma_f32_16x16x32_bf16 v[32:35], v[36:39], a[44:47], v[32:35]
    s_waitcnt lgkmcnt(3)
    v_mfma_f32_32x32x16_bf16 v[64:79], v[40:43], a[24:27], v[64:79]
    buffer_load_dwordx4 a[112:115], v2, s[12:15], s34 offen offset:0 sc1
    buffer_load_dwordx4 a[116:119], v2, s[12:15], s34 offen offset:1024 sc1
    buffer_load_dwordx4 a[120:123], v2, s[12:15], s34 offen offset:2048 sc1
    buffer_load_dwordx4 a[124:127], v2, s[12:15], s34 offen offset:3072 sc1
    s_add_u32 s34, s34, 4096
    s_barrier
    ds_read_b128 v[60:63], v2 offset:40960
    v_mfma_f32_32x32x16_bf16 v[80:95], v[44:47], a[24:27], v[80:95]
    ds_read_b128 v[40:43], v2 offset:9216
    s_waitcnt lgkmcnt(3)
    v_mfma_f32_32x32x16_bf16 v[64:79], v[48:51], a[28:31], v[64:79]
    ds_read_b128 v[44:47], v2 offset:41984
    v_mfma_f32_32x32x16_bf16 v[80:95], v[52:55], a[28:31], v[80:95]
    ds_read_b128 v[48:51], v2 offset:10240
L_vt_33:
    v_cmp_u_f32 vcc, v32, v32
    s_nop 0
    s_cbranch_vccnz L_vs_34
L_vd_35:
    s_waitcnt lgkmcnt(3)
    v_mfma_f32_32x32x16_bf16 v[64:79], v[56:59], a[32:35], v[64:79]
    s_add_u32 s31, s38, 0
    buffer_load_dword v6, v7, s[12:15], s31 offen sc1
    ds_read_b128 v[52:55], v2 offset:43008
    v_mfma_f32_32x32x16_bf16 v[80:95], v[60:63], a[32:35], v[80:95]
    ds_read_b128 v[56:59], v2 offset:11264
    s_waitcnt lgkmcnt(3)
    v_mfma_f32_32x32x16_bf16 v[64:79], v[40:43], a[36:39], v[64:79]
    ds_read_b128 v[60:63], v2 offset:44032
    v_mfma_f32_32x32x16_bf16 v[80:95], v[44:47], a[36:39], v[80:95]
    ds_read_b128 v[40:43], v2 offset:12288
    s_waitcnt vmcnt(17)
    v_mfma_f32_16x16x32_bf16 v[32:35], v[36:39], a[48:51], 0
    v_mfma_f32_16x16x32_bf16 v[32:35], v[36:39], a[52:55], v[32:35]
    v_mfma_f32_16x16x32_bf16 v[32:35], v[36:39], a[56:59], v[32:35]
    v_mfma_f32_16x16x32_bf16 v[32:35], v[36:39], a[60:63], v[32:35]
    s_waitcnt lgkmcnt(3)
    v_mfma_f32_32x32x16_bf16 v[64:79], v[48:51], a[40:43], v[64:79]
    ds_read_b128 v[44:47], v2 offset:45056
    v_mfma_f32_32x32x16_bf16 v[80:95], v[52:55], a[40:43], v[80:95]
    ds_read_b128 v[48:51], v2 offset:13312
    s_waitcnt lgkmcnt(3)
    v_mfma_f32_32x32x16_bf16 v[64:79], v[56:59], a[44:47], v[64:79]
    ds_read_b128 v[52:55], v2 offset:46080
    v_mfma_f32_32x32x16_bf16 v[80:95], v[60:63], a[44:47], v[80:95]
    ds_read_b128 v[56:59], v2 offset:14336
L_vt_36:
    v_cmp_u_f32 vcc, v32, v32
    s_nop 0
    s_cbranch_vccnz L_vs_37
L_vd_38:
    s_waitcnt lgkmcnt(3)
    v_mfma_f32_32x32x16_bf16 v[64:79], v[40:43], a[48:51], v[64:79]
    ds_read_b128 v[60:63], v2 offset:47104
    v_mfma_f32_32x32x16_bf16 v[80:95], v[44:47], a[48:51], v[80:95]
    ds_read_b128 v[40:43], v2 offset:15360
    s_waitcnt lgkmcnt(3)
    v_mfma_f32_32x32x16_bf16 v[64:79], v[48:51], a[52:55], v[64:79]
    ds_read_b128 v[44:47], v2 offset:48128
    v_mfma_f32_32x32x16_bf16 v[80:95], v[52:55], a[52:55], v[80:95]
    ds_read_b128 v[48:51], v2 offset:16384
    s_waitcnt vmcnt(13)
    v_mfma_f32_16x16x32_bf16 v[32:35], v[36:39], a[64:67], 0
    v_mfma_f32_16x16x32_bf16 v[32:35], v[36:39], a[68:71], v[32:35]
    v_mfma_f32_16x16x32_bf16 v[32:35], v[36:39], a[72:75], v[32:35]
    v_mfma_f32_16x16x32_bf16 v[32:35], v[36:39], a[76:79], v[32:35]
    s_waitcnt lgkmcnt(3)
    v_mfma_f32_32x32x16_bf16 v[64:79], v[56:59], a[56:59], v[64:79]
    ds_read_b128 v[52:55], v2 offset:49152
    v_mfma_f32_32x32x16_bf16 v[80:95], v[60:63], a[56:59], v[80:95]
    ds_read_b128 v[56:59], v2 offset:17408
    s_waitcnt lgkmcnt(3)
    v_mfma_f32_32x32x16_bf16 v[64:79], v[40:43], a[60:63], v[64:79]
    ds_read_b128 v[60:63], v2 offset:50176
    v_mfma_f32_32x32x16_bf16 v[80:95], v[44:47], a[60:63], v[80:95]
    ds_read_b128 v[40:43], v2 offset:18432
L_vt_39:
    v_cmp_u_f32 vcc, v32, v32
    s_nop 0
    s_cbranch_vccnz L_vs_40
L_vd_41:
    s_waitcnt vmcnt(0)
    v_cmp_ne_u32 vcc, 1, v6
    s_nop 0
    s_cbranch_vccz L_pok_42
    s_mov_b32 s47, 0x20000
    s_add_u32 s31, s38, 0
L_spin_43:
    buffer_load_dword v6, v7, s[12:15], s31 offen sc1
    s_sub_u32 s47, s47, 1
    s_waitcnt vmcnt(0)
    v_cmp_ne_u32 vcc, 1, v6
    s_cbranch_scc1 L_spok_44
    s_cbranch_vccnz L_spin_43
L_spok_44:
L_pok_42:
    v_lshlrev_b32 v3, 3, v1
    buffer_load_dwordx2 v[96:97], v3, s[12:15], s59 offen offset:0 sc1
    buffer_load_dwordx2 v[98:99], v3, s[12:15], s59 offen offset:512 sc1
    buffer_load_dwordx2 v[100:101], v3, s[12:15], s59 offen offset:1024 sc1
    buffer_load_dwordx2 v[102:103], v3, s[12:15], s59 offen offset:1536 sc1
    buffer_load_dwordx2 v[104:105], v3, s[12:15], s59 offen offset:2048 sc1
    buffer_load_dwordx2 v[106:107], v3, s[12:15], s59 offen offset:2560 sc1
    buffer_load_dwordx2 v[108:109], v3, s[12:15], s59 offen offset:3072 sc1
    buffer_load_dwordx2 v[110:111], v3, s[12:15], s59 offen offset:3584 sc1
    s_waitcnt lgkmcnt(3)
    v_mfma_f32_32x32x16_bf16 v[64:79], v[48:51], a[64:67], v[64:79]
    ds_read_b128 v[44:47], v2 offset:51200
    v_mfma_f32_32x32x16_bf16 v[80:95], v[52:55], a[64:67], v[80:95]
    ds_read_b128 v[48:51], v2 offset:19456
    s_waitcnt lgkmcnt(3)
    v_mfma_f32_32x32x16_bf16 v[64:79], v[56:59], a[68:71], v[64:79]
    ds_read_b128 v[52:55], v2 offset:52224
    v_mfma_f32_32x32x16_bf16 v[80:95], v[60:63], a[68:71], v[80:95]
    ds_read_b128 v[56:59], v2 offset:20480
    v_mfma_f32_16x16x32_bf16 v[32:35], v[36:39], a[80:83], 0
    v_mfma_f32_16x16x32_bf16 v[32:35], v[36:39], a[84:87], v[32:35]
    v_mfma_f32_16x16x32_bf16 v[32:35], v[36:39], a[88:91], v[32:35]
    v_mfma_f32_16x16x32_bf16 v[32:35], v[36:39], a[92:95], v[32:35]
    s_waitcnt lgkmcnt(3)
    v_mfma_f32_32x32x16_bf16 v[64:79], v[40:43], a[72:75], v[64:79]
    ds_read_b128 v[60:63], v2 offset:53248
    v_mfma_f32_32x32x16_bf16 v[80:95], v[44:47], a[72:75], v[80:95]
    ds_read_b128 v[40:43], v2 offset:21504
    s_waitcnt lgkmcnt(3)
    v_mfma_f32_32x32x16_bf16 v[64:79], v[48:51], a[76:79], v[64:79]
    ds_read_b128 v[44:47], v2 offset:54272
    v_mfma_f32_32x32x16_bf16 v[80:95], v[52:55], a[76:79], v[80:95]
    ds_read_b128 v[48:51], v2 offset:22528
L_vt_45:
    v_cmp_u_f32 vcc, v32, v32
    s_nop 0
    s_cbranch_vccnz L_vs_46
L_vd_47:
    s_waitcnt lgkmcnt(3)
    v_mfma_f32_32x32x16_bf16 v[64:79], v[56:59], a[80:83], v[64:79]
    ds_read_b128 v[52:55], v2 offset:55296
    v_mfma_f32_32x32x16_bf16 v[80:95], v[60:63], a[80:83], v[80:95]
    ds_read_b128 v[56:59], v2 offset:23552
    s_waitcnt lgkmcnt(3)
    v_mfma_f32_32x32x16_bf16 v[64:79], v[40:43], a[84:87], v[64:79]
    ds_read_b128 v[60:63], v2 offset:56320
    v_mfma_f32_32x32x16_bf16 v[80:95], v[44:47], a[84:87], v[80:95]
    ds_read_b128 v[40:43], v2 offset:24576
    v_mfma_f32_16x16x32_bf16 v[32:35], v[36:39], a[96:99], 0
    v_mfma_f32_16x16x32_bf16 v[32:35], v[36:39], a[100:103], v[32:35]
    v_mfma_f32_16x16x32_bf16 v[32:35], v[36:39], a[104:107], v[32:35]
    v_mfma_f32_16x16x32_bf16 v[32:35], v[36:39], a[108:111], v[32:35]
    s_waitcnt lgkmcnt(3)
    v_mfma_f32_32x32x16_bf16 v[64:79], v[48:51], a[88:91], v[64:79]
    ds_read_b128 v[44:47], v2 offset:57344
    v_mfma_f32_32x32x16_bf16 v[80:95], v[52:55], a[88:91], v[80:95]
    ds_read_b128 v[48:51], v2 offset:25600
    s_waitcnt lgkmcnt(3)
    v_mfma_f32_32x32x16_bf16 v[64:79], v[56:59], a[92:95], v[64:79]
    ds_read_b128 v[52:55], v2 offset:58368
    v_mfma_f32_32x32x16_bf16 v[80:95], v[60:63], a[92:95], v[80:95]
    ds_read_b128 v[56:59], v2 offset:26624
L_vt_48:
    v_cmp_u_f32 vcc, v32, v32
    s_nop 0
    s_cbranch_vccnz L_vs_49
L_vd_50:
    s_waitcnt lgkmcnt(3)
    v_mfma_f32_32x32x16_bf16 v[64:79], v[40:43], a[96:99], v[64:79]
    ds_read_b128 v[60:63], v2 offset:59392
    s_waitcnt vmcnt(0)
    v_add_f32 v96, v96, v98
    v_add_f32 v97, v97, v99
    v_add_f32 v96, v96, v100
    v_add_f32 v97, v97, v101
    v_add_f32 v96, v96, v102
    v_add_f32 v97, v97, v103
    v_add_f32 v96, v96, v104
    v_add_f32 v97, v97, v105
    v_add_f32 v96, v96, v106
    v_add_f32 v97, v97, v107
    v_add_f32 v96, v96, v108
    v_add_f32 v97, v97, v109
    v_add_f32 v96, v96, v110
    v_add_f32 v97, v97, v111
    v_mov_b32 v3, v96
    s_nop 1
    v_permlane32_swap_b32 v96, v3
    s_nop 1
    v_add_f32 v96, v96, v3
    v_mov_b32 v3, v97
    s_nop 1
    v_permlane32_swap_b32 v97, v3
    s_nop 1
    v_add_f32 v97, v97, v3
    v_mul_f32 v21, 0xbb000000, v96
    v_mul_f32 v20, 0x3b000000, v97
    ds_read_b128 v[96:99], v22 offset:256
    ds_read_b128 v[100:103], v22 offset:288
    ds_read_b128 v[104:107], v22 offset:320
    ds_read_b128 v[108:111], v22 offset:352
    ds_read_b128 v[112:115], v22 offset:384
    ds_read_b128 v[116:119], v22 offset:416
    ds_read_b128 v[120:123], v22 offset:448
    ds_read_b128 v[124:127], v22 offset:480
    v_mfma_f32_32x32x16_bf16 v[80:95], v[44:47], a[96:99], v[80:95]
    v_fma_f32 v20, -v21, v21, v20
    v_max_f32 v20, 0, v20
    v_add_f32 v20, 0x3727c5ac, v20
    v_rsq_f32 v5, v20
    ds_read_b128 v[40:43], v2 offset:27648
    s_waitcnt lgkmcnt(11)
    v_mfma_f32_32x32x16_bf16 v[64:79], v[48:51], a[100:103], v[64:79]
    s_nop 0
    v_mul_f32 v18, 0xc0135761, v5
    v_mul_f32 v19, v5, v5
    v_mul_f32 v19, v19, v18
    ds_read_b128 v[44:47], v2 offset:60416
    v_mfma_f32_32x32x16_bf16 v[80:95], v[52:55], a[100:103], v[80:95]
    v_mul_f32 v19, 0x3d372713, v19
    s_waitcnt lgkmcnt(6)
    v_mul_f32 v96, v21, v96
    v_mul_f32 v97, v21, v97
    v_mul_f32 v98, v21, v98
    ds_read_b128 v[48:51], v2 offset:28672
    v_mfma_f32_16x16x32_bf16 v[32:35], v[36:39], a[112:115], 0
    v_mfma_f32_16x16x32_bf16 v[32:35], v[36:39], a[116:119], v[32:35]
    v_mfma_f32_16x16x32_bf16 v[32:35], v[36:39], a[120:123], v[32:35]
    v_mfma_f32_16x16x32_bf16 v[32:35], v[36:39], a[124:127], v[32:35]
    v_mfma_f32_32x32x16_bf16 v[64:79], v[56:59], a[104:107], v[64:79]
    v_mul_f32 v99, v21, v99
    v_mul_f32 v100, v21, v100
    v_mul_f32 v101, v21, v101
    v_mul_f32 v102, v21, v102
    ds_read_b128 v[52:55], v2 offset:61440
    v_mfma_f32_32x32x16_bf16 v[80:95], v[60:63], a[104:107], v[80:95]
    v_mul_f32 v103, v21, v103
    v_mul_f32 v104, v21, v104
    v_mul_f32 v105, v21, v105
    v_mul_f32 v106, v21, v106
    ds_read_b128 v[56:59], v2 offset:29696
    s_waitcnt lgkmcnt(3)
    v_mfma_f32_32x32x16_bf16 v[64:79], v[40:43], a[108:111], v[64:79]
    v_mul_f32 v107, v21, v107
    v_mul_f32 v108, v21, v108
    v_mul_f32 v109, v21, v109
    v_mul_f32 v110, v21, v110
    ds_read_b128 v[60:63], v2 offset:62464
    v_mfma_f32_32x32x16_bf16 v[80:95], v[44:47], a[108:111], v[80:95]
    v_mul_f32 v111, v21, v111
    v_mul_f32 v112, v21, v112
    v_mul_f32 v113, v21, v113
    v_mul_f32 v114, v21, v114
    ds_read_b128 v[40:43], v2 offset:30720
L_vt_51:
    v_cmp_u_f32 vcc, v32, v32
    s_nop 0
    s_cbranch_vccnz L_vs_52
L_vd_53:
    s_waitcnt lgkmcnt(3)
    v_mfma_f32_32x32x16_bf16 v[64:79], v[48:51], a[112:115], v[64:79]
    v_mul_f32 v115, v21, v115
    v_mul_f32 v116, v21, v116
    v_mul_f32 v117, v21, v117
    v_mul_f32 v118, v21, v118
    ds_read_b128 v[44:47], v2 offset:63488
    v_mfma_f32_32x32x16_bf16 v[80:95], v[52:55], a[112:115], v[80:95]
    v_mul_f32 v119, v21, v119
    v_mul_f32 v120, v21, v120
    v_mul_f32 v121, v21, v121
    v_mul_f32 v122, v21, v122
    ds_read_b128 v[48:51], v2 offset:31744
    s_waitcnt lgkmcnt(3)
    v_mfma_f32_32x32x16_bf16 v[64:79], v[56:59], a[116:119], v[64:79]
    v_mul_f32 v123, v21, v123
    v_mul_f32 v124, v21, v124
    v_mul_f32 v125, v21, v125
    v_mul_f32 v126, v21, v126
    ds_read_b128 v[52:55], v2 offset:64512
    s_lshl_b32 s31, s27, 7
    s_add_u32 s39, s38, s31
    s_lshl_b32 s38, s30, 11
    s_lshl_b32 s31, s29, 10
    s_add_u32 s38, s38, s31
    s_add_u32 s38, s38, 0x1100000
    v_and_b32 v7, 0x380, v7
    v_mfma_f32_32x32x16_bf16 v[80:95], v[60:63], a[116:119], v[80:95]
    v_mul_f32 v127, v21, v127
    s_barrier
    ds_read_b128 v[56:59], v17 offset:0
    s_waitcnt lgkmcnt(3)
    v_mfma_f32_32x32x16_bf16 v[64:79], v[40:43], a[120:123], v[64:79]
    ds_read_b128 v[60:63], v17 offset:32768
    v_mfma_f32_32x32x16_bf16 v[80:95], v[44:47], a[120:123], v[80:95]
    ds_read_b128 v[40:43], v17 offset:1024
    s_waitcnt lgkmcnt(3)
    v_mfma_f32_32x32x16_bf16 v[64:79], v[48:51], a[124:127], v[64:79]
    ds_read_b128 v[44:47], v17 offset:33792
    v_mfma_f32_32x32x16_bf16 v[80:95], v[52:55], a[124:127], v[80:95]
    s_nop 1
    s_barrier
    ds_read_b128 v[48:51], v17 offset:2048
    s_waitcnt lgkmcnt(3)
    v_mfma_f32_32x32x16_bf16 v[96:111], v[56:59], a[0:3], v[96:111]
    ds_read_b128 v[52:55], v17 offset:34816
    v_mfma_f32_32x32x16_bf16 v[112:127], v[60:63], a[0:3], v[112:127]
    ds_read_b128 v[56:59], v17 offset:3072
    s_waitcnt lgkmcnt(3)
    v_mfma_f32_32x32x16_bf16 v[96:111], v[40:43], a[4:7], v[96:111]
    ds_read_b128 v[60:63], v17 offset:35840
    v_mfma_f32_32x32x16_bf16 v[112:127], v[44:47], a[4:7], v[112:127]
    ds_read_b128 v[40:43], v17 offset:4096
    s_waitcnt lgkmcnt(3)
    v_mfma_f32_32x32x16_bf16 v[96:111], v[48:51], a[8:11], v[96:111]
    ds_read_b128 v[44:47], v17 offset:36864
    v_mfma_f32_32x32x16_bf16 v[112:127], v[52:55], a[8:11], v[112:127]
    ds_read_b128 v[48:51], v17 offset:5120
    s_waitcnt lgkmcnt(3)
    v_mfma_f32_32x32x16_bf16 v[96:111], v[56:59], a[12:15], v[96:111]
    ds_read_b128 v[32:35], v22 offset:0
    ds_read_b128 v[36:39], v22 offset:32
    ds_read_b128 v[52:55], v17 offset:37888
    v_mfma_f32_32x32x16_bf16 v[112:127], v[60:63], a[12:15], v[112:127]
    ds_read_b128 v[56:59], v17 offset:6144
    s_waitcnt lgkmcnt(5)
    v_mfma_f32_32x32x16_bf16 v[96:111], v[40:43], a[16:19], v[96:111]
    s_waitcnt lgkmcnt(2)
    v_fma_f32 v64, v32, v21, v64
    v_fma_f32 v65, v33, v21, v65
    v_fma_f32 v66, v34, v21, v66
    v_fma_f32 v67, v35, v21, v67
    ds_read_b128 v[60:63], v17 offset:38912
    v_mfma_f32_32x32x16_bf16 v[112:127], v[44:47], a[16:19], v[112:127]
    v_fma_f32 v68, v36, v21, v68
    v_fma_f32 v69, v37, v21, v69
    v_fma_f32 v70, v38, v21, v70
    v_fma_f32 v71, v39, v21, v71
    ds_read_b128 v[40:43], v17 offset:7168
    s_waitcnt lgkmcnt(3)
    v_mfma_f32_32x32x16_bf16 v[96:111], v[48:51], a[20:23], v[96:111]
    ds_read_b128 v[32:35], v22 offset:64
    ds_read_b128 v[36:39], v22 offset:96
    ds_read_b128 v[44:47], v17 offset:39936
    v_mfma_f32_32x32x16_bf16 v[112:127], v[52:55], a[20:23], v[112:127]
    ds_read_b128 v[48:51], v17 offset:8192
    s_waitcnt lgkmcnt(5)
    v_mfma_f32_32x32x16_bf16 v[96:111], v[56:59], a[24:27], v[96:111]
    s_waitcnt lgkmcnt(2)
    v_fma_f32 v72, v32, v21, v72
    v_fma_f32 v73, v33, v21, v73
    v_fma_f32 v74, v34, v21, v74
    v_fma_f32 v75, v35, v21, v75
    ds_read_b128 v[52:55], v17 offset:40960
    v_mfma_f32_32x32x16_bf16 v[112:127], v[60:63], a[24:27], v[112:127]
    v_fma_f32 v76, v36, v21, v76
    v_fma_f32 v77, v37, v21, v77
    v_fma_f32 v78, v38, v21, v78
    v_fma_f32 v79, v39, v21, v79
    ds_read_b128 v[56:59], v17 offset:9216
    s_waitcnt lgkmcnt(3)
    v_mfma_f32_32x32x16_bf16 v[96:111], v[40:43], a[28:31], v[96:111]
    v_mul_f32 v32, v64, v64
    v_mul_f32 v33, v65, v65
    v_mul_f32 v34, v66, v66
    v_mul_f32 v35, v67, v67
    ds_read_b128 v[60:63], v17 offset:41984
    v_mfma_f32_32x32x16_bf16 v[112:127], v[44:47], a[28:31], v[112:127]
    v_mul_f32 v36, v68, v68
    v_mul_f32 v37, v69, v69
    v_mul_f32 v38, v70, v70
    v_mul_f32 v39, v71, v71
    ds_read_b128 v[40:43], v17 offset:10240
    s_waitcnt lgkmcnt(3)
    v_mfma_f32_32x32x16_bf16 v[96:111], v[48:51], a[32:35], v[96:111]
    v_fma_f32 v32, v32, v19, v18
    v_fma_f32 v33, v33, v19, v18
    v_fma_f32 v34, v34, v19, v18
    v_fma_f32 v35, v35, v19, v18
    ds_read_b128 v[44:47], v17 offset:43008
    v_mfma_f32_32x32x16_bf16 v[112:127], v[52:55], a[32:35], v[112:127]
    v_fma_f32 v36, v36, v19, v18
    v_fma_f32 v37, v37, v19, v18
    v_fma_f32 v38, v38, v19, v18
    v_fma_f32 v39, v39, v19, v18
    ds_read_b128 v[48:51], v17 offset:11264
    s_waitcnt lgkmcnt(3)
    v_mfma_f32_32x32x16_bf16 v[96:111], v[56:59], a[36:39], v[96:111]
    v_mul_f32 v32, v32, v64
    v_mul_f32 v33, v33, v65
    v_mul_f32 v34, v34, v66
    v_mul_f32 v35, v35, v67
    ds_read_b128 v[52:55], v17 offset:44032
    v_mfma_f32_32x32x16_bf16 v[112:127], v[60:63], a[36:39], v[112:127]
    v_mul_f32 v36, v36, v68
    v_mul_f32 v37, v37, v69
    v_mul_f32 v38, v38, v70
    v_mul_f32 v39, v39, v71
    ds_read_b128 v[56:59], v17 offset:12288
    s_waitcnt lgkmcnt(3)
    v_mfma_f32_32x32x16_bf16 v[96:111], v[40:43], a[40:43], v[96:111]
    v_exp_f32 v32, v32
    v_mul_f32 v64, v64, v72
    v_exp_f32 v33, v33
    ds_read_b128 v[60:63], v17 offset:45056
    v_mfma_f32_32x32x16_bf16 v[112:127], v[44:47], a[40:43], v[112:127]
    v_mul_f32 v65, v65, v73
    v_exp_f32 v34, v34
    v_mul_f32 v66, v66, v74
    ds_read_b128 v[40:43], v17 offset:13312
    s_waitcnt lgkmcnt(3)
    v_mfma_f32_32x32x16_bf16 v[96:111], v[48:51], a[44:47], v[96:111]
    v_exp_f32 v35, v35
    v_mul_f32 v67, v67, v75
    v_exp_f32 v36, v36
    ds_read_b128 v[44:47], v17 offset:46080
    v_mfma_f32_32x32x16_bf16 v[112:127], v[52:55], a[44:47], v[112:127]
    v_mul_f32 v68, v68, v76
    v_exp_f32 v37, v37
    v_mul_f32 v69, v69, v77
    ds_read_b128 v[48:51], v17 offset:14336
    s_waitcnt lgkmcnt(3)
    v_mfma_f32_32x32x16_bf16 v[96:111], v[56:59], a[48:51], v[96:111]
    v_exp_f32 v38, v38
    v_mul_f32 v70, v70, v78
    v_exp_f32 v39, v39
    ds_read_b128 v[52:55], v17 offset:47104
    v_mfma_f32_32x32x16_bf16 v[112:127], v[60:63], a[48:51], v[112:127]
    v_mul_f32 v71, v71, v79
    v_fma_f32 v32, v32, v20, v20
    v_fma_f32 v33, v33, v20, v20
    v_fma_f32 v34, v34, v20, v20
    ds_read_b128 v[56:59], v17 offset:15360
    s_waitcnt lgkmcnt(3)
    v_mfma_f32_32x32x16_bf16 v[96:111], v[40:43], a[52:55], v[96:111]
    v_fma_f32 v35, v35, v20, v20
    v_fma_f32 v36, v36, v20, v20
    v_fma_f32 v37, v37, v20, v20
    v_fma_f32 v38, v38, v20, v20
    ds_read_b128 v[60:63], v17 offset:48128
    v_mfma_f32_32x32x16_bf16 v[112:127], v[44:47], a[52:55], v[112:127]
    v_fma_f32 v39, v39, v20, v20
    v_rcp_f32 v32, v32
    v_rcp_f32 v33, v33
    ds_read_b128 v[40:43], v17 offset:16384
    s_waitcnt lgkmcnt(3)
    v_mfma_f32_32x32x16_bf16 v[96:111], v[48:51], a[56:59], v[96:111]
    v_rcp_f32 v34, v34
    v_mul_f32 v64, v64, v32
    v_rcp_f32 v35, v35
    ds_read_b128 v[44:47], v17 offset:49152
    v_mfma_f32_32x32x16_bf16 v[112:127], v[52:55], a[56:59], v[112:127]
    v_mul_f32 v65, v65, v33
    v_rcp_f32 v36, v36
    v_mul_f32 v66, v66, v34
    ds_read_b128 v[48:51], v17 offset:17408
    s_waitcnt lgkmcnt(3)
    v_mfma_f32_32x32x16_bf16 v[96:111], v[56:59], a[60:63], v[96:111]
    v_rcp_f32 v37, v37
    v_mul_f32 v67, v67, v35
    v_rcp_f32 v38, v38
    ds_read_b128 v[52:55], v17 offset:50176
    v_mfma_f32_32x32x16_bf16 v[112:127], v[60:63], a[60:63], v[112:127]
    v_mul_f32 v68, v68, v36
    v_rcp_f32 v39, v39
    v_mul_f32 v69, v69, v37
    ds_read_b128 v[56:59], v17 offset:18432
    s_waitcnt lgkmcnt(3)
    v_mfma_f32_32x32x16_bf16 v[96:111], v[40:43], a[64:67], v[96:111]
    v_mul_f32 v70, v70, v38
    v_mul_f32 v71, v71, v39
    v_cvt_pk_bf16_f32 v72, v64, v65
    v_cvt_pk_bf16_f32 v73, v66, v67
    ds_read_b128 v[60:63], v17 offset:51200
    v_mfma_f32_32x32x16_bf16 v[112:127], v[44:47], a[64:67], v[112:127]
    v_cvt_pk_bf16_f32 v74, v68, v69
    v_cvt_pk_bf16_f32 v75, v70, v71
    buffer_store_dwordx4 v[72:75], v2, s[12:15], s45 offen offset:0 sc1
    s_nop 1
    ds_read_b128 v[64:67], v22 offset:512
    ds_read_b128 v[68:71], v22 offset:544
    ds_read_b128 v[72:75], v22 offset:576
    ds_read_b128 v[76:79], v22 offset:608
    ds_read_b128 v[32:35], v22 offset:128
    ds_read_b128 v[36:39], v22 offset:160
    ds_read_b128 v[40:43], v17 offset:19456
    s_waitcnt lgkmcnt(9)
    v_mfma_f32_32x32x16_bf16 v[96:111], v[48:51], a[68:71], v[96:111]
    ds_read_b128 v[44:47], v17 offset:52224
    v_mfma_f32_32x32x16_bf16 v[112:127], v[52:55], a[68:71], v[112:127]
    s_waitcnt lgkmcnt(2)
    v_fma_f32 v80, v32, v21, v80
    v_fma_f32 v81, v33, v21, v81
    v_fma_f32 v82, v34, v21, v82
    v_fma_f32 v83, v35, v21, v83
    ds_read_b128 v[48:51], v17 offset:20480
    v_mfma_f32_32x32x16_bf16 v[96:111], v[56:59], a[72:75], v[96:111]
    v_fma_f32 v84, v36, v21, v84
    v_fma_f32 v85, v37, v21, v85
    v_fma_f32 v86, v38, v21, v86
    v_fma_f32 v87, v39, v21, v87
    ds_read_b128 v[52:55], v17 offset:53248
    v_mfma_f32_32x32x16_bf16 v[112:127], v[60:63], a[72:75], v[112:127]
    ds_read_b128 v[32:35], v22 offset:192
    ds_read_b128 v[36:39], v22 offset:224
    ds_read_b128 v[56:59], v17 offset:21504
    s_waitcnt lgkmcnt(5)
    v_mfma_f32_32x32x16_bf16 v[96:111], v[40:43], a[76:79], v[96:111]
    ds_read_b128 v[60:63], v17 offset:54272
    v_mfma_f32_32x32x16_bf16 v[112:127], v[44:47], a[76:79], v[112:127]
    s_waitcnt lgkmcnt(2)
    v_fma_f32 v88, v32, v21, v88
    v_fma_f32 v89, v33, v21, v89
    v_fma_f32 v90, v34, v21, v90
    v_fma_f32 v91, v35, v21, v91
    ds_read_b128 v[40:43], v17 offset:22528
    v_mfma_f32_32x32x16_bf16 v[96:111], v[48:51], a[80:83], v[96:111]
    v_fma_f32 v92, v36, v21, v92
    v_fma_f32 v93, v37, v21, v93
    v_fma_f32 v94, v38, v21, v94
    v_fma_f32 v95, v39, v21, v95
    ds_read_b128 v[44:47], v17 offset:55296
    v_mfma_f32_32x32x16_bf16 v[112:127], v[52:55], a[80:83], v[112:127]
    v_mul_f32 v32, v80, v80
    v_mul_f32 v33, v81, v81
    v_mul_f32 v34, v82, v82
    v_mul_f32 v35, v83, v83
    ds_read_b128 v[48:51], v17 offset:23552
    s_waitcnt lgkmcnt(3)
    v_mfma_f32_32x32x16_bf16 v[96:111], v[56:59], a[84:87], v[96:111]
    v_mul_f32 v36, v84, v84
    v_mul_f32 v37, v85, v85
    v_mul_f32 v38, v86, v86
    v_mul_f32 v39, v87, v87
    ds_read_b128 v[52:55], v17 offset:56320
    v_mfma_f32_32x32x16_bf16 v[112:127], v[60:63], a[84:87], v[112:127]
    v_fma_f32 v32, v32, v19, v18
    v_fma_f32 v33, v33, v19, v18
    v_fma_f32 v34, v34, v19, v18
    v_fma_f32 v35, v35, v19, v18
    ds_read_b128 v[56:59], v17 offset:24576
    s_waitcnt lgkmcnt(3)
    v_mfma_f32_32x32x16_bf16 v[96:111], v[40:43], a[88:91], v[96:111]
    v_fma_f32 v36, v36, v19, v18
    v_fma_f32 v37, v37, v19, v18
    v_fma_f32 v38, v38, v19, v18
    v_fma_f32 v39, v39, v19, v18
    ds_read_b128 v[60:63], v17 offset:57344
    v_mfma_f32_32x32x16_bf16 v[112:127], v[44:47], a[88:91], v[112:127]
    v_mul_f32 v32, v32, v80
    v_mul_f32 v33, v33, v81
    v_mul_f32 v34, v34, v82
    v_mul_f32 v35, v35, v83
    ds_read_b128 v[40:43], v17 offset:25600
    s_waitcnt lgkmcnt(3)
    v_mfma_f32_32x32x16_bf16 v[96:111], v[48:51], a[92:95], v[96:111]
    v_mul_f32 v36, v36, v84
    v_mul_f32 v37, v37, v85
    v_mul_f32 v38, v38, v86
    v_mul_f32 v39, v39, v87
    ds_read_b128 v[44:47], v17 offset:58368
    v_mfma_f32_32x32x16_bf16 v[112:127], v[52:55], a[92:95], v[112:127]
    v_exp_f32 v32, v32
    v_mul_f32 v80, v80, v88
    v_exp_f32 v33, v33
    ds_read_b128 v[48:51], v17 offset:26624
    s_waitcnt lgkmcnt(3)
    v_mfma_f32_32x32x16_bf16 v[96:111], v[56:59], a[96:99], v[96:111]
    v_mul_f32 v81, v81, v89
    v_exp_f32 v34, v34
    v_mul_f32 v82, v82, v90
    ds_read_b128 v[52:55], v17 offset:59392
    v_mfma_f32_32x32x16_bf16 v[112:127], v[60:63], a[96:99], v[112:127]
    v_exp_f32 v35, v35
    v_mul_f32 v83, v83, v91
    v_exp_f32 v36, v36
    ds_read_b128 v[56:59], v17 offset:27648
    s_waitcnt lgkmcnt(3)
    v_mfma_f32_32x32x16_bf16 v[96:111], v[40:43], a[100:103], v[96:111]
    v_mul_f32 v84, v84, v92
    v_exp_f32 v37, v37
    v_mul_f32 v85, v85, v93
    ds_read_b128 v[60:63], v17 offset:60416
    v_mfma_f32_32x32x16_bf16 v[112:127], v[44:47], a[100:103], v[112:127]
    v_exp_f32 v38, v38
    v_mul_f32 v86, v86, v94
    v_exp_f32 v39, v39
    ds_read_b128 v[40:43], v17 offset:28672
    s_waitcnt lgkmcnt(3)
    v_mfma_f32_32x32x16_bf16 v[96:111], v[48:51], a[104:107], v[96:111]
    v_mul_f32 v87, v87, v95
    v_fma_f32 v32, v32, v20, v20
    v_fma_f32 v33, v33, v20, v20
    v_fma_f32 v34, v34, v20, v20
    ds_read_b128 v[44:47], v17 offset:61440
    v_mfma_f32_32x32x16_bf16 v[112:127], v[52:55], a[104:107], v[112:127]
    v_fma_f32 v35, v35, v20, v20
    v_fma_f32 v36, v36, v20, v20
    v_fma_f32 v37, v37, v20, v20
    v_fma_f32 v38, v38, v20, v20
    ds_read_b128 v[48:51], v17 offset:29696
    s_waitcnt lgkmcnt(3)
    v_mfma_f32_32x32x16_bf16 v[96:111], v[56:59], a[108:111], v[96:111]
    v_fma_f32 v39, v39, v20, v20
    v_rcp_f32 v32, v32
    v_rcp_f32 v33, v33
    ds_read_b128 v[52:55], v17 offset:62464
    v_mfma_f32_32x32x16_bf16 v[112:127], v[60:63], a[108:111], v[112:127]
    v_rcp_f32 v34, v34
    v_mul_f32 v80, v80, v32
    v_rcp_f32 v35, v35
    ds_read_b128 v[56:59], v17 offset:30720
    s_waitcnt lgkmcnt(3)
    v_mfma_f32_32x32x16_bf16 v[96:111], v[40:43], a[112:115], v[96:111]
    v_mul_f32 v81, v81, v33
    v_rcp_f32 v36, v36
    v_mul_f32 v82, v82, v34
    ds_read_b128 v[60:63], v17 offset:63488
    v_mfma_f32_32x32x16_bf16 v[112:127], v[44:47], a[112:115], v[112:127]
    v_rcp_f32 v37, v37
    v_mul_f32 v83, v83, v35
    v_rcp_f32 v38, v38
    ds_read_b128 v[40:43], v17 offset:31744
    s_waitcnt lgkmcnt(3)
    v_mfma_f32_32x32x16_bf16 v[96:111], v[48:51], a[116:119], v[96:111]
    v_mul_f32 v84, v84, v36
    v_rcp_f32 v39, v39
    v_mul_f32 v85, v85, v37
    ds_read_b128 v[44:47], v17 offset:64512
    v_mfma_f32_32x32x16_bf16 v[112:127], v[52:55], a[116:119], v[112:127]
    v_mul_f32 v86, v86, v38
    v_mul_f32 v87, v87, v39
    v_cvt_pk_bf16_f32 v88, v80, v81
    v_cvt_pk_bf16_f32 v89, v82, v83
    s_barrier
    ds_read_b128 v[48:51], v2 offset:0
    s_waitcnt lgkmcnt(3)
    v_mfma_f32_32x32x16_bf16 v[96:111], v[56:59], a[120:123], v[96:111]
    v_cvt_pk_bf16_f32 v90, v84, v85
    v_cvt_pk_bf16_f32 v91, v86, v87
    buffer_store_dwordx4 v[88:91], v2, s[12:15], s45 offen offset:1024 sc1
    s_nop 1
    ds_read_b128 v[80:83], v22 offset:640
    ds_read_b128 v[84:87], v22 offset:672
    ds_read_b128 v[88:91], v22 offset:704
    ds_read_b128 v[92:95], v22 offset:736
    v_mul_f32 v64, v21, v64
    ds_read_b128 v[52:55], v2 offset:32768
    v_mfma_f32_32x32x16_bf16 v[112:127], v[60:63], a[120:123], v[112:127]
    v_mul_f32 v65, v21, v65
    v_mul_f32 v66, v21, v66
    v_mul_f32 v67, v21, v67
    v_mul_f32 v68, v21, v68
    ds_read_b128 v[56:59], v2 offset:1024
    s_waitcnt lgkmcnt(7)
    v_mfma_f32_32x32x16_bf16 v[96:111], v[40:43], a[124:127], v[96:111]
    v_mul_f32 v69, v21, v69
    v_mul_f32 v70, v21, v70
    v_mul_f32 v71, v21, v71
    v_mul_f32 v72, v21, v72
    ds_read_b128 v[60:63], v2 offset:33792
    v_mfma_f32_32x32x16_bf16 v[112:127], v[44:47], a[124:127], v[112:127]
    v_mul_f32 v73, v21, v73
    v_mul_f32 v74, v21, v74
    v_mul_f32 v75, v21, v75
    v_mul_f32 v76, v21, v76
    v_mul_f32 v77, v21, v77
    v_mul_f32 v78, v21, v78
    v_mul_f32 v79, v21, v79
    s_waitcnt lgkmcnt(3)
    v_mul_f32 v80, v21, v80
    v_mul_f32 v81, v21, v81
    v_mul_f32 v82, v21, v82
    v_mul_f32 v83, v21, v83
    v_mul_f32 v84, v21, v84
    v_mul_f32 v85, v21, v85
    v_mul_f32 v86, v21, v86
    v_mul_f32 v87, v21, v87
    v_mul_f32 v88, v21, v88
    v_mul_f32 v89, v21, v89
    v_mul_f32 v90, v21, v90
    v_mul_f32 v91, v21, v91
    v_mul_f32 v92, v21, v92
    v_mul_f32 v93, v21, v93
    v_mul_f32 v94, v21, v94
    v_mul_f32 v95, v21, v95
    s_nop 1
    s_barrier
    ds_read_b128 v[40:43], v2 offset:2048
    s_waitcnt lgkmcnt(3)
    v_mfma_f32_32x32x16_bf16 v[64:79], v[48:51], a[0:3], v[64:79]
    ds_read_b128 v[44:47], v2 offset:34816
    v_mfma_f32_32x32x16_bf16 v[80:95], v[52:55], a[0:3], v[80:95]
    ds_read_b128 v[48:51], v2 offset:3072
    s_waitcnt lgkmcnt(3)
    v_mfma_f32_32x32x16_bf16 v[64:79], v[56:59], a[4:7], v[64:79]
    ds_read_b128 v[52:55], v2 offset:35840
    v_mfma_f32_32x32x16_bf16 v[80:95], v[60:63], a[4:7], v[80:95]
    ds_read_b128 v[56:59], v2 offset:4096
    s_waitcnt lgkmcnt(3)
    v_mfma_f32_32x32x16_bf16 v[64:79], v[40:43], a[8:11], v[64:79]
    ds_read_b128 v[60:63], v2 offset:36864
    v_mfma_f32_32x32x16_bf16 v[80:95], v[44:47], a[8:11], v[80:95]
    ds_read_b128 v[40:43], v2 offset:5120
    s_waitcnt lgkmcnt(3)
    v_mfma_f32_32x32x16_bf16 v[64:79], v[48:51], a[12:15], v[64:79]
    v_mul_f32 v32, v96, v96
    v_mul_f32 v33, v97, v97
    v_mul_f32 v34, v98, v98
    v_mul_f32 v35, v99, v99
    ds_read_b128 v[44:47], v2 offset:37888
    v_mfma_f32_32x32x16_bf16 v[80:95], v[52:55], a[12:15], v[80:95]
    v_mul_f32 v36, v100, v100
    v_mul_f32 v37, v101, v101
    v_mul_f32 v38, v102, v102
    v_mul_f32 v39, v103, v103
    ds_read_b128 v[48:51], v2 offset:6144
    s_waitcnt lgkmcnt(3)
    v_mfma_f32_32x32x16_bf16 v[64:79], v[56:59], a[16:19], v[64:79]
    v_fma_f32 v32, v32, v19, v18
    v_fma_f32 v33, v33, v19, v18
    v_fma_f32 v34, v34, v19, v18
    v_fma_f32 v35, v35, v19, v18
    ds_read_b128 v[52:55], v2 offset:38912
    v_mfma_f32_32x32x16_bf16 v[80:95], v[60:63], a[16:19], v[80:95]
    v_fma_f32 v36, v36, v19, v18
    v_fma_f32 v37, v37, v19, v18
    v_fma_f32 v38, v38, v19, v18
    v_fma_f32 v39, v39, v19, v18
    ds_read_b128 v[56:59], v2 offset:7168
    s_waitcnt lgkmcnt(3)
    v_mfma_f32_32x32x16_bf16 v[64:79], v[40:43], a[20:23], v[64:79]
    v_mul_f32 v32, v32, v96
    v_mul_f32 v33, v33, v97
    v_mul_f32 v34, v34, v98
    v_mul_f32 v35, v35, v99
    ds_read_b128 v[60:63], v2 offset:39936
    v_mfma_f32_32x32x16_bf16 v[80:95], v[44:47], a[20:23], v[80:95]
    v_mul_f32 v36, v36, v100
    v_mul_f32 v37, v37, v101
    v_mul_f32 v38, v38, v102
    v_mul_f32 v39, v39, v103
    ds_read_b128 v[40:43], v2 offset:8192
    s_waitcnt lgkmcnt(3)
    v_mfma_f32_32x32x16_bf16 v[64:79], v[48:51], a[24:27], v[64:79]
    v_exp_f32 v32, v32
    v_mul_f32 v96, v96, v104
    v_exp_f32 v33, v33
    ds_read_b128 v[44:47], v2 offset:40960
    v_mfma_f32_32x32x16_bf16 v[80:95], v[52:55], a[24:27], v[80:95]
    v_mul_f32 v97, v97, v105
    v_exp_f32 v34, v34
    v_mul_f32 v98, v98, v106
    ds_read_b128 v[48:51], v2 offset:9216
    s_waitcnt lgkmcnt(3)
    v_mfma_f32_32x32x16_bf16 v[64:79], v[56:59], a[28:31], v[64:79]
    v_exp_f32 v35, v35
    v_mul_f32 v99, v99, v107
    v_exp_f32 v36, v36
    ds_read_b128 v[52:55], v2 offset:41984
    v_mfma_f32_32x32x16_bf16 v[80:95], v[60:63], a[28:31], v[80:95]
    v_mul_f32 v100, v100, v108
    v_exp_f32 v37, v37
    v_mul_f32 v101, v101, v109
    ds_read_b128 v[56:59], v2 offset:10240
    s_waitcnt lgkmcnt(3)
    v_mfma_f32_32x32x16_bf16 v[64:79], v[40:43], a[32:35], v[64:79]
    v_exp_f32 v38, v38
    v_mul_f32 v102, v102, v110
    v_exp_f32 v39, v39
    ds_read_b128 v[60:63], v2 offset:43008
    v_mfma_f32_32x32x16_bf16 v[80:95], v[44:47], a[32:35], v[80:95]
    v_mul_f32 v103, v103, v111
    v_fma_f32 v32, v32, v20, v20
    v_fma_f32 v33, v33, v20, v20
    v_fma_f32 v34, v34, v20, v20
    ds_read_b128 v[40:43], v2 offset:11264
    s_waitcnt lgkmcnt(3)
    v_mfma_f32_32x32x16_bf16 v[64:79], v[48:51], a[36:39], v[64:79]
    v_fma_f32 v35, v35, v20, v20
    v_fma_f32 v36, v36, v20, v20
    v_fma_f32 v37, v37, v20, v20
    v_fma_f32 v38, v38, v20, v20
    s_waitcnt vmcnt(0)
    s_add_u32 s31, s39, 131072
    s_mov_b64 exec, 1
    buffer_store_dword v10, v9, s[12:15], s31 offen sc1
    s_mov_b64 exec, -1
    ds_read_b128 v[44:47], v2 offset:44032
    v_mfma_f32_32x32x16_bf16 v[80:95], v[52:55], a[36:39], v[80:95]
    v_fma_f32 v39, v39, v20, v20
    v_rcp_f32 v32, v32
    v_rcp_f32 v33, v33
    ds_read_b128 v[48:51], v2 offset:12288
    s_waitcnt lgkmcnt(3)
    v_mfma_f32_32x32x16_bf16 v[64:79], v[56:59], a[40:43], v[64:79]
    v_rcp_f32 v34, v34
    v_mul_f32 v96, v96, v32
    v_rcp_f32 v35, v35
    ds_read_b128 v[52:55], v2 offset:45056
    v_mfma_f32_32x32x16_bf16 v[80:95], v[60:63], a[40:43], v[80:95]
    v_mul_f32 v97, v97, v33
    v_rcp_f32 v36, v36
    v_mul_f32 v98, v98, v34
    ds_read_b128 v[56:59], v2 offset:13312
    s_waitcnt lgkmcnt(3)
    v_mfma_f32_32x32x16_bf16 v[64:79], v[40:43], a[44:47], v[64:79]
    v_rcp_f32 v37, v37
    v_mul_f32 v99, v99, v35
    v_rcp_f32 v38, v38
    ds_read_b128 v[60:63], v2 offset:46080
    v_mfma_f32_32x32x16_bf16 v[80:95], v[44:47], a[44:47], v[80:95]
    v_mul_f32 v100, v100, v36
    v_rcp_f32 v39, v39
    v_mul_f32 v101, v101, v37
    ds_read_b128 v[40:43], v2 offset:14336
    s_waitcnt lgkmcnt(3)
    v_mfma_f32_32x32x16_bf16 v[64:79], v[48:51], a[48:51], v[64:79]
    v_mul_f32 v102, v102, v38
    v_mul_f32 v103, v103, v39
    v_cvt_pk_bf16_f32 v104, v96, v97
    v_cvt_pk_bf16_f32 v105, v98, v99
    ds_read_b128 v[44:47], v2 offset:47104
    v_mfma_f32_32x32x16_bf16 v[80:95], v[52:55], a[48:51], v[80:95]
    v_cvt_pk_bf16_f32 v106, v100, v101
    v_cvt_pk_bf16_f32 v107, v102, v103
    buffer_store_dwordx4 v[104:107], v2, s[12:15], s45 offen offset:2048 sc1
    s_nop 1
    ds_read_b128 v[96:99], v22 offset:768
    ds_read_b128 v[100:103], v22 offset:800
    ds_read_b128 v[104:107], v22 offset:832
    ds_read_b128 v[108:111], v22 offset:864
    v_mul_f32 v32, v112, v112
    ds_read_b128 v[48:51], v2 offset:15360
    s_waitcnt lgkmcnt(7)
    v_mfma_f32_32x32x16_bf16 v[64:79], v[56:59], a[52:55], v[64:79]
    v_mul_f32 v33, v113, v113
    v_mul_f32 v34, v114, v114
    v_mul_f32 v35, v115, v115
    v_mul_f32 v36, v116, v116
    ds_read_b128 v[52:55], v2 offset:48128
    v_mfma_f32_32x32x16_bf16 v[80:95], v[60:63], a[52:55], v[80:95]
    v_mul_f32 v37, v117, v117
    v_mul_f32 v38, v118, v118
    v_mul_f32 v39, v119, v119
    v_fma_f32 v32, v32, v19, v18
    ds_read_b128 v[56:59], v2 offset:16384
    s_waitcnt lgkmcnt(7)
    v_mfma_f32_32x32x16_bf16 v[64:79], v[40:43], a[56:59], v[64:79]
    v_fma_f32 v33, v33, v19, v18
    v_fma_f32 v34, v34, v19, v18
    v_fma_f32 v35, v35, v19, v18
    v_fma_f32 v36, v36, v19, v18
    ds_read_b128 v[60:63], v2 offset:49152
    v_mfma_f32_32x32x16_bf16 v[80:95], v[44:47], a[56:59], v[80:95]
    v_fma_f32 v37, v37, v19, v18
    v_fma_f32 v38, v38, v19, v18
    v_fma_f32 v39, v39, v19, v18
    v_mul_f32 v32, v32, v112
    ds_read_b128 v[40:43], v2 offset:17408
    s_waitcnt lgkmcnt(3)
    v_mfma_f32_32x32x16_bf16 v[64:79], v[48:51], a[60:63], v[64:79]
    v_mul_f32 v33, v33, v113
    v_mul_f32 v34, v34, v114
    v_mul_f32 v35, v35, v115
    v_mul_f32 v36, v36, v116
    ds_read_b128 v[44:47], v2 offset:50176
    v_mfma_f32_32x32x16_bf16 v[80:95], v[52:55], a[60:63], v[80:95]
    v_mul_f32 v37, v37, v117
    v_mul_f32 v38, v38, v118
    v_mul_f32 v39, v39, v119
    v_exp_f32 v32, v32
    ds_read_b128 v[48:51], v2 offset:18432
    s_waitcnt lgkmcnt(3)
    v_mfma_f32_32x32x16_bf16 v[64:79], v[56:59], a[64:67], v[64:79]
    v_mul_f32 v112, v112, v120
    v_exp_f32 v33, v33
    v_mul_f32 v113, v113, v121
    ds_read_b128 v[52:55], v2 offset:51200
    v_mfma_f32_32x32x16_bf16 v[80:95], v[60:63], a[64:67], v[80:95]
    v_exp_f32 v34, v34
    v_mul_f32 v114, v114, v122
    v_exp_f32 v35, v35
    ds_read_b128 v[56:59], v2 offset:19456
    s_waitcnt lgkmcnt(3)
    v_mfma_f32_32x32x16_bf16 v[64:79], v[40:43], a[68:71], v[64:79]
    v_mul_f32 v115, v115, v123
    v_exp_f32 v36, v36
    v_mul_f32 v116, v116, v124
    ds_read_b128 v[60:63], v2 offset:52224
    v_mfma_f32_32x32x16_bf16 v[80:95], v[44:47], a[68:71], v[80:95]
    v_exp_f32 v37, v37
    v_mul_f32 v117, v117, v125
    v_exp_f32 v38, v38
    ds_read_b128 v[40:43], v2 offset:20480
    s_waitcnt lgkmcnt(3)
    v_mfma_f32_32x32x16_bf16 v[64:79], v[48:51], a[72:75], v[64:79]
    v_mul_f32 v118, v118, v126
    v_exp_f32 v39, v39
    v_mul_f32 v119, v119, v127
    ds_read_b128 v[44:47], v2 offset:53248
    v_mfma_f32_32x32x16_bf16 v[80:95], v[52:55], a[72:75], v[80:95]
    v_fma_f32 v32, v32, v20, v20
    v_fma_f32 v33, v33, v20, v20
    v_fma_f32 v34, v34, v20, v20
    v_fma_f32 v35, v35, v20, v20
    ds_read_b128 v[48:51], v2 offset:21504
    s_waitcnt lgkmcnt(3)
    v_mfma_f32_32x32x16_bf16 v[64:79], v[56:59], a[76:79], v[64:79]
    v_fma_f32 v36, v36, v20, v20
    v_fma_f32 v37, v37, v20, v20
    v_fma_f32 v38, v38, v20, v20
    v_fma_f32 v39, v39, v20, v20
    ds_read_b128 v[52:55], v2 offset:54272
    v_mfma_f32_32x32x16_bf16 v[80:95], v[60:63], a[76:79], v[80:95]
    v_rcp_f32 v32, v32
    v_rcp_f32 v33, v33
    ds_read_b128 v[56:59], v2 offset:22528
    s_waitcnt lgkmcnt(3)
    v_mfma_f32_32x32x16_bf16 v[64:79], v[40:43], a[80:83], v[64:79]
    v_rcp_f32 v34, v34
    v_mul_f32 v112, v112, v32
    v_rcp_f32 v35, v35
    ds_read_b128 v[60:63], v2 offset:55296
    v_mfma_f32_32x32x16_bf16 v[80:95], v[44:47], a[80:83], v[80:95]
    v_mul_f32 v113, v113, v33
    v_rcp_f32 v36, v36
    v_mul_f32 v114, v114, v34
    ds_read_b128 v[40:43], v2 offset:23552
    s_waitcnt lgkmcnt(3)
    v_mfma_f32_32x32x16_bf16 v[64:79], v[48:51], a[84:87], v[64:79]
    v_rcp_f32 v37, v37
    v_mul_f32 v115, v115, v35
    v_rcp_f32 v38, v38
    ds_read_b128 v[44:47], v2 offset:56320
    v_mfma_f32_32x32x16_bf16 v[80:95], v[52:55], a[84:87], v[80:95]
    v_mul_f32 v116, v116, v36
    v_rcp_f32 v39, v39
    v_mul_f32 v117, v117, v37
    s_add_u32 s31, s38, 131072
    buffer_load_dword v6, v7, s[12:15], s31 offen sc1
    ds_read_b128 v[48:51], v2 offset:24576
    s_waitcnt lgkmcnt(3)
    v_mfma_f32_32x32x16_bf16 v[64:79], v[56:59], a[88:91], v[64:79]
    v_mul_f32 v118, v118, v38
    v_mul_f32 v119, v119, v39
    v_cvt_pk_bf16_f32 v120, v112, v113
    v_cvt_pk_bf16_f32 v121, v114, v115
    ds_read_b128 v[52:55], v2 offset:57344
    v_mfma_f32_32x32x16_bf16 v[80:95], v[60:63], a[88:91], v[80:95]
    v_cvt_pk_bf16_f32 v122, v116, v117
    v_cvt_pk_bf16_f32 v123, v118, v119
    buffer_store_dwordx4 v[120:123], v2, s[12:15], s45 offen offset:3072 sc1
    v_mul_f32 v96, v21, v96
    ds_read_b128 v[56:59], v2 offset:25600
    s_waitcnt lgkmcnt(3)
    v_mfma_f32_32x32x16_bf16 v[64:79], v[40:43], a[92:95], v[64:79]
    v_mul_f32 v97, v21, v97
    v_mul_f32 v98, v21, v98
    v_mul_f32 v99, v21, v99
    v_mul_f32 v100, v21, v100
    ds_read_b128 v[60:63], v2 offset:58368
    v_mfma_f32_32x32x16_bf16 v[80:95], v[44:47], a[92:95], v[80:95]
    v_mul_f32 v101, v21, v101
    v_mul_f32 v102, v21, v102
    v_mul_f32 v103, v21, v103
    v_mul_f32 v104, v21, v104
    ds_read_b128 v[40:43], v2 offset:26624
    s_waitcnt lgkmcnt(3)
    v_mfma_f32_32x32x16_bf16 v[64:79], v[48:51], a[96:99], v[64:79]
    v_mul_f32 v105, v21, v105
    v_mul_f32 v106, v21, v106
    v_mul_f32 v107, v21, v107
    v_mul_f32 v108, v21, v108
    ds_read_b128 v[44:47], v2 offset:59392
    v_mfma_f32_32x32x16_bf16 v[80:95], v[52:55], a[96:99], v[80:95]
    v_mul_f32 v109, v21, v109
    v_mul_f32 v110, v21, v110
    v_mul_f32 v111, v21, v111
    ds_read_b128 v[48:51], v2 offset:27648
    s_waitcnt lgkmcnt(3)
    v_mfma_f32_32x32x16_bf16 v[64:79], v[56:59], a[100:103], v[64:79]
    ds_read_b128 v[52:55], v2 offset:60416
    v_mfma_f32_32x32x16_bf16 v[80:95], v[60:63], a[100:103], v[80:95]
    ds_read_b128 v[56:59], v2 offset:28672
    s_waitcnt lgkmcnt(3)
    v_mfma_f32_32x32x16_bf16 v[64:79], v[40:43], a[104:107], v[64:79]
    ds_read_b128 v[60:63], v2 offset:61440
    v_mfma_f32_32x32x16_bf16 v[80:95], v[44:47], a[104:107], v[80:95]
    ds_read_b128 v[40:43], v2 offset:29696
    s_waitcnt lgkmcnt(3)
    v_mfma_f32_32x32x16_bf16 v[64:79], v[48:51], a[108:111], v[64:79]
    ds_read_b128 v[44:47], v2 offset:62464
    v_mfma_f32_32x32x16_bf16 v[80:95], v[52:55], a[108:111], v[80:95]
    ds_read_b128 v[48:51], v2 offset:30720
    s_waitcnt lgkmcnt(3)
    v_mfma_f32_32x32x16_bf16 v[64:79], v[56:59], a[112:115], v[64:79]
    ds_read_b128 v[52:55], v2 offset:63488
    v_mfma_f32_32x32x16_bf16 v[80:95], v[60:63], a[112:115], v[80:95]
    ds_read_b128 v[56:59], v2 offset:31744
    s_waitcnt lgkmcnt(3)
    v_mfma_f32_32x32x16_bf16 v[64:79], v[40:43], a[116:119], v[64:79]
    ds_read_b128 v[60:63], v2 offset:64512
    v_mfma_f32_32x32x16_bf16 v[80:95], v[44:47], a[116:119], v[80:95]
    s_barrier
    ds_read_b128 v[40:43], v17 offset:0
    s_waitcnt lgkmcnt(3)
    v_mfma_f32_32x32x16_bf16 v[64:79], v[48:51], a[120:123], v[64:79]
    ds_read_b128 v[44:47], v17 offset:1024
    v_mfma_f32_32x32x16_bf16 v[80:95], v[52:55], a[120:123], v[80:95]
    ds_read_b128 v[48:51], v17 offset:2048
    s_waitcnt lgkmcnt(3)
    v_mfma_f32_32x32x16_bf16 v[64:79], v[56:59], a[124:127], v[64:79]
    ds_read_b128 v[52:55], v17 offset:3072
    v_mfma_f32_32x32x16_bf16 v[80:95], v[60:63], a[124:127], v[80:95]
    s_nop 1
    s_barrier
    ds_read_b128 v[56:59], v17 offset:4096
    s_waitcnt lgkmcnt(3)
    v_mfma_f32_32x32x16_bf16 v[96:111], v[40:43], a[0:3], v[96:111]
    ds_read_b128 v[60:63], v17 offset:5120
    v_mfma_f32_32x32x16_bf16 v[96:111], v[44:47], a[4:7], v[96:111]
    ds_read_b128 v[40:43], v17 offset:6144
    s_waitcnt lgkmcnt(3)
    v_mfma_f32_32x32x16_bf16 v[96:111], v[48:51], a[8:11], v[96:111]
    ds_read_b128 v[44:47], v17 offset:7168
    v_mfma_f32_32x32x16_bf16 v[96:111], v[52:55], a[12:15], v[96:111]
    s_waitcnt vmcnt(1)
    v_cmp_ne_u32 vcc, 1, v6
    s_nop 0
    s_cbranch_vccz L_pok_54
    s_mov_b32 s47, 0x20000
    s_add_u32 s31, s38, 131072
L_spin_55:
    buffer_load_dword v6, v7, s[12:15], s31 offen sc1
    s_sub_u32 s47, s47, 1
    s_waitcnt vmcnt(0)
    v_cmp_ne_u32 vcc, 1, v6
    s_cbranch_scc1 L_spok_56
    s_cbranch_vccnz L_spin_55
L_spok_56:
L_pok_54:
    ds_read_b128 v[48:51], v17 offset:8192
    s_waitcnt lgkmcnt(3)
    v_mfma_f32_32x32x16_bf16 v[96:111], v[56:59], a[16:19], v[96:111]
    s_add_u32 s32, s54, 0
    buffer_load_dwordx4 a[0:3], v2, s[12:15], s32 offen sc1
    ds_read_b128 v[52:55], v17 offset:9216
    v_mfma_f32_32x32x16_bf16 v[96:111], v[60:63], a[20:23], v[96:111]
    s_add_u32 s32, s54, 1024
    buffer_load_dwordx4 a[4:7], v2, s[12:15], s32 offen sc1
    ds_read_b128 v[56:59], v17 offset:10240
    s_waitcnt lgkmcnt(3)
    v_mfma_f32_32x32x16_bf16 v[96:111], v[40:43], a[24:27], v[96:111]
    s_add_u32 s32, s54, 28672
    buffer_load_dwordx4 a[8:11], v2, s[12:15], s32 offen sc1
    v_mul_f32 v32, v64, v64
    v_mul_f32 v33, v65, v65
    v_mul_f32 v34, v66, v66
    v_mul_f32 v35, v67, v67
    v_mul_f32 v36, v68, v68
    v_mul_f32 v37, v69, v69
    ds_read_b128 v[60:63], v17 offset:11264
    v_mfma_f32_32x32x16_bf16 v[96:111], v[44:47], a[28:31], v[96:111]
    s_add_u32 s32, s54, 29696
    buffer_load_dwordx4 a[12:15], v2, s[12:15], s32 offen sc1
    v_mul_f32 v38, v70, v70
    v_mul_f32 v39, v71, v71
    v_fma_f32 v32, v32, v19, v18
    v_fma_f32 v33, v33, v19, v18
    v_fma_f32 v34, v34, v19, v18
    v_fma_f32 v35, v35, v19, v18
    ds_read_b128 v[40:43], v17 offset:12288
    s_waitcnt lgkmcnt(3)
    v_mfma_f32_32x32x16_bf16 v[96:111], v[48:51], a[32:35], v[96:111]
    s_add_u32 s32, s54, 7168
    buffer_load_dwordx4 a[16:19], v2, s[12:15], s32 offen sc1
    v_fma_f32 v36, v36, v19, v18
    v_fma_f32 v37, v37, v19, v18
    v_fma_f32 v38, v38, v19, v18
    v_fma_f32 v39, v39, v19, v18
    v_mul_f32 v32, v32, v64
    v_mul_f32 v33, v33, v65
    ds_read_b128 v[44:47], v17 offset:13312
    v_mfma_f32_32x32x16_bf16 v[96:111], v[52:55], a[36:39], v[96:111]
    s_add_u32 s32, s54, 8192
    buffer_load_dwordx4 a[20:23], v2, s[12:15], s32 offen sc1
    v_mul_f32 v34, v34, v66
    v_mul_f32 v35, v35, v67
    v_mul_f32 v36, v36, v68
    v_mul_f32 v37, v37, v69
    v_mul_f32 v38, v38, v70
    v_mul_f32 v39, v39, v71
    ds_read_b128 v[48:51], v17 offset:14336
    s_waitcnt lgkmcnt(3)
    v_mfma_f32_32x32x16_bf16 v[96:111], v[56:59], a[40:43], v[96:111]
    s_add_u32 s32, s54, 35840
    buffer_load_dwordx4 a[24:27], v2, s[12:15], s32 offen sc1
    v_exp_f32 v32, v32
    v_mul_f32 v64, v64, v72
    v_exp_f32 v33, v33
    v_mul_f32 v65, v65, v73
    ds_read_b128 v[52:55], v17 offset:15360
    v_mfma_f32_32x32x16_bf16 v[96:111], v[60:63], a[44:47], v[96:111]
    s_add_u32 s32, s54, 36864
    buffer_load_dwordx4 a[28:31], v2, s[12:15], s32 offen sc1
    v_exp_f32 v34, v34
    v_mul_f32 v66, v66, v74
    v_exp_f32 v35, v35
    v_mul_f32 v67, v67, v75
    ds_read_b128 v[56:59], v17 offset:16384
    s_waitcnt lgkmcnt(3)
    v_mfma_f32_32x32x16_bf16 v[96:111], v[40:43], a[48:51], v[96:111]
    s_add_u32 s32, s54, 14336
    buffer_load_dwordx4 a[32:35], v2, s[12:15], s32 offen sc1
    v_exp_f32 v36, v36
    v_mul_f32 v68, v68, v76
    v_exp_f32 v37, v37
    v_mul_f32 v69, v69, v77
    ds_read_b128 v[60:63], v17 offset:17408
    v_mfma_f32_32x32x16_bf16 v[96:111], v[44:47], a[52:55], v[96:111]
    s_add_u32 s32, s54, 15360
    buffer_load_dwordx4 a[36:39], v2, s[12:15], s32 offen sc1
    v_exp_f32 v38, v38
    v_mul_f32 v70, v70, v78
    v_exp_f32 v39, v39
    v_mul_f32 v71, v71, v79
    ds_read_b128 v[40:43], v17 offset:18432
    s_waitcnt lgkmcnt(3)
    v_mfma_f32_32x32x16_bf16 v[96:111], v[48:51], a[56:59], v[96:111]
    s_add_u32 s32, s54, 43008
    buffer_load_dwordx4 a[40:43], v2, s[12:15], s32 offen sc1
    v_fma_f32 v32, v32, v20, v20
    v_fma_f32 v33, v33, v20, v20
    v_fma_f32 v34, v34, v20, v20
    v_fma_f32 v35, v35, v20, v20
    v_fma_f32 v36, v36, v20, v20
    v_fma_f32 v37, v37, v20, v20
    ds_read_b128 v[44:47], v17 offset:19456
    v_mfma_f32_32x32x16_bf16 v[96:111], v[52:55], a[60:63], v[96:111]
    s_add_u32 s32, s54, 44032
    buffer_load_dwordx4 a[44:47], v2, s[12:15], s32 offen sc1
    v_fma_f32 v38, v38, v20, v20
    v_fma_f32 v39, v39, v20, v20
    v_rcp_f32 v32, v32
    v_rcp_f32 v33, v33
    ds_read_b128 v[48:51], v17 offset:20480
    s_waitcnt lgkmcnt(3)
    v_mfma_f32_32x32x16_bf16 v[96:111], v[56:59], a[64:67], v[96:111]
    s_add_u32 s32, s54, 21504
    buffer_load_dwordx4 a[48:51], v2, s[12:15], s32 offen sc1
    v_rcp_f32 v34, v34
    v_mul_f32 v64, v64, v32
    v_rcp_f32 v35, v35
    v_mul_f32 v65, v65, v33
    s_waitcnt vmcnt(13)
    s_add_u32 s31, s39, 262144
    s_mov_b64 exec, 1
    buffer_store_dword v10, v9, s[12:15], s31 offen sc1
    s_mov_b64 exec, -1
    ds_read_b128 v[52:55], v17 offset:21504
    v_mfma_f32_32x32x16_bf16 v[96:111], v[60:63], a[68:71], v[96:111]
    s_add_u32 s32, s54, 22528
    buffer_load_dwordx4 a[52:55], v2, s[12:15], s32 offen sc1
    v_rcp_f32 v36, v36
    v_mul_f32 v66, v66, v34
    v_rcp_f32 v37, v37
    v_mul_f32 v67, v67, v35
    ds_read_b128 v[56:59], v17 offset:22528
    s_waitcnt lgkmcnt(3)
    v_mfma_f32_32x32x16_bf16 v[96:111], v[40:43], a[72:75], v[96:111]
    s_add_u32 s32, s54, 50176
    buffer_load_dwordx4 a[56:59], v2, s[12:15], s32 offen sc1
    v_rcp_f32 v38, v38
    v_mul_f32 v68, v68, v36
    v_rcp_f32 v39, v39
    v_mul_f32 v69, v69, v37
    ds_read_b128 v[60:63], v17 offset:23552
    v_mfma_f32_32x32x16_bf16 v[96:111], v[44:47], a[76:79], v[96:111]
    s_add_u32 s32, s54, 51200
    buffer_load_dwordx4 a[60:63], v2, s[12:15], s32 offen sc1
    v_mul_f32 v70, v70, v38
    v_mul_f32 v71, v71, v39
    v_cvt_pk_bf16_f32 v72, v64, v65
    v_cvt_pk_bf16_f32 v73, v66, v67
    v_cvt_pk_bf16_f32 v74, v68, v69
    v_cvt_pk_bf16_f32 v75, v70, v71
    ds_read_b128 v[40:43], v17 offset:24576
    s_waitcnt lgkmcnt(3)
    v_mfma_f32_32x32x16_bf16 v[96:111], v[48:51], a[80:83], v[96:111]
    s_add_u32 s45, s45, 4096
    buffer_store_dwordx4 v[72:75], v2, s[12:15], s45 offen offset:0 sc1
    v_mul_f32 v32, v80, v80
    v_mul_f32 v33, v81, v81
    v_mul_f32 v34, v82, v82
    v_mul_f32 v35, v83, v83
    v_mul_f32 v36, v84, v84
    ds_read_b128 v[44:47], v17 offset:25600
    v_mfma_f32_32x32x16_bf16 v[96:111], v[52:55], a[84:87], v[96:111]
    v_mul_f32 v37, v85, v85
    v_mul_f32 v38, v86, v86
    v_mul_f32 v39, v87, v87
    v_fma_f32 v32, v32, v19, v18
    v_fma_f32 v33, v33, v19, v18
    v_fma_f32 v34, v34, v19, v18
    ds_read_b128 v[48:51], v17 offset:26624
    s_waitcnt lgkmcnt(3)
    v_mfma_f32_32x32x16_bf16 v[96:111], v[56:59], a[88:91], v[96:111]
    v_fma_f32 v35, v35, v19, v18
    v_fma_f32 v36, v36, v19, v18
    v_fma_f32 v37, v37, v19, v18
    v_fma_f32 v38, v38, v19, v18
    v_fma_f32 v39, v39, v19, v18
    v_mul_f32 v32, v32, v80
    ds_read_b128 v[52:55], v17 offset:27648
    v_mfma_f32_32x32x16_bf16 v[96:111], v[60:63], a[92:95], v[96:111]
    v_mul_f32 v33, v33, v81
    v_mul_f32 v34, v34, v82
    v_mul_f32 v35, v35, v83
    v_mul_f32 v36, v36, v84
    v_mul_f32 v37, v37, v85
    v_mul_f32 v38, v38, v86
    ds_read_b128 v[56:59], v17 offset:28672
    s_waitcnt lgkmcnt(3)
    v_mfma_f32_32x32x16_bf16 v[96:111], v[40:43], a[96:99], v[96:111]
    v_mul_f32 v39, v39, v87
    v_exp_f32 v32, v32
    v_mul_f32 v80, v80, v88
    v_exp_f32 v33, v33
    ds_read_b128 v[60:63], v17 offset:29696
    v_mfma_f32_32x32x16_bf16 v[96:111], v[44:47], a[100:103], v[96:111]
    v_mul_f32 v81, v81, v89
    v_exp_f32 v34, v34
    v_mul_f32 v82, v82, v90
    v_exp_f32 v35, v35
    ds_read_b128 v[40:43], v17 offset:30720
    s_waitcnt lgkmcnt(3)
    v_mfma_f32_32x32x16_bf16 v[96:111], v[48:51], a[104:107], v[96:111]
    v_mul_f32 v83, v83, v91
    v_exp_f32 v36, v36
    v_mul_f32 v84, v84, v92
    v_exp_f32 v37, v37
    ds_read_b128 v[44:47], v17 offset:31744
    v_mfma_f32_32x32x16_bf16 v[96:111], v[52:55], a[108:111], v[96:111]
    v_mul_f32 v85, v85, v93
    v_exp_f32 v38, v38
    v_mul_f32 v86, v86, v94
    v_exp_f32 v39, v39
    s_waitcnt lgkmcnt(2)
    v_mfma_f32_32x32x16_bf16 v[96:111], v[56:59], a[112:115], v[96:111]
    v_mul_f32 v87, v87, v95
    v_fma_f32 v32, v32, v20, v20
    v_fma_f32 v33, v33, v20, v20
    v_fma_f32 v34, v34, v20, v20
    v_fma_f32 v35, v35, v20, v20
    v_fma_f32 v36, v36, v20, v20
    v_mfma_f32_32x32x16_bf16 v[96:111], v[60:63], a[116:119], v[96:111]
    v_fma_f32 v37, v37, v20, v20
    v_fma_f32 v38, v38, v20, v20
    v_fma_f32 v39, v39, v20, v20
    v_rcp_f32 v32, v32
    v_rcp_f32 v33, v33
    s_waitcnt lgkmcnt(0)
    v_mfma_f32_32x32x16_bf16 v[96:111], v[40:43], a[120:123], v[96:111]
    v_rcp_f32 v34, v34
    v_mul_f32 v80, v80, v32
    v_rcp_f32 v35, v35
    v_mul_f32 v81, v81, v33
    v_mfma_f32_32x32x16_bf16 v[96:111], v[44:47], a[124:127], v[96:111]
    v_rcp_f32 v36, v36
    v_mul_f32 v82, v82, v34
    v_rcp_f32 v37, v37
    v_mul_f32 v83, v83, v35
    v_rcp_f32 v38, v38
    v_mul_f32 v84, v84, v36
    v_rcp_f32 v39, v39
    v_mul_f32 v85, v85, v37
    v_mul_f32 v86, v86, v38
    v_mul_f32 v87, v87, v39
    v_cvt_pk_bf16_f32 v88, v80, v81
    v_cvt_pk_bf16_f32 v89, v82, v83
    v_cvt_pk_bf16_f32 v90, v84, v85
    v_cvt_pk_bf16_f32 v91, v86, v87
    buffer_store_dwordx4 v[88:91], v2, s[12:15], s45 offen offset:1024 sc1
    s_nop 11
    s_nop 1
    s_barrier
    ds_read_b64_tr_b16 v[40:41], v15 offset:0
    ds_read_b64_tr_b16 v[42:43], v15 offset:1024
    ds_read_b64_tr_b16 v[44:45], v16 offset:0
    ds_read_b64_tr_b16 v[46:47], v16 offset:1024
    ds_read_b64_tr_b16 v[48:49], v15 offset:2048
    ds_read_b64_tr_b16 v[50:51], v15 offset:3072
    ds_read_b64_tr_b16 v[52:53], v16 offset:2048
    ds_read_b64_tr_b16 v[54:55], v16 offset:3072
    ds_read_b64_tr_b16 v[56:57], v15 offset:4096
    ds_read_b64_tr_b16 v[58:59], v15 offset:5120
    ds_read_b64_tr_b16 v[60:61], v16 offset:4096
    ds_read_b64_tr_b16 v[62:63], v16 offset:5120
    s_waitcnt vmcnt(18) lgkmcnt(8)
    v_mfma_f32_32x32x16_bf16 v[64:79], v[40:43], a[0:3], 0
    s_add_u32 s31, s38, 262144
    buffer_load_dword v6, v7, s[12:15], s31 offen sc1
    v_mul_f32 v32, v96, v96
    v_mul_f32 v33, v97, v97
    v_mul_f32 v34, v98, v98
    v_mul_f32 v35, v99, v99
    v_mul_f32 v36, v100, v100
    v_mul_f32 v37, v101, v101
    v_mul_f32 v38, v102, v102
    v_mul_f32 v39, v103, v103
    v_fma_f32 v32, v32, v19, v18
    v_fma_f32 v33, v33, v19, v18
    v_fma_f32 v34, v34, v19, v18
    v_fma_f32 v35, v35, v19, v18
    v_fma_f32 v36, v36, v19, v18
    v_fma_f32 v37, v37, v19, v18
    v_fma_f32 v38, v38, v19, v18
    v_fma_f32 v39, v39, v19, v18
    v_mul_f32 v32, v32, v96
    v_mul_f32 v33, v33, v97
    v_mul_f32 v34, v34, v98
    v_mul_f32 v35, v35, v99
    v_mul_f32 v36, v36, v100
    v_mul_f32 v37, v37, v101
    v_mul_f32 v38, v38, v102
    v_mul_f32 v39, v39, v103
    v_mfma_f32_32x32x16_bf16 v[80:95], v[44:47], a[0:3], 0
    v_exp_f32 v32, v32
    v_mul_f32 v96, v96, v104
    v_exp_f32 v33, v33
    v_mul_f32 v97, v97, v105
    v_exp_f32 v34, v34
    v_mul_f32 v98, v98, v106
    v_exp_f32 v35, v35
    v_mul_f32 v99, v99, v107
    v_exp_f32 v36, v36
    v_mul_f32 v100, v100, v108
    v_exp_f32 v37, v37
    v_mul_f32 v101, v101, v109
    v_exp_f32 v38, v38
    v_mul_f32 v102, v102, v110
    v_exp_f32 v39, v39
    v_mul_f32 v103, v103, v111
    ds_read_b64_tr_b16 v[40:41], v15 offset:6144
    ds_read_b64_tr_b16 v[42:43], v15 offset:7168
    ds_read_b64_tr_b16 v[44:45], v16 offset:6144
    ds_read_b64_tr_b16 v[46:47], v16 offset:7168
    s_waitcnt vmcnt(18) lgkmcnt(8)
    v_mfma_f32_32x32x16_bf16 v[64:79], v[48:51], a[4:7], v[64:79]
    v_fma_f32 v32, v32, v20, v20
    v_fma_f32 v33, v33, v20, v20
    v_fma_f32 v34, v34, v20, v20
    v_fma_f32 v35, v35, v20, v20
    v_fma_f32 v36, v36, v20, v20
    v_fma_f32 v37, v37, v20, v20
    v_fma_f32 v38, v38, v20, v20
    v_fma_f32 v39, v39, v20, v20
    v_rcp_f32 v32, v32
    v_rcp_f32 v33, v33
    v_rcp_f32 v34, v34
    v_mul_f32 v96, v96, v32
    v_rcp_f32 v35, v35
    v_mul_f32 v97, v97, v33
    v_rcp_f32 v36, v36
    v_mul_f32 v98, v98, v34
    v_rcp_f32 v37, v37
    v_mul_f32 v99, v99, v35
    v_mfma_f32_32x32x16_bf16 v[80:95], v[52:55], a[4:7], v[80:95]
    v_rcp_f32 v38, v38
    v_mul_f32 v100, v100, v36
    v_rcp_f32 v39, v39
    v_mul_f32 v101, v101, v37
    v_mul_f32 v102, v102, v38
    v_mul_f32 v103, v103, v39
    v_cvt_pk_bf16_f32 v104, v96, v97
    v_cvt_pk_bf16_f32 v105, v98, v99
    v_cvt_pk_bf16_f32 v106, v100, v101
    v_cvt_pk_bf16_f32 v107, v102, v103
    buffer_store_dwordx4 v[104:107], v2, s[12:15], s45 offen offset:2048 sc1
    s_barrier
    ds_read_b64_tr_b16 v[48:49], v13 offset:32768
    ds_read_b64_tr_b16 v[50:51], v13 offset:33792
    ds_read_b64_tr_b16 v[52:53], v14 offset:32768
    ds_read_b64_tr_b16 v[54:55], v14 offset:33792
    s_waitcnt vmcnt(18) lgkmcnt(8)
    v_mfma_f32_32x32x16_bf16 v[64:79], v[56:59], a[8:11], v[64:79]
    v_mfma_f32_32x32x16_bf16 v[80:95], v[60:63], a[8:11], v[80:95]
    ds_read_b64_tr_b16 v[56:57], v13 offset:34816
    ds_read_b64_tr_b16 v[58:59], v13 offset:35840
    ds_read_b64_tr_b16 v[60:61], v14 offset:34816
    ds_read_b64_tr_b16 v[62:63], v14 offset:35840
    s_waitcnt vmcnt(17) lgkmcnt(8)
    v_mfma_f32_32x32x16_bf16 v[64:79], v[40:43], a[12:15], v[64:79]
    v_mfma_f32_32x32x16_bf16 v[80:95], v[44:47], a[12:15], v[80:95]
    ds_read_b64_tr_b16 v[40:41], v13 offset:36864
    ds_read_b64_tr_b16 v[42:43], v13 offset:37888
    ds_read_b64_tr_b16 v[44:45], v14 offset:36864
    ds_read_b64_tr_b16 v[46:47], v14 offset:37888
    s_waitcnt vmcnt(16) lgkmcnt(8)
    v_mfma_f32_32x32x16_bf16 v[64:79], v[48:51], a[16:19], v[64:79]
    v_mfma_f32_32x32x16_bf16 v[80:95], v[52:55], a[16:19], v[80:95]
    ds_read_b64_tr_b16 v[48:49], v13 offset:38912
    ds_read_b64_tr_b16 v[50:51], v13 offset:39936
    ds_read_b64_tr_b16 v[52:53], v14 offset:38912
    ds_read_b64_tr_b16 v[54:55], v14 offset:39936
    s_waitcnt vmcnt(15) lgkmcnt(8)
    v_mfma_f32_32x32x16_bf16 v[64:79], v[56:59], a[20:23], v[64:79]
    v_mfma_f32_32x32x16_bf16 v[80:95], v[60:63], a[20:23], v[80:95]
    s_barrier
    ds_read_b64_tr_b16 v[56:57], v13 offset:49152
    ds_read_b64_tr_b16 v[58:59], v13 offset:50176
    ds_read_b64_tr_b16 v[60:61], v14 offset:49152
    ds_read_b64_tr_b16 v[62:63], v14 offset:50176
    s_waitcnt vmcnt(14) lgkmcnt(8)
    v_mfma_f32_32x32x16_bf16 v[64:79], v[40:43], a[24:27], v[64:79]
    s_waitcnt vmcnt(1)
    v_cmp_ne_u32 vcc, 1, v6
    s_nop 0
    s_cbranch_vccz L_pok_57
    s_mov_b32 s47, 0x20000
    s_add_u32 s31, s38, 262144
L_spin_58:
    buffer_load_dword v6, v7, s[12:15], s31 offen sc1
    s_sub_u32 s47, s47, 1
    s_waitcnt vmcnt(0)
    v_cmp_ne_u32 vcc, 1, v6
    s_cbranch_scc1 L_spok_59
    s_cbranch_vccnz L_spin_58
L_spok_59:
L_pok_57:
    v_mfma_f32_32x32x16_bf16 v[80:95], v[44:47], a[24:27], v[80:95]
    s_waitcnt vmcnt(0)
    s_add_u32 s31, s39, 393216
    s_mov_b64 exec, 1
    buffer_store_dword v10, v9, s[12:15], s31 offen sc1
    s_mov_b64 exec, -1
    ds_read_b64_tr_b16 v[40:41], v13 offset:51200
    ds_read_b64_tr_b16 v[42:43], v13 offset:52224
    ds_read_b64_tr_b16 v[44:45], v14 offset:51200
    ds_read_b64_tr_b16 v[46:47], v14 offset:52224
    s_waitcnt lgkmcnt(8)
    v_mfma_f32_32x32x16_bf16 v[64:79], v[48:51], a[28:31], v[64:79]
    s_add_u32 s32, s54, 2048
    buffer_load_dwordx4 a[64:67], v2, s[12:15], s32 offen sc1
    v_mfma_f32_32x32x16_bf16 v[80:95], v[52:55], a[28:31], v[80:95]
    s_add_u32 s32, s54, 3072
    buffer_load_dwordx4 a[68:71], v2, s[12:15], s32 offen sc1
    ds_read_b64_tr_b16 v[48:49], v13 offset:53248
    ds_read_b64_tr_b16 v[50:51], v13 offset:54272
    ds_read_b64_tr_b16 v[52:53], v14 offset:53248
    ds_read_b64_tr_b16 v[54:55], v14 offset:54272
    s_waitcnt lgkmcnt(8)
    v_mfma_f32_32x32x16_bf16 v[64:79], v[56:59], a[32:35], v[64:79]
    s_add_u32 s32, s54, 30720
    buffer_load_dwordx4 a[72:75], v2, s[12:15], s32 offen sc1
    v_mfma_f32_32x32x16_bf16 v[80:95], v[60:63], a[32:35], v[80:95]
    s_add_u32 s32, s54, 31744
    buffer_load_dwordx4 a[76:79], v2, s[12:15], s32 offen sc1
    ds_read_b64_tr_b16 v[56:57], v13 offset:55296
    ds_read_b64_tr_b16 v[58:59], v13 offset:56320
    ds_read_b64_tr_b16 v[60:61], v14 offset:55296
    ds_read_b64_tr_b16 v[62:63], v14 offset:56320
    s_waitcnt lgkmcnt(8)
    v_mfma_f32_32x32x16_bf16 v[64:79], v[40:43], a[36:39], v[64:79]
    s_add_u32 s32, s54, 9216
    buffer_load_dwordx4 a[80:83], v2, s[12:15], s32 offen sc1
    v_mfma_f32_32x32x16_bf16 v[80:95], v[44:47], a[36:39], v[80:95]
    s_add_u32 s32, s54, 10240
    buffer_load_dwordx4 a[84:87], v2, s[12:15], s32 offen sc1
    s_barrier
    ds_read_b64_tr_b16 v[40:41], v11 offset:0
    ds_read_b64_tr_b16 v[42:43], v11 offset:1024
    ds_read_b64_tr_b16 v[44:45], v12 offset:0
    ds_read_b64_tr_b16 v[46:47], v12 offset:1024
    s_waitcnt lgkmcnt(8)
    v_mfma_f32_32x32x16_bf16 v[64:79], v[48:51], a[40:43], v[64:79]
    s_add_u32 s32, s54, 37888
    buffer_load_dwordx4 a[88:91], v2, s[12:15], s32 offen sc1
    v_mfma_f32_32x32x16_bf16 v[80:95], v[52:55], a[40:43], v[80:95]
    s_add_u32 s32, s54, 38912
    buffer_load_dwordx4 a[92:95], v2, s[12:15], s32 offen sc1
    ds_read_b64_tr_b16 v[48:49], v11 offset:2048
    ds_read_b64_tr_b16 v[50:51], v11 offset:3072
    ds_read_b64_tr_b16 v[52:53], v12 offset:2048
    ds_read_b64_tr_b16 v[54:55], v12 offset:3072
    s_waitcnt lgkmcnt(8)
    v_mfma_f32_32x32x16_bf16 v[64:79], v[56:59], a[44:47], v[64:79]
    s_add_u32 s32, s54, 16384
    buffer_load_dwordx4 a[96:99], v2, s[12:15], s32 offen sc1
    v_mfma_f32_32x32x16_bf16 v[80:95], v[60:63], a[44:47], v[80:95]
    s_add_u32 s32, s54, 17408
    buffer_load_dwordx4 a[100:103], v2, s[12:15], s32 offen sc1
    ds_read_b64_tr_b16 v[56:57], v11 offset:4096
    ds_read_b64_tr_b16 v[58:59], v11 offset:5120
    ds_read_b64_tr_b16 v[60:61], v12 offset:4096
    ds_read_b64_tr_b16 v[62:63], v12 offset:5120
    s_waitcnt lgkmcnt(8)
    v_mfma_f32_32x32x16_bf16 v[64:79], v[40:43], a[48:51], v[64:79]
    s_add_u32 s32, s54, 45056
    buffer_load_dwordx4 a[104:107], v2, s[12:15], s32 offen sc1
    v_mfma_f32_32x32x16_bf16 v[80:95], v[44:47], a[48:51], v[80:95]
    s_add_u32 s32, s54, 46080
    buffer_load_dwordx4 a[108:111], v2, s[12:15], s32 offen sc1
    ds_read_b64_tr_b16 v[40:41], v11 offset:6144
    ds_read_b64_tr_b16 v[42:43], v11 offset:7168
    ds_read_b64_tr_b16 v[44:45], v12 offset:6144
    ds_read_b64_tr_b16 v[46:47], v12 offset:7168
    s_waitcnt lgkmcnt(8)
    v_mfma_f32_32x32x16_bf16 v[64:79], v[48:51], a[52:55], v[64:79]
    s_add_u32 s32, s54, 23552
    buffer_load_dwordx4 a[112:115], v2, s[12:15], s32 offen sc1
    v_mfma_f32_32x32x16_bf16 v[80:95], v[52:55], a[52:55], v[80:95]
    s_add_u32 s32, s54, 24576
    buffer_load_dwordx4 a[116:119], v2, s[12:15], s32 offen sc1
    s_barrier
    ds_read_b64_tr_b16 v[48:49], v11 offset:16384
    ds_read_b64_tr_b16 v[50:51], v11 offset:17408
    ds_read_b64_tr_b16 v[52:53], v12 offset:16384
    ds_read_b64_tr_b16 v[54:55], v12 offset:17408
    s_waitcnt lgkmcnt(8)
    v_mfma_f32_32x32x16_bf16 v[64:79], v[56:59], a[56:59], v[64:79]
    s_add_u32 s32, s54, 52224
    buffer_load_dwordx4 a[120:123], v2, s[12:15], s32 offen sc1
    v_mfma_f32_32x32x16_bf16 v[80:95], v[60:63], a[56:59], v[80:95]
    s_add_u32 s32, s54, 53248
    buffer_load_dwordx4 a[124:127], v2, s[12:15], s32 offen sc1
    ds_read_b64_tr_b16 v[56:57], v11 offset:18432
    ds_read_b64_tr_b16 v[58:59], v11 offset:19456
    ds_read_b64_tr_b16 v[60:61], v12 offset:18432
    ds_read_b64_tr_b16 v[62:63], v12 offset:19456
    s_waitcnt lgkmcnt(8)
    v_mfma_f32_32x32x16_bf16 v[64:79], v[40:43], a[60:63], v[64:79]
    v_mfma_f32_32x32x16_bf16 v[80:95], v[44:47], a[60:63], v[80:95]
    ds_read_b64_tr_b16 v[40:41], v11 offset:20480
    ds_read_b64_tr_b16 v[42:43], v11 offset:21504
    ds_read_b64_tr_b16 v[44:45], v12 offset:20480
    ds_read_b64_tr_b16 v[46:47], v12 offset:21504
    s_waitcnt vmcnt(15) lgkmcnt(8)
    v_mfma_f32_32x32x16_bf16 v[64:79], v[48:51], a[64:67], v[64:79]
    v_mfma_f32_32x32x16_bf16 v[80:95], v[52:55], a[64:67], v[80:95]
    ds_read_b64_tr_b16 v[48:49], v11 offset:22528
    ds_read_b64_tr_b16 v[50:51], v11 offset:23552
    ds_read_b64_tr_b16 v[52:53], v12 offset:22528
    ds_read_b64_tr_b16 v[54:55], v12 offset:23552
    s_waitcnt vmcnt(14) lgkmcnt(8)
    v_mfma_f32_32x32x16_bf16 v[64:79], v[56:59], a[68:71], v[64:79]
    v_mfma_f32_32x32x16_bf16 v[80:95], v[60:63], a[68:71], v[80:95]
    s_barrier
    ds_read_b64_tr_b16 v[56:57], v11 offset:32768
    ds_read_b64_tr_b16 v[58:59], v11 offset:33792
    ds_read_b64_tr_b16 v[60:61], v12 offset:32768
    ds_read_b64_tr_b16 v[62:63], v12 offset:33792
    s_waitcnt vmcnt(13) lgkmcnt(8)
    v_mfma_f32_32x32x16_bf16 v[64:79], v[40:43], a[72:75], v[64:79]
    s_add_u32 s31, s38, 393216
    buffer_load_dword v6, v7, s[12:15], s31 offen sc1
    v_mfma_f32_32x32x16_bf16 v[80:95], v[44:47], a[72:75], v[80:95]
    ds_read_b64_tr_b16 v[40:41], v11 offset:34816
    ds_read_b64_tr_b16 v[42:43], v11 offset:35840
    ds_read_b64_tr_b16 v[44:45], v12 offset:34816
    ds_read_b64_tr_b16 v[46:47], v12 offset:35840
    s_waitcnt vmcnt(13) lgkmcnt(8)
    v_mfma_f32_32x32x16_bf16 v[64:79], v[48:51], a[76:79], v[64:79]
    v_mfma_f32_32x32x16_bf16 v[80:95], v[52:55], a[76:79], v[80:95]
    ds_read_b64_tr_b16 v[48:49], v11 offset:36864
    ds_read_b64_tr_b16 v[50:51], v11 offset:37888
    ds_read_b64_tr_b16 v[52:53], v12 offset:36864
    ds_read_b64_tr_b16 v[54:55], v12 offset:37888
    s_waitcnt vmcnt(12) lgkmcnt(8)
    v_mfma_f32_32x32x16_bf16 v[64:79], v[56:59], a[80:83], v[64:79]
    v_mfma_f32_32x32x16_bf16 v[80:95], v[60:63], a[80:83], v[80:95]
    ds_read_b64_tr_b16 v[56:57], v11 offset:38912
    ds_read_b64_tr_b16 v[58:59], v11 offset:39936
    ds_read_b64_tr_b16 v[60:61], v12 offset:38912
    ds_read_b64_tr_b16 v[62:63], v12 offset:39936
    s_waitcnt vmcnt(11) lgkmcnt(8)
    v_mfma_f32_32x32x16_bf16 v[64:79], v[40:43], a[84:87], v[64:79]
    v_mfma_f32_32x32x16_bf16 v[80:95], v[44:47], a[84:87], v[80:95]
    s_barrier
    ds_read_b64_tr_b16 v[40:41], v11 offset:49152
    ds_read_b64_tr_b16 v[42:43], v11 offset:50176
    ds_read_b64_tr_b16 v[44:45], v12 offset:49152
    ds_read_b64_tr_b16 v[46:47], v12 offset:50176
    s_waitcnt vmcnt(10) lgkmcnt(8)
    v_mfma_f32_32x32x16_bf16 v[64:79], v[48:51], a[88:91], v[64:79]
    v_mfma_f32_32x32x16_bf16 v[80:95], v[52:55], a[88:91], v[80:95]
    ds_read_b64_tr_b16 v[48:49], v11 offset:51200
    ds_read_b64_tr_b16 v[50:51], v11 offset:52224
    ds_read_b64_tr_b16 v[52:53], v12 offset:51200
    ds_read_b64_tr_b16 v[54:55], v12 offset:52224
    s_waitcnt vmcnt(9) lgkmcnt(8)
    v_mfma_f32_32x32x16_bf16 v[64:79], v[56:59], a[92:95], v[64:79]
    v_mfma_f32_32x32x16_bf16 v[80:95], v[60:63], a[92:95], v[80:95]
    ds_read_b64_tr_b16 v[56:57], v11 offset:53248
    ds_read_b64_tr_b16 v[58:59], v11 offset:54272
    ds_read_b64_tr_b16 v[60:61], v12 offset:53248
    ds_read_b64_tr_b16 v[62:63], v12 offset:54272
    s_waitcnt vmcnt(8) lgkmcnt(8)
    v_mfma_f32_32x32x16_bf16 v[64:79], v[40:43], a[96:99], v[64:79]
    v_mfma_f32_32x32x16_bf16 v[80:95], v[44:47], a[96:99], v[80:95]
    ds_read_b64_tr_b16 v[40:41], v11 offset:55296
    ds_read_b64_tr_b16 v[42:43], v11 offset:56320
    ds_read_b64_tr_b16 v[44:45], v12 offset:55296
    ds_read_b64_tr_b16 v[46:47], v12 offset:56320
    s_waitcnt vmcnt(7) lgkmcnt(8)
    v_mfma_f32_32x32x16_bf16 v[64:79], v[48:51], a[100:103], v[64:79]
    v_mfma_f32_32x32x16_bf16 v[80:95], v[52:55], a[100:103], v[80:95]
    s_barrier
    ds_read_b64_tr_b16 v[48:49], v13 offset:0
    ds_read_b64_tr_b16 v[50:51], v13 offset:1024
    ds_read_b64_tr_b16 v[52:53], v14 offset:0
    ds_read_b64_tr_b16 v[54:55], v14 offset:1024
    s_waitcnt vmcnt(6) lgkmcnt(8)
    v_mfma_f32_32x32x16_bf16 v[64:79], v[56:59], a[104:107], v[64:79]
    s_waitcnt vmcnt(0)
    v_cmp_ne_u32 vcc, 1, v6
    s_nop 0
    s_cbranch_vccz L_pok_60
    s_mov_b32 s47, 0x20000
    s_add_u32 s31, s38, 393216
L_spin_61:
    buffer_load_dword v6, v7, s[12:15], s31 offen sc1
    s_sub_u32 s47, s47, 1
    s_waitcnt vmcnt(0)
    v_cmp_ne_u32 vcc, 1, v6
    s_cbranch_scc1 L_spok_62
    s_cbranch_vccnz L_spin_61
L_spok_62:
L_pok_60:
    v_mfma_f32_32x32x16_bf16 v[80:95], v[60:63], a[104:107], v[80:95]
    s_add_u32 s32, s54, 4096
    buffer_load_dwordx4 v[96:99], v2, s[12:15], s32 offen sc1
    ds_read_b64_tr_b16 v[56:57], v13 offset:2048
    ds_read_b64_tr_b16 v[58:59], v13 offset:3072
    ds_read_b64_tr_b16 v[60:61], v14 offset:2048
    ds_read_b64_tr_b16 v[62:63], v14 offset:3072
    s_waitcnt lgkmcnt(8)
    v_mfma_f32_32x32x16_bf16 v[64:79], v[40:43], a[108:111], v[64:79]
    s_add_u32 s32, s54, 5120
    buffer_load_dwordx4 v[100:103], v2, s[12:15], s32 offen sc1
    v_mfma_f32_32x32x16_bf16 v[80:95], v[44:47], a[108:111], v[80:95]
    s_add_u32 s32, s54, 32768
    buffer_load_dwordx4 v[104:107], v2, s[12:15], s32 offen sc1
    ds_read_b64_tr_b16 v[40:41], v13 offset:4096
    ds_read_b64_tr_b16 v[42:43], v13 offset:5120
    ds_read_b64_tr_b16 v[44:45], v14 offset:4096
    ds_read_b64_tr_b16 v[46:47], v14 offset:5120
    s_waitcnt lgkmcnt(8)
    v_mfma_f32_32x32x16_bf16 v[64:79], v[48:51], a[112:115], v[64:79]
    s_add_u32 s32, s54, 33792
    buffer_load_dwordx4 v[108:111], v2, s[12:15], s32 offen sc1
    v_mfma_f32_32x32x16_bf16 v[80:95], v[52:55], a[112:115], v[80:95]
    s_add_u32 s32, s54, 6144
    buffer_load_dwordx4 v[112:115], v2, s[12:15], s32 offen sc1
    ds_read_b64_tr_b16 v[48:49], v13 offset:6144
    ds_read_b64_tr_b16 v[50:51], v13 offset:7168
    ds_read_b64_tr_b16 v[52:53], v14 offset:6144
    ds_read_b64_tr_b16 v[54:55], v14 offset:7168
    s_waitcnt lgkmcnt(8)
    v_mfma_f32_32x32x16_bf16 v[64:79], v[56:59], a[116:119], v[64:79]
    s_add_u32 s32, s54, 11264
    buffer_load_dwordx4 v[116:119], v2, s[12:15], s32 offen sc1
    v_mfma_f32_32x32x16_bf16 v[80:95], v[60:63], a[116:119], v[80:95]
    s_add_u32 s32, s54, 34816
    buffer_load_dwordx4 v[120:123], v2, s[12:15], s32 offen sc1
    s_barrier
    ds_read_b64_tr_b16 v[56:57], v13 offset:16384
    ds_read_b64_tr_b16 v[58:59], v13 offset:17408
    ds_read_b64_tr_b16 v[60:61], v14 offset:16384
    ds_read_b64_tr_b16 v[62:63], v14 offset:17408
    s_waitcnt lgkmcnt(8)
    v_mfma_f32_32x32x16_bf16 v[64:79], v[40:43], a[120:123], v[64:79]
    s_add_u32 s32, s54, 39936
    buffer_load_dwordx4 v[124:127], v2, s[12:15], s32 offen sc1
    v_mfma_f32_32x32x16_bf16 v[80:95], v[44:47], a[120:123], v[80:95]
    s_add_u32 s32, s54, 12288
    buffer_load_dwordx4 a[0:3], v2, s[12:15], s32 offen sc1
    ds_read_b64_tr_b16 v[40:41], v13 offset:18432
    ds_read_b64_tr_b16 v[42:43], v13 offset:19456
    ds_read_b64_tr_b16 v[44:45], v14 offset:18432
    ds_read_b64_tr_b16 v[46:47], v14 offset:19456
    s_waitcnt lgkmcnt(8)
    v_mfma_f32_32x32x16_bf16 v[64:79], v[48:51], a[124:127], v[64:79]
    s_add_u32 s32, s54, 13312
    buffer_load_dwordx4 a[4:7], v2, s[12:15], s32 offen sc1
    v_mfma_f32_32x32x16_bf16 v[80:95], v[52:55], a[124:127], v[80:95]
    s_add_u32 s32, s54, 40960
    buffer_load_dwordx4 a[8:11], v2, s[12:15], s32 offen sc1
    ds_read_b64_tr_b16 v[48:49], v13 offset:20480
    ds_read_b64_tr_b16 v[50:51], v13 offset:21504
    ds_read_b64_tr_b16 v[52:53], v14 offset:20480
    ds_read_b64_tr_b16 v[54:55], v14 offset:21504
    s_waitcnt vmcnt(10) lgkmcnt(8)
    v_mfma_f32_32x32x16_bf16 v[64:79], v[56:59], v[96:99], v[64:79]
    s_add_u32 s32, s54, 41984
    buffer_load_dwordx4 a[12:15], v2, s[12:15], s32 offen sc1
    v_mfma_f32_32x32x16_bf16 v[80:95], v[60:63], v[96:99], v[80:95]
    s_add_u32 s32, s54, 18432
    buffer_load_dwordx4 a[16:19], v2, s[12:15], s32 offen sc1
    ds_read_b64_tr_b16 v[56:57], v13 offset:22528
    ds_read_b64_tr_b16 v[58:59], v13 offset:23552
    ds_read_b64_tr_b16 v[60:61], v14 offset:22528
    ds_read_b64_tr_b16 v[62:63], v14 offset:23552
    s_waitcnt vmcnt(11) lgkmcnt(8)
    v_mfma_f32_32x32x16_bf16 v[64:79], v[40:43], v[100:103], v[64:79]
    s_add_u32 s32, s54, 19456
    buffer_load_dwordx4 a[20:23], v2, s[12:15], s32 offen sc1
    v_mfma_f32_32x32x16_bf16 v[80:95], v[44:47], v[100:103], v[80:95]
    s_add_u32 s32, s54, 47104
    buffer_load_dwordx4 a[24:27], v2, s[12:15], s32 offen sc1
    s_barrier
    ds_read_b64_tr_b16 v[40:41], v15 offset:0
    ds_read_b64_tr_b16 v[42:43], v15 offset:1024
    ds_read_b64_tr_b16 v[44:45], v16 offset:0
    ds_read_b64_tr_b16 v[46:47], v16 offset:1024
    s_waitcnt vmcnt(12) lgkmcnt(8)
    v_mfma_f32_32x32x16_bf16 v[64:79], v[48:51], v[104:107], v[64:79]
    s_add_u32 s32, s54, 48128
    buffer_load_dwordx4 a[28:31], v2, s[12:15], s32 offen sc1
    v_mfma_f32_32x32x16_bf16 v[80:95], v[52:55], v[104:107], v[80:95]
    s_add_u32 s32, s54, 20480
    buffer_load_dwordx4 a[32:35], v2, s[12:15], s32 offen sc1
    ds_read_b64_tr_b16 v[48:49], v15 offset:2048
    ds_read_b64_tr_b16 v[50:51], v15 offset:3072
    ds_read_b64_tr_b16 v[52:53], v16 offset:2048
    ds_read_b64_tr_b16 v[54:55], v16 offset:3072
    s_waitcnt vmcnt(13) lgkmcnt(8)
    v_mfma_f32_32x32x16_bf16 v[64:79], v[56:59], v[108:111], v[64:79]
    s_add_u32 s32, s54, 25600
    buffer_load_dwordx4 a[36:39], v2, s[12:15], s32 offen sc1
    v_mfma_f32_32x32x16_bf16 v[80:95], v[60:63], v[108:111], v[80:95]
    s_add_u32 s32, s54, 49152
    buffer_load_dwordx4 a[40:43], v2, s[12:15], s32 offen sc1
    ds_read_b64_tr_b16 v[56:57], v15 offset:4096
    ds_read_b64_tr_b16 v[58:59], v15 offset:5120
    ds_read_b64_tr_b16 v[60:61], v16 offset:4096
    ds_read_b64_tr_b16 v[62:63], v16 offset:5120
    s_waitcnt vmcnt(14) lgkmcnt(8)
    v_mfma_f32_32x32x16_bf16 v[64:79], v[40:43], v[112:115], v[64:79]
    s_add_u32 s32, s54, 54272
    buffer_load_dwordx4 a[44:47], v2, s[12:15], s32 offen sc1
    v_mfma_f32_32x32x16_bf16 v[80:95], v[44:47], v[112:115], v[80:95]
    s_add_u32 s32, s54, 26624
    buffer_load_dwordx4 a[48:51], v2, s[12:15], s32 offen sc1
    ds_read_b64_tr_b16 v[40:41], v15 offset:6144
    ds_read_b64_tr_b16 v[42:43], v15 offset:7168
    ds_read_b64_tr_b16 v[44:45], v16 offset:6144
    ds_read_b64_tr_b16 v[46:47], v16 offset:7168
    s_waitcnt vmcnt(15) lgkmcnt(8)
    v_mfma_f32_32x32x16_bf16 v[64:79], v[48:51], v[116:119], v[64:79]
    s_add_u32 s32, s54, 27648
    buffer_load_dwordx4 a[52:55], v2, s[12:15], s32 offen sc1
    v_mfma_f32_32x32x16_bf16 v[80:95], v[52:55], v[116:119], v[80:95]
    s_add_u32 s32, s54, 55296
    buffer_load_dwordx4 a[56:59], v2, s[12:15], s32 offen sc1
    s_barrier
    ds_read_b64_tr_b16 v[48:49], v13 offset:32768
    ds_read_b64_tr_b16 v[50:51], v13 offset:33792
    ds_read_b64_tr_b16 v[52:53], v14 offset:32768
    ds_read_b64_tr_b16 v[54:55], v14 offset:33792
    s_waitcnt vmcnt(16) lgkmcnt(8)
    v_mfma_f32_32x32x16_bf16 v[64:79], v[56:59], v[120:123], v[64:79]
    s_add_u32 s32, s54, 56320
    buffer_load_dwordx4 a[60:63], v2, s[12:15], s32 offen sc1
    v_mfma_f32_32x32x16_bf16 v[80:95], v[60:63], v[120:123], v[80:95]
    ds_read_b64_tr_b16 v[56:57], v13 offset:34816
    ds_read_b64_tr_b16 v[58:59], v13 offset:35840
    ds_read_b64_tr_b16 v[60:61], v14 offset:34816
    ds_read_b64_tr_b16 v[62:63], v14 offset:35840
    s_waitcnt vmcnt(16) lgkmcnt(8)
    v_mfma_f32_32x32x16_bf16 v[64:79], v[40:43], v[124:127], v[64:79]
    v_mfma_f32_32x32x16_bf16 v[80:95], v[44:47], v[124:127], v[80:95]
    ds_read_b64_tr_b16 v[40:41], v13 offset:36864
    ds_read_b64_tr_b16 v[42:43], v13 offset:37888
    ds_read_b64_tr_b16 v[44:45], v14 offset:36864
    ds_read_b64_tr_b16 v[46:47], v14 offset:37888
    s_waitcnt vmcnt(15) lgkmcnt(8)
    v_mfma_f32_32x32x16_bf16 v[64:79], v[48:51], a[0:3], v[64:79]
    v_mfma_f32_32x32x16_bf16 v[80:95], v[52:55], a[0:3], v[80:95]
    ds_read_b64_tr_b16 v[48:49], v13 offset:38912
    ds_read_b64_tr_b16 v[50:51], v13 offset:39936
    ds_read_b64_tr_b16 v[52:53], v14 offset:38912
    ds_read_b64_tr_b16 v[54:55], v14 offset:39936
    s_waitcnt vmcnt(14) lgkmcnt(8)
    v_mfma_f32_32x32x16_bf16 v[64:79], v[56:59], a[4:7], v[64:79]
    v_mfma_f32_32x32x16_bf16 v[80:95], v[60:63], a[4:7], v[80:95]
    s_barrier
    ds_read_b64_tr_b16 v[56:57], v13 offset:49152
    ds_read_b64_tr_b16 v[58:59], v13 offset:50176
    ds_read_b64_tr_b16 v[60:61], v14 offset:49152
    ds_read_b64_tr_b16 v[62:63], v14 offset:50176
    s_waitcnt vmcnt(13) lgkmcnt(8)
    v_mfma_f32_32x32x16_bf16 v[64:79], v[40:43], a[8:11], v[64:79]
    v_mfma_f32_32x32x16_bf16 v[80:95], v[44:47], a[8:11], v[80:95]
    ds_read_b64_tr_b16 v[40:41], v13 offset:51200
    ds_read_b64_tr_b16 v[42:43], v13 offset:52224
    ds_read_b64_tr_b16 v[44:45], v14 offset:51200
    ds_read_b64_tr_b16 v[46:47], v14 offset:52224
    s_waitcnt vmcnt(12) lgkmcnt(8)
    v_mfma_f32_32x32x16_bf16 v[64:79], v[48:51], a[12:15], v[64:79]
    v_mfma_f32_32x32x16_bf16 v[80:95], v[52:55], a[12:15], v[80:95]
    ds_read_b64_tr_b16 v[48:49], v13 offset:53248
    ds_read_b64_tr_b16 v[50:51], v13 offset:54272
    ds_read_b64_tr_b16 v[52:53], v14 offset:53248
    ds_read_b64_tr_b16 v[54:55], v14 offset:54272
    s_waitcnt vmcnt(11) lgkmcnt(8)
    v_mfma_f32_32x32x16_bf16 v[64:79], v[56:59], a[16:19], v[64:79]
    v_mfma_f32_32x32x16_bf16 v[80:95], v[60:63], a[16:19], v[80:95]
    ds_read_b64_tr_b16 v[56:57], v13 offset:55296
    ds_read_b64_tr_b16 v[58:59], v13 offset:56320
    ds_read_b64_tr_b16 v[60:61], v14 offset:55296
    ds_read_b64_tr_b16 v[62:63], v14 offset:56320
    s_waitcnt vmcnt(10) lgkmcnt(8)
    v_mfma_f32_32x32x16_bf16 v[64:79], v[40:43], a[20:23], v[64:79]
    v_mfma_f32_32x32x16_bf16 v[80:95], v[44:47], a[20:23], v[80:95]
    s_barrier
    ds_read_b64_tr_b16 v[40:41], v11 offset:0
    ds_read_b64_tr_b16 v[42:43], v11 offset:1024
    ds_read_b64_tr_b16 v[44:45], v12 offset:0
    ds_read_b64_tr_b16 v[46:47], v12 offset:1024
    s_waitcnt vmcnt(9) lgkmcnt(8)
    v_mfma_f32_32x32x16_bf16 v[64:79], v[48:51], a[24:27], v[64:79]
    v_mfma_f32_32x32x16_bf16 v[80:95], v[52:55], a[24:27], v[80:95]
    ds_read_b64_tr_b16 v[48:49], v11 offset:2048
    ds_read_b64_tr_b16 v[50:51], v11 offset:3072
    ds_read_b64_tr_b16 v[52:53], v12 offset:2048
    ds_read_b64_tr_b16 v[54:55], v12 offset:3072
    s_waitcnt vmcnt(8) lgkmcnt(8)
    v_mfma_f32_32x32x16_bf16 v[64:79], v[56:59], a[28:31], v[64:79]
    v_mfma_f32_32x32x16_bf16 v[80:95], v[60:63], a[28:31], v[80:95]
    ds_read_b64_tr_b16 v[56:57], v11 offset:4096
    ds_read_b64_tr_b16 v[58:59], v11 offset:5120
    ds_read_b64_tr_b16 v[60:61], v12 offset:4096
    ds_read_b64_tr_b16 v[62:63], v12 offset:5120
    s_waitcnt vmcnt(7) lgkmcnt(8)
    v_mfma_f32_32x32x16_bf16 v[64:79], v[40:43], a[32:35], v[64:79]
    v_mfma_f32_32x32x16_bf16 v[80:95], v[44:47], a[32:35], v[80:95]
    ds_read_b64_tr_b16 v[40:41], v11 offset:6144
    ds_read_b64_tr_b16 v[42:43], v11 offset:7168
    ds_read_b64_tr_b16 v[44:45], v12 offset:6144
    ds_read_b64_tr_b16 v[46:47], v12 offset:7168
    s_waitcnt vmcnt(6) lgkmcnt(8)
    v_mfma_f32_32x32x16_bf16 v[64:79], v[48:51], a[36:39], v[64:79]
    v_mfma_f32_32x32x16_bf16 v[80:95], v[52:55], a[36:39], v[80:95]
    s_barrier
    ds_read_b64_tr_b16 v[48:49], v11 offset:16384
    ds_read_b64_tr_b16 v[50:51], v11 offset:17408
    ds_read_b64_tr_b16 v[52:53], v12 offset:16384
    ds_read_b64_tr_b16 v[54:55], v12 offset:17408
    s_waitcnt vmcnt(5) lgkmcnt(8)
    v_mfma_f32_32x32x16_bf16 v[64:79], v[56:59], a[40:43], v[64:79]
    v_mfma_f32_32x32x16_bf16 v[80:95], v[60:63], a[40:43], v[80:95]
    ds_read_b64_tr_b16 v[56:57], v11 offset:18432
    ds_read_b64_tr_b16 v[58:59], v11 offset:19456
    ds_read_b64_tr_b16 v[60:61], v12 offset:18432
    ds_read_b64_tr_b16 v[62:63], v12 offset:19456
    s_waitcnt vmcnt(4) lgkmcnt(8)
    v_mfma_f32_32x32x16_bf16 v[64:79], v[40:43], a[44:47], v[64:79]
    v_mfma_f32_32x32x16_bf16 v[80:95], v[44:47], a[44:47], v[80:95]
    ds_read_b64_tr_b16 v[40:41], v11 offset:20480
    ds_read_b64_tr_b16 v[42:43], v11 offset:21504
    ds_read_b64_tr_b16 v[44:45], v12 offset:20480
    ds_read_b64_tr_b16 v[46:47], v12 offset:21504
    s_waitcnt vmcnt(3) lgkmcnt(8)
    v_mfma_f32_32x32x16_bf16 v[64:79], v[48:51], a[48:51], v[64:79]
    v_mfma_f32_32x32x16_bf16 v[80:95], v[52:55], a[48:51], v[80:95]
    ds_read_b64_tr_b16 v[48:49], v11 offset:22528
    ds_read_b64_tr_b16 v[50:51], v11 offset:23552
    ds_read_b64_tr_b16 v[52:53], v12 offset:22528
    ds_read_b64_tr_b16 v[54:55], v12 offset:23552
    s_waitcnt vmcnt(2) lgkmcnt(8)
    v_mfma_f32_32x32x16_bf16 v[64:79], v[56:59], a[52:55], v[64:79]
    v_mfma_f32_32x32x16_bf16 v[80:95], v[60:63], a[52:55], v[80:95]
    s_waitcnt vmcnt(1) lgkmcnt(4)
    v_mfma_f32_32x32x16_bf16 v[64:79], v[40:43], a[56:59], v[64:79]
    v_mfma_f32_32x32x16_bf16 v[80:95], v[44:47], a[56:59], v[80:95]
    s_waitcnt vmcnt(0) lgkmcnt(0)
    v_mfma_f32_32x32x16_bf16 v[64:79], v[48:51], a[60:63], v[64:79]
    v_mfma_f32_32x32x16_bf16 v[80:95], v[52:55], a[60:63], v[80:95]
    v_lshlrev_b32 v96, 16, v24
    v_and_b32 v97, 0xffff0000, v24
    v_lshlrev_b32 v98, 16, v25
    v_and_b32 v99, 0xffff0000, v25
    v_lshlrev_b32 v100, 16, v26
    v_and_b32 v101, 0xffff0000, v26
    v_lshlrev_b32 v102, 16, v27
    v_and_b32 v103, 0xffff0000, v27
    v_lshlrev_b32 v104, 16, v28
    v_and_b32 v105, 0xffff0000, v28
    v_lshlrev_b32 v106, 16, v29
    v_and_b32 v107, 0xffff0000, v29
    v_lshlrev_b32 v108, 16, v30
    v_and_b32 v109, 0xffff0000, v30
    v_lshlrev_b32 v110, 16, v31
    v_and_b32 v111, 0xffff0000, v31
    s_lshl_b32 s31, s24, 12
    s_add_u32 s31, s31, 114688
    v_add_u32 v3, s31, v2
    v_xor_b32 v4, 8192, v3
    ds_write_b128 v3, v[80:83] offset:0
    ds_write_b128 v3, v[84:87] offset:1024
    ds_write_b128 v3, v[88:91] offset:2048
    ds_write_b128 v3, v[92:95] offset:3072
    s_waitcnt lgkmcnt(0)
    s_barrier
    ds_read_b128 v[80:83], v4 offset:0
    ds_read_b128 v[84:87], v4 offset:1024
    ds_read_b128 v[88:91], v4 offset:2048
    ds_read_b128 v[92:95], v4 offset:3072
    v_pk_add_f32 v[64:65], v[64:65], v[96:97] op_sel:[0,0] op_sel_hi:[1,1]
    v_pk_add_f32 v[66:67], v[66:67], v[98:99] op_sel:[0,0] op_sel_hi:[1,1]
    v_pk_add_f32 v[68:69], v[68:69], v[100:101] op_sel:[0,0] op_sel_hi:[1,1]
    v_pk_add_f32 v[70:71], v[70:71], v[102:103] op_sel:[0,0] op_sel_hi:[1,1]
    v_pk_add_f32 v[72:73], v[72:73], v[104:105] op_sel:[0,0] op_sel_hi:[1,1]
    v_pk_add_f32 v[74:75], v[74:75], v[106:107] op_sel:[0,0] op_sel_hi:[1,1]
    v_pk_add_f32 v[76:77], v[76:77], v[108:109] op_sel:[0,0] op_sel_hi:[1,1]
    v_pk_add_f32 v[78:79], v[78:79], v[110:111] op_sel:[0,0] op_sel_hi:[1,1]
    s_waitcnt lgkmcnt(0)
    v_pk_add_f32 v[64:65], v[64:65], v[80:81] op_sel:[0,0] op_sel_hi:[1,1]
    v_pk_add_f32 v[66:67], v[66:67], v[82:83] op_sel:[0,0] op_sel_hi:[1,1]
    v_pk_add_f32 v[68:69], v[68:69], v[84:85] op_sel:[0,0] op_sel_hi:[1,1]
    v_pk_add_f32 v[70:71], v[70:71], v[86:87] op_sel:[0,0] op_sel_hi:[1,1]
    v_pk_add_f32 v[72:73], v[72:73], v[88:89] op_sel:[0,0] op_sel_hi:[1,1]
    v_pk_add_f32 v[74:75], v[74:75], v[90:91] op_sel:[0,0] op_sel_hi:[1,1]
    v_pk_add_f32 v[76:77], v[76:77], v[92:93] op_sel:[0,0] op_sel_hi:[1,1]
    v_pk_add_f32 v[78:79], v[78:79], v[94:95] op_sel:[0,0] op_sel_hi:[1,1]
    v_cvt_pk_bf16_f32 v96, v64, v65
    v_cvt_pk_bf16_f32 v97, v66, v67
    v_cvt_pk_bf16_f32 v98, v68, v69
    v_cvt_pk_bf16_f32 v99, v70, v71
    v_cvt_pk_bf16_f32 v100, v72, v73
    v_cvt_pk_bf16_f32 v101, v74, v75
    v_cvt_pk_bf16_f32 v102, v76, v77
    v_cvt_pk_bf16_f32 v103, v78, v79
    s_nop 1
    v_permlane32_swap_b32 v96, v98
    v_permlane32_swap_b32 v97, v99
    v_permlane32_swap_b32 v100, v102
    v_permlane32_swap_b32 v101, v103
    s_nop 1
    buffer_store_dwordx4 v[96:99], v8, s[40:43], 0 offen
    buffer_store_dwordx4 v[100:103], v8, s[40:43], 0 offen offset:32
    s_branch L_end_11
L_vs_16:
    s_cmp_eq_u32 s58, 0
    s_cbranch_scc1 L_vd_17
    s_sub_u32 s58, s58, 1
    s_cmp_lg_u32 s58, 0
    s_cbranch_scc1 L_vn_63
    s_mov_b32 s47, 0x20000
    s_add_u32 s31, s38, 0
L_spin_64:
    buffer_load_dword v6, v7, s[12:15], s31 offen sc1
    s_sub_u32 s47, s47, 1
    s_waitcnt vmcnt(0)
    v_cmp_ne_u32 vcc, 1, v6
    s_cbranch_scc1 L_spok_65
    s_cbranch_vccnz L_spin_64
L_spok_65:
    s_add_u32 s31, s56, 4096
    buffer_load_dwordx4 a[16:19], v2, s[12:15], s31 offen offset:0 sc1
    buffer_load_dwordx4 a[20:23], v2, s[12:15], s31 offen offset:1024 sc1
    buffer_load_dwordx4 a[24:27], v2, s[12:15], s31 offen offset:2048 sc1
    buffer_load_dwordx4 a[28:31], v2, s[12:15], s31 offen offset:3072 sc1
    s_add_u32 s31, s56, 8192
    buffer_load_dwordx4 a[32:35], v2, s[12:15], s31 offen offset:0 sc1
    buffer_load_dwordx4 a[36:39], v2, s[12:15], s31 offen offset:1024 sc1
    buffer_load_dwordx4 a[40:43], v2, s[12:15], s31 offen offset:2048 sc1
    buffer_load_dwordx4 a[44:47], v2, s[12:15], s31 offen offset:3072 sc1
    s_add_u32 s31, s56, 12288
    buffer_load_dwordx4 a[48:51], v2, s[12:15], s31 offen offset:0 sc1
    buffer_load_dwordx4 a[52:55], v2, s[12:15], s31 offen offset:1024 sc1
    buffer_load_dwordx4 a[56:59], v2, s[12:15], s31 offen offset:2048 sc1
    buffer_load_dwordx4 a[60:63], v2, s[12:15], s31 offen offset:3072 sc1
L_vn_63:
    s_add_u32 s31, s56, 0
    buffer_load_dwordx4 a[0:3], v2, s[12:15], s31 offen offset:0 sc1
    buffer_load_dwordx4 a[4:7], v2, s[12:15], s31 offen offset:1024 sc1
    buffer_load_dwordx4 a[8:11], v2, s[12:15], s31 offen offset:2048 sc1
    buffer_load_dwordx4 a[12:15], v2, s[12:15], s31 offen offset:3072 sc1
    s_waitcnt vmcnt(0)
    v_mfma_f32_16x16x32_bf16 v[32:35], v[36:39], a[0:3], 0
    v_mfma_f32_16x16x32_bf16 v[32:35], v[36:39], a[4:7], v[32:35]
    v_mfma_f32_16x16x32_bf16 v[32:35], v[36:39], a[8:11], v[32:35]
    v_mfma_f32_16x16x32_bf16 v[32:35], v[36:39], a[12:15], v[32:35]
    s_nop 7
    s_branch L_vt_15
L_vs_19:
    s_cmp_eq_u32 s58, 0
    s_cbranch_scc1 L_vd_20
    s_sub_u32 s58, s58, 1
    s_cmp_lg_u32 s58, 0
    s_cbranch_scc1 L_vn_66
    s_mov_b32 s47, 0x20000
    s_add_u32 s31, s38, 0
L_spin_67:
    buffer_load_dword v6, v7, s[12:15], s31 offen sc1
    s_sub_u32 s47, s47, 1
    s_waitcnt vmcnt(0)
    v_cmp_ne_u32 vcc, 1, v6
    s_cbranch_scc1 L_spok_68
    s_cbranch_vccnz L_spin_67
L_spok_68:
    s_add_u32 s31, s56, 8192
    buffer_load_dwordx4 a[32:35], v2, s[12:15], s31 offen offset:0 sc1
    buffer_load_dwordx4 a[36:39], v2, s[12:15], s31 offen offset:1024 sc1
    buffer_load_dwordx4 a[40:43], v2, s[12:15], s31 offen offset:2048 sc1
    buffer_load_dwordx4 a[44:47], v2, s[12:15], s31 offen offset:3072 sc1
    s_add_u32 s31, s56, 12288
    buffer_load_dwordx4 a[48:51], v2, s[12:15], s31 offen offset:0 sc1
    buffer_load_dwordx4 a[52:55], v2, s[12:15], s31 offen offset:1024 sc1
    buffer_load_dwordx4 a[56:59], v2, s[12:15], s31 offen offset:2048 sc1
    buffer_load_dwordx4 a[60:63], v2, s[12:15], s31 offen offset:3072 sc1
L_vn_66:
    s_add_u32 s31, s56, 4096
    buffer_load_dwordx4 a[16:19], v2, s[12:15], s31 offen offset:0 sc1
    buffer_load_dwordx4 a[20:23], v2, s[12:15], s31 offen offset:1024 sc1
    buffer_load_dwordx4 a[24:27], v2, s[12:15], s31 offen offset:2048 sc1
    buffer_load_dwordx4 a[28:31], v2, s[12:15], s31 offen offset:3072 sc1
    s_waitcnt vmcnt(0)
    v_mfma_f32_16x16x32_bf16 v[32:35], v[36:39], a[16:19], 0
    v_mfma_f32_16x16x32_bf16 v[32:35], v[36:39], a[20:23], v[32:35]
    v_mfma_f32_16x16x32_bf16 v[32:35], v[36:39], a[24:27], v[32:35]
    v_mfma_f32_16x16x32_bf16 v[32:35], v[36:39], a[28:31], v[32:35]
    s_nop 7
    s_branch L_vt_18
L_vs_22:
    s_cmp_eq_u32 s58, 0
    s_cbranch_scc1 L_vd_23
    s_sub_u32 s58, s58, 1
    s_cmp_lg_u32 s58, 0
    s_cbranch_scc1 L_vn_69
    s_mov_b32 s47, 0x20000
    s_add_u32 s31, s38, 0
L_spin_70:
    buffer_load_dword v6, v7, s[12:15], s31 offen sc1
    s_sub_u32 s47, s47, 1
    s_waitcnt vmcnt(0)
    v_cmp_ne_u32 vcc, 1, v6
    s_cbranch_scc1 L_spok_71
    s_cbranch_vccnz L_spin_70
L_spok_71:
    s_add_u32 s31, s56, 12288
    buffer_load_dwordx4 a[48:51], v2, s[12:15], s31 offen offset:0 sc1
    buffer_load_dwordx4 a[52:55], v2, s[12:15], s31 offen offset:1024 sc1
    buffer_load_dwordx4 a[56:59], v2, s[12:15], s31 offen offset:2048 sc1
    buffer_load_dwordx4 a[60:63], v2, s[12:15], s31 offen offset:3072 sc1
L_vn_69:
    s_add_u32 s31, s56, 8192
    buffer_load_dwordx4 a[32:35], v2, s[12:15], s31 offen offset:0 sc1
    buffer_load_dwordx4 a[36:39], v2, s[12:15], s31 offen offset:1024 sc1
    buffer_load_dwordx4 a[40:43], v2, s[12:15], s31 offen offset:2048 sc1
    buffer_load_dwordx4 a[44:47], v2, s[12:15], s31 offen offset:3072 sc1
    s_waitcnt vmcnt(0)
    v_mfma_f32_16x16x32_bf16 v[32:35], v[36:39], a[32:35], 0
    v_mfma_f32_16x16x32_bf16 v[32:35], v[36:39], a[36:39], v[32:35]
    v_mfma_f32_16x16x32_bf16 v[32:35], v[36:39], a[40:43], v[32:35]
    v_mfma_f32_16x16x32_bf16 v[32:35], v[36:39], a[44:47], v[32:35]
    s_nop 7
    s_branch L_vt_21
L_vs_25:
    s_cmp_eq_u32 s58, 0
    s_cbranch_scc1 L_vd_26
    s_sub_u32 s58, s58, 1
    s_cmp_lg_u32 s58, 0
    s_cbranch_scc1 L_vn_72
    s_mov_b32 s47, 0x20000
    s_add_u32 s31, s38, 0
L_spin_73:
    buffer_load_dword v6, v7, s[12:15], s31 offen sc1
    s_sub_u32 s47, s47, 1
    s_waitcnt vmcnt(0)
    v_cmp_ne_u32 vcc, 1, v6
    s_cbranch_scc1 L_spok_74
    s_cbranch_vccnz L_spin_73
L_spok_74:
L_vn_72:
    s_add_u32 s31, s56, 12288
    buffer_load_dwordx4 a[48:51], v2, s[12:15], s31 offen offset:0 sc1
    buffer_load_dwordx4 a[52:55], v2, s[12:15], s31 offen offset:1024 sc1
    buffer_load_dwordx4 a[56:59], v2, s[12:15], s31 offen offset:2048 sc1
    buffer_load_dwordx4 a[60:63], v2, s[12:15], s31 offen offset:3072 sc1
    s_waitcnt vmcnt(0)
    v_mfma_f32_16x16x32_bf16 v[32:35], v[36:39], a[48:51], 0
    v_mfma_f32_16x16x32_bf16 v[32:35], v[36:39], a[52:55], v[32:35]
    v_mfma_f32_16x16x32_bf16 v[32:35], v[36:39], a[56:59], v[32:35]
    v_mfma_f32_16x16x32_bf16 v[32:35], v[36:39], a[60:63], v[32:35]
    s_nop 7
    s_branch L_vt_24
L_vs_28:
    s_cmp_eq_u32 s58, 0
    s_cbranch_scc1 L_vd_29
    s_sub_u32 s58, s58, 1
    s_cmp_lg_u32 s58, 0
    s_cbranch_scc1 L_vn_75
    s_mov_b32 s47, 0x20000
    s_add_u32 s31, s38, 0
L_spin_76:
    buffer_load_dword v6, v7, s[12:15], s31 offen sc1
    s_sub_u32 s47, s47, 1
    s_waitcnt vmcnt(0)
    v_cmp_ne_u32 vcc, 1, v6
    s_cbranch_scc1 L_spok_77
    s_cbranch_vccnz L_spin_76
L_spok_77:
    s_add_u32 s31, s56, 4096
    buffer_load_dwordx4 a[16:19], v2, s[12:15], s31 offen offset:0 sc1
    buffer_load_dwordx4 a[20:23], v2, s[12:15], s31 offen offset:1024 sc1
    buffer_load_dwordx4 a[24:27], v2, s[12:15], s31 offen offset:2048 sc1
    buffer_load_dwordx4 a[28:31], v2, s[12:15], s31 offen offset:3072 sc1
    s_add_u32 s31, s56, 8192
    buffer_load_dwordx4 a[32:35], v2, s[12:15], s31 offen offset:0 sc1
    buffer_load_dwordx4 a[36:39], v2, s[12:15], s31 offen offset:1024 sc1
    buffer_load_dwordx4 a[40:43], v2, s[12:15], s31 offen offset:2048 sc1
    buffer_load_dwordx4 a[44:47], v2, s[12:15], s31 offen offset:3072 sc1
    s_add_u32 s31, s56, 12288
    buffer_load_dwordx4 a[48:51], v2, s[12:15], s31 offen offset:0 sc1
    buffer_load_dwordx4 a[52:55], v2, s[12:15], s31 offen offset:1024 sc1
    buffer_load_dwordx4 a[56:59], v2, s[12:15], s31 offen offset:2048 sc1
    buffer_load_dwordx4 a[60:63], v2, s[12:15], s31 offen offset:3072 sc1
L_vn_75:
    s_add_u32 s31, s56, 0
    buffer_load_dwordx4 a[0:3], v2, s[12:15], s31 offen offset:0 sc1
    buffer_load_dwordx4 a[4:7], v2, s[12:15], s31 offen offset:1024 sc1
    buffer_load_dwordx4 a[8:11], v2, s[12:15], s31 offen offset:2048 sc1
    buffer_load_dwordx4 a[12:15], v2, s[12:15], s31 offen offset:3072 sc1
    s_waitcnt vmcnt(0)
    v_mfma_f32_16x16x32_bf16 v[32:35], v[36:39], a[0:3], 0
    v_mfma_f32_16x16x32_bf16 v[32:35], v[36:39], a[4:7], v[32:35]
    v_mfma_f32_16x16x32_bf16 v[32:35], v[36:39], a[8:11], v[32:35]
    v_mfma_f32_16x16x32_bf16 v[32:35], v[36:39], a[12:15], v[32:35]
    s_nop 7
    s_branch L_vt_27
L_vs_31:
    s_cmp_eq_u32 s58, 0
    s_cbranch_scc1 L_vd_32
    s_sub_u32 s58, s58, 1
    s_cmp_lg_u32 s58, 0
    s_cbranch_scc1 L_vn_78
    s_mov_b32 s47, 0x20000
    s_add_u32 s31, s38, 0
L_spin_79:
    buffer_load_dword v6, v7, s[12:15], s31 offen sc1
    s_sub_u32 s47, s47, 1
    s_waitcnt vmcnt(0)
    v_cmp_ne_u32 vcc, 1, v6
    s_cbranch_scc1 L_spok_80
    s_cbranch_vccnz L_spin_79
L_spok_80:
    s_add_u32 s31, s56, 8192
    buffer_load_dwordx4 a[32:35], v2, s[12:15], s31 offen offset:0 sc1
    buffer_load_dwordx4 a[36:39], v2, s[12:15], s31 offen offset:1024 sc1
    buffer_load_dwordx4 a[40:43], v2, s[12:15], s31 offen offset:2048 sc1
    buffer_load_dwordx4 a[44:47], v2, s[12:15], s31 offen offset:3072 sc1
    s_add_u32 s31, s56, 12288
    buffer_load_dwordx4 a[48:51], v2, s[12:15], s31 offen offset:0 sc1
    buffer_load_dwordx4 a[52:55], v2, s[12:15], s31 offen offset:1024 sc1
    buffer_load_dwordx4 a[56:59], v2, s[12:15], s31 offen offset:2048 sc1
    buffer_load_dwordx4 a[60:63], v2, s[12:15], s31 offen offset:3072 sc1
    s_add_u32 s31, s56, 16384
    buffer_load_dwordx4 a[64:67], v2, s[12:15], s31 offen offset:0 sc1
    buffer_load_dwordx4 a[68:71], v2, s[12:15], s31 offen offset:1024 sc1
    buffer_load_dwordx4 a[72:75], v2, s[12:15], s31 offen offset:2048 sc1
    buffer_load_dwordx4 a[76:79], v2, s[12:15], s31 offen offset:3072 sc1
    s_add_u32 s31, s56, 20480
    buffer_load_dwordx4 a[80:83], v2, s[12:15], s31 offen offset:0 sc1
    buffer_load_dwordx4 a[84:87], v2, s[12:15], s31 offen offset:1024 sc1
    buffer_load_dwordx4 a[88:91], v2, s[12:15], s31 offen offset:2048 sc1
    buffer_load_dwordx4 a[92:95], v2, s[12:15], s31 offen offset:3072 sc1
L_vn_78:
    s_add_u32 s31, s56, 4096
    buffer_load_dwordx4 a[16:19], v2, s[12:15], s31 offen offset:0 sc1
    buffer_load_dwordx4 a[20:23], v2, s[12:15], s31 offen offset:1024 sc1
    buffer_load_dwordx4 a[24:27], v2, s[12:15], s31 offen offset:2048 sc1
    buffer_load_dwordx4 a[28:31], v2, s[12:15], s31 offen offset:3072 sc1
    s_waitcnt vmcnt(0)
    v_mfma_f32_16x16x32_bf16 v[32:35], v[36:39], a[16:19], 0
    v_mfma_f32_16x16x32_bf16 v[32:35], v[36:39], a[20:23], v[32:35]
    v_mfma_f32_16x16x32_bf16 v[32:35], v[36:39], a[24:27], v[32:35]
    v_mfma_f32_16x16x32_bf16 v[32:35], v[36:39], a[28:31], v[32:35]
    s_nop 7
    s_branch L_vt_30
L_vs_34:
    s_cmp_eq_u32 s58, 0
    s_cbranch_scc1 L_vd_35
    s_sub_u32 s58, s58, 1
    s_cmp_lg_u32 s58, 0
    s_cbranch_scc1 L_vn_81
    s_mov_b32 s47, 0x20000
    s_add_u32 s31, s38, 0
L_spin_82:
    buffer_load_dword v6, v7, s[12:15], s31 offen sc1
    s_sub_u32 s47, s47, 1
    s_waitcnt vmcnt(0)
    v_cmp_ne_u32 vcc, 1, v6
    s_cbranch_scc1 L_spok_83
    s_cbranch_vccnz L_spin_82
L_spok_83:
    s_add_u32 s31, s56, 12288
    buffer_load_dwordx4 a[48:51], v2, s[12:15], s31 offen offset:0 sc1
    buffer_load_dwordx4 a[52:55], v2, s[12:15], s31 offen offset:1024 sc1
    buffer_load_dwordx4 a[56:59], v2, s[12:15], s31 offen offset:2048 sc1
    buffer_load_dwordx4 a[60:63], v2, s[12:15], s31 offen offset:3072 sc1
    s_add_u32 s31, s56, 16384
    buffer_load_dwordx4 a[64:67], v2, s[12:15], s31 offen offset:0 sc1
    buffer_load_dwordx4 a[68:71], v2, s[12:15], s31 offen offset:1024 sc1
    buffer_load_dwordx4 a[72:75], v2, s[12:15], s31 offen offset:2048 sc1
    buffer_load_dwordx4 a[76:79], v2, s[12:15], s31 offen offset:3072 sc1
    s_add_u32 s31, s56, 20480
    buffer_load_dwordx4 a[80:83], v2, s[12:15], s31 offen offset:0 sc1
    buffer_load_dwordx4 a[84:87], v2, s[12:15], s31 offen offset:1024 sc1
    buffer_load_dwordx4 a[88:91], v2, s[12:15], s31 offen offset:2048 sc1
    buffer_load_dwordx4 a[92:95], v2, s[12:15], s31 offen offset:3072 sc1
    s_add_u32 s31, s56, 24576
    buffer_load_dwordx4 a[96:99], v2, s[12:15], s31 offen offset:0 sc1
    buffer_load_dwordx4 a[100:103], v2, s[12:15], s31 offen offset:1024 sc1
    buffer_load_dwordx4 a[104:107], v2, s[12:15], s31 offen offset:2048 sc1
    buffer_load_dwordx4 a[108:111], v2, s[12:15], s31 offen offset:3072 sc1
    s_add_u32 s31, s56, 28672
    buffer_load_dwordx4 a[112:115], v2, s[12:15], s31 offen offset:0 sc1
    buffer_load_dwordx4 a[116:119], v2, s[12:15], s31 offen offset:1024 sc1
    buffer_load_dwordx4 a[120:123], v2, s[12:15], s31 offen offset:2048 sc1
    buffer_load_dwordx4 a[124:127], v2, s[12:15], s31 offen offset:3072 sc1
L_vn_81:
    s_add_u32 s31, s56, 8192
    buffer_load_dwordx4 a[32:35], v2, s[12:15], s31 offen offset:0 sc1
    buffer_load_dwordx4 a[36:39], v2, s[12:15], s31 offen offset:1024 sc1
    buffer_load_dwordx4 a[40:43], v2, s[12:15], s31 offen offset:2048 sc1
    buffer_load_dwordx4 a[44:47], v2, s[12:15], s31 offen offset:3072 sc1
    s_waitcnt vmcnt(0)
    v_mfma_f32_16x16x32_bf16 v[32:35], v[36:39], a[32:35], 0
    v_mfma_f32_16x16x32_bf16 v[32:35], v[36:39], a[36:39], v[32:35]
    v_mfma_f32_16x16x32_bf16 v[32:35], v[36:39], a[40:43], v[32:35]
    v_mfma_f32_16x16x32_bf16 v[32:35], v[36:39], a[44:47], v[32:35]
    s_nop 7
    s_branch L_vt_33
L_vs_37:
    s_cmp_eq_u32 s58, 0
    s_cbranch_scc1 L_vd_38
    s_sub_u32 s58, s58, 1
    s_cmp_lg_u32 s58, 0
    s_cbranch_scc1 L_vn_84
    s_mov_b32 s47, 0x20000
    s_add_u32 s31, s38, 0
L_spin_85:
    buffer_load_dword v6, v7, s[12:15], s31 offen sc1
    s_sub_u32 s47, s47, 1
    s_waitcnt vmcnt(0)
    v_cmp_ne_u32 vcc, 1, v6
    s_cbranch_scc1 L_spok_86
    s_cbranch_vccnz L_spin_85
L_spok_86:
    s_add_u32 s31, s56, 16384
    buffer_load_dwordx4 a[64:67], v2, s[12:15], s31 offen offset:0 sc1
    buffer_load_dwordx4 a[68:71], v2, s[12:15], s31 offen offset:1024 sc1
    buffer_load_dwordx4 a[72:75], v2, s[12:15], s31 offen offset:2048 sc1
    buffer_load_dwordx4 a[76:79], v2, s[12:15], s31 offen offset:3072 sc1
    s_add_u32 s31, s56, 20480
    buffer_load_dwordx4 a[80:83], v2, s[12:15], s31 offen offset:0 sc1
    buffer_load_dwordx4 a[84:87], v2, s[12:15], s31 offen offset:1024 sc1
    buffer_load_dwordx4 a[88:91], v2, s[12:15], s31 offen offset:2048 sc1
    buffer_load_dwordx4 a[92:95], v2, s[12:15], s31 offen offset:3072 sc1
    s_add_u32 s31, s56, 24576
    buffer_load_dwordx4 a[96:99], v2, s[12:15], s31 offen offset:0 sc1
    buffer_load_dwordx4 a[100:103], v2, s[12:15], s31 offen offset:1024 sc1
    buffer_load_dwordx4 a[104:107], v2, s[12:15], s31 offen offset:2048 sc1
    buffer_load_dwordx4 a[108:111], v2, s[12:15], s31 offen offset:3072 sc1
    s_add_u32 s31, s56, 28672
    buffer_load_dwordx4 a[112:115], v2, s[12:15], s31 offen offset:0 sc1
    buffer_load_dwordx4 a[116:119], v2, s[12:15], s31 offen offset:1024 sc1
    buffer_load_dwordx4 a[120:123], v2, s[12:15], s31 offen offset:2048 sc1
    buffer_load_dwordx4 a[124:127], v2, s[12:15], s31 offen offset:3072 sc1
L_vn_84:
    s_add_u32 s31, s56, 12288
    buffer_load_dwordx4 a[48:51], v2, s[12:15], s31 offen offset:0 sc1
    buffer_load_dwordx4 a[52:55], v2, s[12:15], s31 offen offset:1024 sc1
    buffer_load_dwordx4 a[56:59], v2, s[12:15], s31 offen offset:2048 sc1
    buffer_load_dwordx4 a[60:63], v2, s[12:15], s31 offen offset:3072 sc1
    s_waitcnt vmcnt(0)
    v_mfma_f32_16x16x32_bf16 v[32:35], v[36:39], a[48:51], 0
    v_mfma_f32_16x16x32_bf16 v[32:35], v[36:39], a[52:55], v[32:35]
    v_mfma_f32_16x16x32_bf16 v[32:35], v[36:39], a[56:59], v[32:35]
    v_mfma_f32_16x16x32_bf16 v[32:35], v[36:39], a[60:63], v[32:35]
    s_nop 7
    s_branch L_vt_36
L_vs_40:
    s_cmp_eq_u32 s58, 0
    s_cbranch_scc1 L_vd_41
    s_sub_u32 s58, s58, 1
    s_cmp_lg_u32 s58, 0
    s_cbranch_scc1 L_vn_87
    s_mov_b32 s47, 0x20000
    s_add_u32 s31, s38, 0
L_spin_88:
    buffer_load_dword v6, v7, s[12:15], s31 offen sc1
    s_sub_u32 s47, s47, 1
    s_waitcnt vmcnt(0)
    v_cmp_ne_u32 vcc, 1, v6
    s_cbranch_scc1 L_spok_89
    s_cbranch_vccnz L_spin_88
L_spok_89:
    s_add_u32 s31, s56, 20480
    buffer_load_dwordx4 a[80:83], v2, s[12:15], s31 offen offset:0 sc1
    buffer_load_dwordx4 a[84:87], v2, s[12:15], s31 offen offset:1024 sc1
    buffer_load_dwordx4 a[88:91], v2, s[12:15], s31 offen offset:2048 sc1
    buffer_load_dwordx4 a[92:95], v2, s[12:15], s31 offen offset:3072 sc1
    s_add_u32 s31, s56, 24576
    buffer_load_dwordx4 a[96:99], v2, s[12:15], s31 offen offset:0 sc1
    buffer_load_dwordx4 a[100:103], v2, s[12:15], s31 offen offset:1024 sc1
    buffer_load_dwordx4 a[104:107], v2, s[12:15], s31 offen offset:2048 sc1
    buffer_load_dwordx4 a[108:111], v2, s[12:15], s31 offen offset:3072 sc1
    s_add_u32 s31, s56, 28672
    buffer_load_dwordx4 a[112:115], v2, s[12:15], s31 offen offset:0 sc1
    buffer_load_dwordx4 a[116:119], v2, s[12:15], s31 offen offset:1024 sc1
    buffer_load_dwordx4 a[120:123], v2, s[12:15], s31 offen offset:2048 sc1
    buffer_load_dwordx4 a[124:127], v2, s[12:15], s31 offen offset:3072 sc1
L_vn_87:
    s_add_u32 s31, s56, 16384
    buffer_load_dwordx4 a[64:67], v2, s[12:15], s31 offen offset:0 sc1
    buffer_load_dwordx4 a[68:71], v2, s[12:15], s31 offen offset:1024 sc1
    buffer_load_dwordx4 a[72:75], v2, s[12:15], s31 offen offset:2048 sc1
    buffer_load_dwordx4 a[76:79], v2, s[12:15], s31 offen offset:3072 sc1
    s_waitcnt vmcnt(0)
    v_mfma_f32_16x16x32_bf16 v[32:35], v[36:39], a[64:67], 0
    v_mfma_f32_16x16x32_bf16 v[32:35], v[36:39], a[68:71], v[32:35]
    v_mfma_f32_16x16x32_bf16 v[32:35], v[36:39], a[72:75], v[32:35]
    v_mfma_f32_16x16x32_bf16 v[32:35], v[36:39], a[76:79], v[32:35]
    s_nop 7
    s_branch L_vt_39
L_vs_46:
    s_cmp_eq_u32 s58, 0
    s_cbranch_scc1 L_vd_47
    s_sub_u32 s58, s58, 1
    s_cmp_lg_u32 s58, 0
    s_cbranch_scc1 L_vn_90
    s_mov_b32 s47, 0x20000
    s_add_u32 s31, s38, 0
L_spin_91:
    buffer_load_dword v6, v7, s[12:15], s31 offen sc1
    s_sub_u32 s47, s47, 1
    s_waitcnt vmcnt(0)
    v_cmp_ne_u32 vcc, 1, v6
    s_cbranch_scc1 L_spok_92
    s_cbranch_vccnz L_spin_91
L_spok_92:
    s_add_u32 s31, s56, 24576
    buffer_load_dwordx4 a[96:99], v2, s[12:15], s31 offen offset:0 sc1
    buffer_load_dwordx4 a[100:103], v2, s[12:15], s31 offen offset:1024 sc1
    buffer_load_dwordx4 a[104:107], v2, s[12:15], s31 offen offset:2048 sc1
    buffer_load_dwordx4 a[108:111], v2, s[12:15], s31 offen offset:3072 sc1
    s_add_u32 s31, s56, 28672
    buffer_load_dwordx4 a[112:115], v2, s[12:15], s31 offen offset:0 sc1
    buffer_load_dwordx4 a[116:119], v2, s[12:15], s31 offen offset:1024 sc1
    buffer_load_dwordx4 a[120:123], v2, s[12:15], s31 offen offset:2048 sc1
    buffer_load_dwordx4 a[124:127], v2, s[12:15], s31 offen offset:3072 sc1
L_vn_90:
    s_add_u32 s31, s56, 20480
    buffer_load_dwordx4 a[80:83], v2, s[12:15], s31 offen offset:0 sc1
    buffer_load_dwordx4 a[84:87], v2, s[12:15], s31 offen offset:1024 sc1
    buffer_load_dwordx4 a[88:91], v2, s[12:15], s31 offen offset:2048 sc1
    buffer_load_dwordx4 a[92:95], v2, s[12:15], s31 offen offset:3072 sc1
    s_waitcnt vmcnt(0)
    v_mfma_f32_16x16x32_bf16 v[32:35], v[36:39], a[80:83], 0
    v_mfma_f32_16x16x32_bf16 v[32:35], v[36:39], a[84:87], v[32:35]
    v_mfma_f32_16x16x32_bf16 v[32:35], v[36:39], a[88:91], v[32:35]
    v_mfma_f32_16x16x32_bf16 v[32:35], v[36:39], a[92:95], v[32:35]
    s_nop 7
    s_branch L_vt_45
L_vs_49:
    s_cmp_eq_u32 s58, 0
    s_cbranch_scc1 L_vd_50
    s_sub_u32 s58, s58, 1
    s_cmp_lg_u32 s58, 0
    s_cbranch_scc1 L_vn_93
    s_mov_b32 s47, 0x20000
    s_add_u32 s31, s38, 0
L_spin_94:
    buffer_load_dword v6, v7, s[12:15], s31 offen sc1
    s_sub_u32 s47, s47, 1
    s_waitcnt vmcnt(0)
    v_cmp_ne_u32 vcc, 1, v6
    s_cbranch_scc1 L_spok_95
    s_cbranch_vccnz L_spin_94
L_spok_95:
    s_add_u32 s31, s56, 28672
    buffer_load_dwordx4 a[112:115], v2, s[12:15], s31 offen offset:0 sc1
    buffer_load_dwordx4 a[116:119], v2, s[12:15], s31 offen offset:1024 sc1
    buffer_load_dwordx4 a[120:123], v2, s[12:15], s31 offen offset:2048 sc1
    buffer_load_dwordx4 a[124:127], v2, s[12:15], s31 offen offset:3072 sc1
L_vn_93:
    s_add_u32 s31, s56, 24576
    buffer_load_dwordx4 a[96:99], v2, s[12:15], s31 offen offset:0 sc1
    buffer_load_dwordx4 a[100:103], v2, s[12:15], s31 offen offset:1024 sc1
    buffer_load_dwordx4 a[104:107], v2, s[12:15], s31 offen offset:2048 sc1
    buffer_load_dwordx4 a[108:111], v2, s[12:15], s31 offen offset:3072 sc1
    s_waitcnt vmcnt(0)
    v_mfma_f32_16x16x32_bf16 v[32:35], v[36:39], a[96:99], 0
    v_mfma_f32_16x16x32_bf16 v[32:35], v[36:39], a[100:103], v[32:35]
    v_mfma_f32_16x16x32_bf16 v[32:35], v[36:39], a[104:107], v[32:35]
    v_mfma_f32_16x16x32_bf16 v[32:35], v[36:39], a[108:111], v[32:35]
    s_nop 7
    s_branch L_vt_48
L_vs_52:
    s_cmp_eq_u32 s58, 0
    s_cbranch_scc1 L_vd_53
    s_sub_u32 s58, s58, 1
    s_cmp_lg_u32 s58, 0
    s_cbranch_scc1 L_vn_96
    s_mov_b32 s47, 0x20000
    s_add_u32 s31, s38, 0
L_spin_97:
    buffer_load_dword v6, v7, s[12:15], s31 offen sc1
    s_sub_u32 s47, s47, 1
    s_waitcnt vmcnt(0)
    v_cmp_ne_u32 vcc, 1, v6
    s_cbranch_scc1 L_spok_98
    s_cbranch_vccnz L_spin_97
L_spok_98:
L_vn_96:
    s_add_u32 s31, s56, 28672
    buffer_load_dwordx4 a[112:115], v2, s[12:15], s31 offen offset:0 sc1
    buffer_load_dwordx4 a[116:119], v2, s[12:15], s31 offen offset:1024 sc1
    buffer_load_dwordx4 a[120:123], v2, s[12:15], s31 offen offset:2048 sc1
    buffer_load_dwordx4 a[124:127], v2, s[12:15], s31 offen offset:3072 sc1
    s_waitcnt vmcnt(0)
    v_mfma_f32_16x16x32_bf16 v[32:35], v[36:39], a[112:115], 0
    v_mfma_f32_16x16x32_bf16 v[32:35], v[36:39], a[116:119], v[32:35]
    v_mfma_f32_16x16x32_bf16 v[32:35], v[36:39], a[120:123], v[32:35]
    v_mfma_f32_16x16x32_bf16 v[32:35], v[36:39], a[124:127], v[32:35]
    s_nop 7
    s_branch L_vt_51
    s_branch L_end_11
L_fallback_5:
    s_barrier
    v_accvgpr_write_b32 a0, 0
    v_accvgpr_write_b32 a1, 0
    v_accvgpr_write_b32 a2, 0
    v_accvgpr_write_b32 a3, 0
    v_accvgpr_write_b32 a4, 0
    v_accvgpr_write_b32 a5, 0
    v_accvgpr_write_b32 a6, 0
    v_accvgpr_write_b32 a7, 0
    v_accvgpr_write_b32 a8, 0
    v_accvgpr_write_b32 a9, 0
    v_accvgpr_write_b32 a10, 0
    v_accvgpr_write_b32 a11, 0
    v_accvgpr_write_b32 a12, 0
    v_accvgpr_write_b32 a13, 0
    v_accvgpr_write_b32 a14, 0
    v_accvgpr_write_b32 a15, 0
    v_accvgpr_write_b32 a16, 0
    v_accvgpr_write_b32 a17, 0
    v_accvgpr_write_b32 a18, 0
    v_accvgpr_write_b32 a19, 0
    v_accvgpr_write_b32 a20, 0
    v_accvgpr_write_b32 a21, 0
    v_accvgpr_write_b32 a22, 0
    v_accvgpr_write_b32 a23, 0
    v_accvgpr_write_b32 a24, 0
    v_accvgpr_write_b32 a25, 0
    v_accvgpr_write_b32 a26, 0
    v_accvgpr_write_b32 a27, 0
    v_accvgpr_write_b32 a28, 0
    v_accvgpr_write_b32 a29, 0
    v_accvgpr_write_b32 a30, 0
    v_accvgpr_write_b32 a31, 0
    v_mov_b32 v7, 0xff800000
    v_mov_b32 v8, 0xff800000
    v_mov_b32 v3, v2
    s_mov_b32 s30, 64
L_maxl_99:
    ds_read_b128 v[24:27], v3
    v_add_u32 v3, 2048, v3
    s_waitcnt lgkmcnt(0)
    v_mfma_f32_32x32x16_bf16 v[44:59], v[24:27], v[12:15], 0
    v_mfma_f32_32x32x16_bf16 v[60:75], v[24:27], v[16:19], 0
    s_nop 10
    v_max3_f32 v7, v44, v45, v7
    v_max3_f32 v7, v46, v47, v7
    v_max3_f32 v7, v48, v49, v7
    v_max3_f32 v7, v50, v51, v7
    v_max3_f32 v7, v52, v53, v7
    v_max3_f32 v7, v54, v55, v7
    v_max3_f32 v7, v56, v57, v7
    v_max3_f32 v7, v58, v59, v7
    v_max3_f32 v8, v60, v61, v8
    v_max3_f32 v8, v62, v63, v8
    v_max3_f32 v8, v64, v65, v8
    v_max3_f32 v8, v66, v67, v8
    v_max3_f32 v8, v68, v69, v8
    v_max3_f32 v8, v70, v71, v8
    v_max3_f32 v8, v72, v73, v8
    v_max3_f32 v8, v74, v75, v8
    s_sub_u32 s30, s30, 1
    s_cmp_lg_u32 s30, 0
    s_cbranch_scc1 L_maxl_99
    s_lshl_b32 s27, s33, 16
    v_add_u32 v3, s27, v2
    ds_read_b128 v[20:23], v3
    s_mov_b64 exec, s[34:35]
    ds_read_b128 v[28:31], v3 offset:1024
    ds_read_b128 v[32:35], v3 offset:1280
    s_mov_b64 exec, -1
    v_mov_b32 v4, v7
    v_mov_b32 v5, v8
    s_nop 1
    v_permlane32_swap_b32 v7, v4
    v_permlane32_swap_b32 v8, v5
    s_nop 1
    v_max_f32 v7, v7, v4
    v_max_f32 v8, v8, v5
    v_pk_mul_f32 v[76:77], v[6:7], -1.0 op_sel:[1,0] op_sel_hi:[1,0]
    v_pk_mul_f32 v[78:79], v[6:7], -1.0 op_sel:[1,0] op_sel_hi:[1,0]
    v_pk_mul_f32 v[80:81], v[6:7], -1.0 op_sel:[1,0] op_sel_hi:[1,0]
    v_pk_mul_f32 v[82:83], v[6:7], -1.0 op_sel:[1,0] op_sel_hi:[1,0]
    v_pk_mul_f32 v[84:85], v[6:7], -1.0 op_sel:[1,0] op_sel_hi:[1,0]
    v_pk_mul_f32 v[86:87], v[6:7], -1.0 op_sel:[1,0] op_sel_hi:[1,0]
    v_pk_mul_f32 v[88:89], v[6:7], -1.0 op_sel:[1,0] op_sel_hi:[1,0]
    v_pk_mul_f32 v[90:91], v[6:7], -1.0 op_sel:[1,0] op_sel_hi:[1,0]
    v_pk_mul_f32 v[92:93], v[8:9], -1.0 op_sel:[0,0] op_sel_hi:[0,0]
    v_pk_mul_f32 v[94:95], v[8:9], -1.0 op_sel:[0,0] op_sel_hi:[0,0]
    v_pk_mul_f32 v[96:97], v[8:9], -1.0 op_sel:[0,0] op_sel_hi:[0,0]
    v_pk_mul_f32 v[98:99], v[8:9], -1.0 op_sel:[0,0] op_sel_hi:[0,0]
    v_pk_mul_f32 v[100:101], v[8:9], -1.0 op_sel:[0,0] op_sel_hi:[0,0]
    v_pk_mul_f32 v[102:103], v[8:9], -1.0 op_sel:[0,0] op_sel_hi:[0,0]
    v_pk_mul_f32 v[104:105], v[8:9], -1.0 op_sel:[0,0] op_sel_hi:[0,0]
    v_pk_mul_f32 v[106:107], v[8:9], -1.0 op_sel:[0,0] op_sel_hi:[0,0]
    s_waitcnt lgkmcnt(0)
    s_nop 0
    v_mfma_f32_32x32x16_bf16 v[44:59], v[20:23], v[12:15], v[76:91]
    v_mov_b32 v68, 0
    v_mov_b32 v69, 0
    v_mov_b32 v70, 0
    v_mov_b32 v71, 0
    v_mov_b32 v72, 0
    v_mov_b32 v73, 0
    v_mov_b32 v74, 0
    v_mov_b32 v75, 0
    s_nop 3
    s_mov_b32 s30, 16
L_fbl_100:
    v_exp_f32 v44, v44
    v_exp_f32 v45, v45
    v_smfmac_f32_32x32x32_bf16 a[16:31], v[40:43], v[68:75], v6
    v_exp_f32 v46, v46
    ds_read_b128 v[24:27], v3 offset:2048
    s_mov_b64 exec, s[34:35]
    ds_read_b128 v[36:39], v3 offset:3072
    ds_read_b128 v[40:43], v3 offset:3328
    s_mov_b64 exec, -1
    v_exp_f32 v47, v47
    v_exp_f32 v48, v48
    v_mfma_f32_32x32x16_bf16 v[60:75], v[20:23], v[16:19], v[92:107]
    v_exp_f32 v49, v49
    v_exp_f32 v50, v50
    v_exp_f32 v51, v51
    v_exp_f32 v52, v52
    v_exp_f32 v53, v53
    v_exp_f32 v54, v54
    v_smfmac_f32_32x32x32_bf16 a[0:15], v[28:31], v[44:51], v6
    v_exp_f32 v55, v55
    v_exp_f32 v56, v56
    v_exp_f32 v57, v57
    v_exp_f32 v58, v58
    v_exp_f32 v59, v59
    v_exp_f32 v60, v60
    v_exp_f32 v61, v61
    v_smfmac_f32_32x32x32_bf16 a[0:15], v[32:35], v[52:59], v6
    v_exp_f32 v62, v62
    v_exp_f32 v63, v63
    v_exp_f32 v64, v64
    s_waitcnt lgkmcnt(0)
    v_mfma_f32_32x32x16_bf16 v[44:59], v[24:27], v[12:15], v[76:91]
    v_exp_f32 v65, v65
    v_exp_f32 v66, v66
    v_exp_f32 v67, v67
    v_exp_f32 v68, v68
    v_exp_f32 v69, v69
    v_exp_f32 v70, v70
    v_smfmac_f32_32x32x32_bf16 a[16:31], v[28:31], v[60:67], v6
    v_exp_f32 v71, v71
    v_exp_f32 v72, v72
    v_exp_f32 v73, v73
    v_exp_f32 v74, v74
    v_exp_f32 v75, v75
    v_exp_f32 v44, v44
    v_exp_f32 v45, v45
    v_smfmac_f32_32x32x32_bf16 a[16:31], v[32:35], v[68:75], v6
    v_exp_f32 v46, v46
    ds_read_b128 v[20:23], v3 offset:4096
    s_mov_b64 exec, s[34:35]
    ds_read_b128 v[28:31], v3 offset:5120
    ds_read_b128 v[32:35], v3 offset:5376
    s_mov_b64 exec, -1
    v_exp_f32 v47, v47
    v_exp_f32 v48, v48
    v_mfma_f32_32x32x16_bf16 v[60:75], v[24:27], v[16:19], v[92:107]
    v_exp_f32 v49, v49
    v_exp_f32 v50, v50
    v_exp_f32 v51, v51
    v_exp_f32 v52, v52
    v_exp_f32 v53, v53
    v_exp_f32 v54, v54
    v_smfmac_f32_32x32x32_bf16 a[0:15], v[36:39], v[44:51], v6
    v_exp_f32 v55, v55
    v_exp_f32 v56, v56
    v_exp_f32 v57, v57
    v_exp_f32 v58, v58
    v_exp_f32 v59, v59
    v_exp_f32 v60, v60
    v_exp_f32 v61, v61
    v_smfmac_f32_32x32x32_bf16 a[0:15], v[40:43], v[52:59], v6
    v_exp_f32 v62, v62
    v_exp_f32 v63, v63
    v_exp_f32 v64, v64
    s_waitcnt lgkmcnt(0)
    v_mfma_f32_32x32x16_bf16 v[44:59], v[20:23], v[12:15], v[76:91]
    v_exp_f32 v65, v65
    v_exp_f32 v66, v66
    v_exp_f32 v67, v67
    v_exp_f32 v68, v68
    v_exp_f32 v69, v69
    v_exp_f32 v70, v70
    v_smfmac_f32_32x32x32_bf16 a[16:31], v[36:39], v[60:67], v6
    v_exp_f32 v71, v71
    v_exp_f32 v72, v72
    v_exp_f32 v73, v73
    v_exp_f32 v74, v74
    v_exp_f32 v75, v75
    v_add_u32 v3, 4096, v3
    s_sub_u32 s30, s30, 1
    s_cmp_lg_u32 s30, 0
    s_cbranch_scc1 L_fbl_100
    s_waitcnt lgkmcnt(0)
    s_nop 1
    v_smfmac_f32_32x32x32_bf16 a[16:31], v[40:43], v[68:75], v6
    s_mov_b32 s27, 0x5e800000
    s_xor_b32 s28, s24, 4
    s_mul_i32 s28, s28, 3072
    s_add_u32 s28, s28, 131072
    v_add_u32 v5, s28, v2
    v_accvgpr_read_b32 v76, a0
    v_accvgpr_read_b32 v77, a1
    v_accvgpr_read_b32 v78, a2
    v_accvgpr_read_b32 v79, a3
    v_accvgpr_read_b32 v80, a4
    v_accvgpr_read_b32 v81, a5
    v_accvgpr_read_b32 v82, a6
    v_accvgpr_read_b32 v83, a7
    v_accvgpr_read_b32 v84, a8
    ds_write_b128 v9, a[16:19]
    ds_write_b128 v9, a[20:23] offset:1024
    ds_write_b128 v9, a[24:27] offset:2048
    s_waitcnt lgkmcnt(0)
    s_barrier
    ds_read_b128 v[44:47], v5
    ds_read_b128 v[48:51], v5 offset:1024
    ds_read_b128 v[52:55], v5 offset:2048
    s_lshl_b32 s28, s26, 5
    s_add_u32 s28, s28, s25
    s_waitcnt lgkmcnt(0)
    s_branch L_attok_6
L_end_11:
ffn_kernel_done:
    s_endpgm
TEXT_END:
.section .rodata,"a"
.p2align 6
.amdhsa_kernel qkv_kernel
  .amdhsa_next_free_vgpr 247
  .amdhsa_next_free_sgpr 48
  .amdhsa_accum_offset 248
  .amdhsa_group_segment_fixed_size 0
  .amdhsa_kernarg_size 80
  .amdhsa_user_sgpr_count 2
  .amdhsa_user_sgpr_kernarg_segment_ptr 1
  .amdhsa_system_sgpr_workgroup_id_x 1
.end_amdhsa_kernel
.p2align 6
.amdhsa_kernel ffn_kernel
  .amdhsa_next_free_vgpr 256
  .amdhsa_next_free_sgpr 100
  .amdhsa_accum_offset 128
  .amdhsa_group_segment_fixed_size 0
  .amdhsa_kernarg_size 80
  .amdhsa_user_sgpr_count 2
  .amdhsa_user_sgpr_kernarg_segment_ptr 1
  .amdhsa_system_sgpr_workgroup_id_x 1
.end_amdhsa_kernel
```
